```python
import torch

def _softmax(x, axis=-1):
    return torch.softmax(x, dim=axis)
def _gelu(x):
    return torch.nn.functional.gelu(x, approximate="tanh")
def _silu(x):
    return torch.nn.functional.silu(x)
def _sigmoid(x):
    return torch.sigmoid(x)
def _layernorm(x, axis=-1, eps=1e-5):
    m = x.mean(dim=axis, keepdim=True)
    v = x.var(dim=axis, keepdim=True, unbiased=False)
    return (x - m) / torch.sqrt(v + eps)
def _scatter_add(tgt, idx, src, axis=0):
    return tgt.clone().index_add_(axis, idx, src)
def _segment_sum(src, seg, n):
    out = torch.zeros((n,) + src.shape[1:], dtype=src.dtype)
    return out.index_add_(0, seg, src)
def _pad(x, pw):
    flat = tuple(v for pair in reversed(pw) for v in pair)
    return torch.nn.functional.pad(x, flat)

kernel_name = 'recurrent_scan__linear_kernel_hedgehog__dense_activation_silu__prompt'

def setup_inputs():

    _w = (lambda a: (lambda t: t.to(torch.bfloat16) if t.is_floating_point() else t)(torch.as_tensor(a)))
    def _A_setup():
        B, S, D, H = 1, 2048, 640, 32
        Dh = D // H
        return {
            "x": _w((lambda *s: torch.randn(*s, dtype=torch.bfloat16) * 0.05)(B, S, D)),
            "wqkv": _w((lambda *s: torch.randn(*s, dtype=torch.bfloat16) * 0.4)(D, 3 * D)),
            "w_phi": _w((lambda *s: torch.randn(*s, dtype=torch.bfloat16) * 0.4)(H, Dh, Dh) * (Dh ** -0.5)),
            "wo": _w((lambda *s: torch.randn(*s, dtype=torch.bfloat16) * 0.2)(D, D)),
        }
    _A_in = _A_setup()

    def _B_setup():
        B, S, D, F = 1, 2048, 640, 1728
        return {
            "x": _w((lambda *s: torch.randn(*s, dtype=torch.bfloat16) * 0.05)(B, S, D)),
            "w1": _w((lambda *s: torch.randn(*s, dtype=torch.bfloat16) * 0.4)(D, F) * (D ** -0.5)),
            "w2": _w((lambda *s: torch.randn(*s, dtype=torch.bfloat16) * 0.1)(F, D) * (F ** -0.5)),
        }
    _B_in = _B_setup()

    return {
        "A_x": _A_in["x"],
        "A_wqkv": _A_in["wqkv"],
        "A_w_phi": _A_in["w_phi"],
        "A_wo": _A_in["wo"],
        "B_x": _B_in["x"],
        "B_w1": _B_in["w1"],
        "B_w2": _B_in["w2"],
    }

def reference(A_x, A_wqkv, A_w_phi, A_wo, B_x, B_w1, B_w2):
    def _A_ref(x, wqkv, w_phi, wo):
        B, S, D = x.shape
        H = 32; Dh = D // H
        qkv = (lambda x, *d: x.permute(*d))((x @ wqkv).reshape(B, S, 3, H, Dh), 2, 0, 3, 1, 4)
        q, k, v = qkv[0], qkv[1], qkv[2]
        pq = torch.einsum("bhsd,hdf->bhsf", q, w_phi)
        pk = torch.einsum("bhsd,hdf->bhsf", k, w_phi)
        phi_q = torch.concatenate([_softmax(pq, axis=-1), _softmax(-pq, axis=-1)], axis=-1)
        phi_k = torch.concatenate([_softmax(pk, axis=-1), _softmax(-pk, axis=-1)], axis=-1)
        kv = torch.einsum("bhsf,bhsd->bhfd", phi_k, v)
        z  = torch.einsum("bhsf->bhf", phi_k)
        num = torch.einsum("bhqf,bhfd->bhqd", phi_q, kv)
        den = torch.einsum("bhqf,bhf->bhq", phi_q, z)[..., None] + 1e-6
        o = num / den
        return (lambda x, *d: x.permute(*d))(o, 0, 2, 1, 3).reshape(B, S, D) @ wo

    def _B_ref(x, w1, w2):
        h = torch.einsum("bsd,df->bsf", x, w1)
        h = _silu(h)
        out = torch.einsum("bsf,fd->bsd", h, w2)
        return out

    x = A_x
    xn = _layernorm(x, axis=-1)
    s = _A_ref(xn, A_wqkv, A_w_phi, A_wo)
    g = _silu(_B_ref(xn, B_w1, B_w2))
    return x + s * g
```

```asm
; @launch kernel=k1_kernel grid=(256,1,1) block=(512,1,1) lds=163840
.amdgcn_target "amdgcn-amd-amdhsa--gfx950"
.text
.globl k1_kernel
.p2align 8
.type k1_kernel,@function
k1_kernel:
    s_cmp_ge_u32 s2, 256
    s_cbranch_scc1 K1_END
    s_load_dwordx16 s[4:19], s[0:1], 0
    s_load_dwordx4 s[20:23], s[0:1], 64
    v_and_b32 v1, 63, v0
    v_and_b32 v2, 15, v0
    v_lshrrev_b32 v3, 4, v1
    v_lshrrev_b32 v24, 6, v0
    s_nop 0
    v_readfirstlane_b32 s48, v24
    s_and_b32 s49, s2, 7
    s_lshr_b32 s50, s2, 3
    s_and_b32 s51, s49, 1
    s_lshl_b32 s51, s51, 3
    s_and_b32 s66, s50, 7
    s_add_u32 s51, s51, s66
    s_lshr_b32 s52, s49, 1
    s_lshr_b32 s67, s50, 3
    s_lshl_b32 s52, s52, 1
    s_and_b32 s54, s67, 1
    s_add_u32 s52, s52, s54
    s_lshr_b32 s53, s67, 1
    s_and_b32 s54, s48, 3
    s_lshr_b32 s55, s48, 2
    s_mul_i32 s58, s52, 3
    s_add_u32 s58, s58, 3
    s_lshl_b32 s57, s52, 2
    s_cmp_lt_u32 s52, 3
    s_cselect_b32 s58, s57, s58
    s_cselect_b32 s68, 2, 3
    s_cmp_eq_u32 s53, 0
    s_cselect_b32 s68, s55, s68
    s_mov_b32 s59, 30
    s_mov_b32 s64, 30
    s_movk_i32 s65, 480
    s_movk_i32 s69, 2185
    s_mov_b32 s70, 4
    s_cmp_eq_u32 s68, 2
    s_cselect_b32 s59, 32, s59
    s_cselect_b32 s64, 34, s64
    s_cselect_b32 s65, 544, s65
    s_cselect_b32 s69, 1928, s69
    s_cselect_b32 s70, 5, s70
    s_cmp_eq_u32 s68, 3
    s_cselect_b32 s59, 24, s59
    s_cselect_b32 s64, 26, s64
    s_cselect_b32 s65, 416, s65
    s_cselect_b32 s69, 2521, s69
    s_mul_i32 s62, s52, 160
    s_lshl_b32 s57, s58, 7
    s_movk_i32 s63, 3840
    s_cmp_eq_u32 s53, 0
    s_cselect_b32 s62, s62, s57
    s_cselect_b32 s63, s63, 3456
    v_mov_b32 v13, 1073741824
    s_mul_i32 s72, s48, s70
    s_add_u32 s57, s72, 0
    s_lshl_b32 s57, s57, 6
    v_add_u32 v24, s57, v1
    v_mul_u32_u24 v25, s69, v24
    v_lshrrev_b32 v25, 16, v25
    v_mul_u32_u24 v26, s64, v25
    v_sub_u32 v26, v24, v26
    v_lshrrev_b32 v27, 1, v25
    v_and_b32 v27, 4, v27
    v_xor_b32 v25, v25, v27
    v_mul_u32_u24 v25, s63, v25
    v_lshl_add_u32 v25, v26, 4, v25
    v_add_u32 v25, s62, v25
    v_mul_u32_u24 v27, 26, v26
    v_lshrrev_b32 v27, 8, v27
    v_mul_u32_u24 v27, 1120, v27
    s_cmp_eq_u32 s53, 0
    s_cselect_b64 vcc, -1, 0
    v_cndmask_b32 v27, 0, v27, vcc
    v_add_u32 v25, v25, v27
    v_cmp_gt_u32 vcc, s59, v26
    s_nop 1
    v_cndmask_b32 v4, v13, v25, vcc
    s_add_u32 s57, s72, 1
    s_lshl_b32 s57, s57, 6
    v_add_u32 v24, s57, v1
    v_mul_u32_u24 v25, s69, v24
    v_lshrrev_b32 v25, 16, v25
    v_mul_u32_u24 v26, s64, v25
    v_sub_u32 v26, v24, v26
    v_lshrrev_b32 v27, 1, v25
    v_and_b32 v27, 4, v27
    v_xor_b32 v25, v25, v27
    v_mul_u32_u24 v25, s63, v25
    v_lshl_add_u32 v25, v26, 4, v25
    v_add_u32 v25, s62, v25
    v_mul_u32_u24 v27, 26, v26
    v_lshrrev_b32 v27, 8, v27
    v_mul_u32_u24 v27, 1120, v27
    s_cmp_eq_u32 s53, 0
    s_cselect_b64 vcc, -1, 0
    v_cndmask_b32 v27, 0, v27, vcc
    v_add_u32 v25, v25, v27
    v_cmp_gt_u32 vcc, s59, v26
    s_nop 1
    v_cndmask_b32 v5, v13, v25, vcc
    s_add_u32 s57, s72, 2
    s_lshl_b32 s57, s57, 6
    v_add_u32 v24, s57, v1
    v_mul_u32_u24 v25, s69, v24
    v_lshrrev_b32 v25, 16, v25
    v_mul_u32_u24 v26, s64, v25
    v_sub_u32 v26, v24, v26
    v_lshrrev_b32 v27, 1, v25
    v_and_b32 v27, 4, v27
    v_xor_b32 v25, v25, v27
    v_mul_u32_u24 v25, s63, v25
    v_lshl_add_u32 v25, v26, 4, v25
    v_add_u32 v25, s62, v25
    v_mul_u32_u24 v27, 26, v26
    v_lshrrev_b32 v27, 8, v27
    v_mul_u32_u24 v27, 1120, v27
    s_cmp_eq_u32 s53, 0
    s_cselect_b64 vcc, -1, 0
    v_cndmask_b32 v27, 0, v27, vcc
    v_add_u32 v25, v25, v27
    v_cmp_gt_u32 vcc, s59, v26
    s_nop 1
    v_cndmask_b32 v6, v13, v25, vcc
    s_add_u32 s57, s72, 3
    s_lshl_b32 s57, s57, 6
    v_add_u32 v24, s57, v1
    v_mul_u32_u24 v25, s69, v24
    v_lshrrev_b32 v25, 16, v25
    v_mul_u32_u24 v26, s64, v25
    v_sub_u32 v26, v24, v26
    v_lshrrev_b32 v27, 1, v25
    v_and_b32 v27, 4, v27
    v_xor_b32 v25, v25, v27
    v_mul_u32_u24 v25, s63, v25
    v_lshl_add_u32 v25, v26, 4, v25
    v_add_u32 v25, s62, v25
    v_mul_u32_u24 v27, 26, v26
    v_lshrrev_b32 v27, 8, v27
    v_mul_u32_u24 v27, 1120, v27
    s_cmp_eq_u32 s53, 0
    s_cselect_b64 vcc, -1, 0
    v_cndmask_b32 v27, 0, v27, vcc
    v_add_u32 v25, v25, v27
    v_cmp_gt_u32 vcc, s59, v26
    s_nop 1
    v_cndmask_b32 v7, v13, v25, vcc
    s_add_u32 s57, s72, 4
    s_lshl_b32 s57, s57, 6
    v_add_u32 v24, s57, v1
    v_mul_u32_u24 v25, s69, v24
    v_lshrrev_b32 v25, 16, v25
    v_mul_u32_u24 v26, s64, v25
    v_sub_u32 v26, v24, v26
    v_lshrrev_b32 v27, 1, v25
    v_and_b32 v27, 4, v27
    v_xor_b32 v25, v25, v27
    v_mul_u32_u24 v25, s63, v25
    v_lshl_add_u32 v25, v26, 4, v25
    v_add_u32 v25, s62, v25
    v_mul_u32_u24 v27, 26, v26
    v_lshrrev_b32 v27, 8, v27
    v_mul_u32_u24 v27, 1120, v27
    s_cmp_eq_u32 s53, 0
    s_cselect_b64 vcc, -1, 0
    v_cndmask_b32 v27, 0, v27, vcc
    v_add_u32 v25, v25, v27
    v_cmp_gt_u32 vcc, s59, v26
    s_nop 1
    v_cndmask_b32 v8, v13, v25, vcc
    v_lshrrev_b32 v24, 3, v1
    v_xor_b32 v25, v24, v1
    v_and_b32 v25, 7, v25
    v_mul_u32_u24 v24, 1280, v24
    v_lshl_add_u32 v24, v25, 4, v24
    s_lshl_b32 s57, s51, 3
    s_add_u32 s57, s57, s48
    s_mul_i32 s57, s57, 20480
    v_add_u32 v9, s57, v24
    v_add_u32 v10, 10240, v9
    v_and_b32 v24, 1, v1
    v_mul_u32_u24 v24, 156, v24
    v_lshrrev_b32 v25, 1, v1
    v_mul_u32_u24 v25, 1280, v25
    v_add_u32 v24, v24, v25
    v_lshlrev_b32 v25, 7, v1
    s_cmp_eq_u32 s53, 0
    s_cselect_b64 vcc, -1, 0
    v_cndmask_b32 v24, v25, v24, vcc
    s_lshl_b32 s57, s66, 3
    s_add_u32 s57, s57, s48
    s_mul_i32 s57, s57, s63
    s_add_u32 s57, s57, s62
    v_add_u32 v11, s57, v24
    s_lshl_b32 s57, s67, 3
    s_add_u32 s57, s57, s48
    s_lshl_b32 s57, s57, 2
    s_lshl_b32 s61, s51, 7
    s_add_u32 s57, s57, s61
    v_add_u32 v24, s57, v1
    v_mul_u32_u24 v12, 1280, v24
    s_lshl_b32 s57, s53, 3
    s_add_u32 s71, s57, s52
    s_lshl_b32 s57, s71, 3
    s_add_u32 s57, s57, s48
    s_lshl_b32 s61, s51, 7
    s_add_u32 s49, s57, s61
    s_mul_i32 s57, s49, 1280
    v_lshlrev_b32 v24, 5, v1
    v_add_u32 v24, s57, v24
    v_cmp_gt_u32 vcc, 40, v1
    s_nop 1
    v_cndmask_b32 v14, v13, v24, vcc
    v_mul_u32_u24 v24, 13, v1
    v_lshrrev_b32 v24, 8, v24
    v_mul_u32_u24 v24, 1120, v24
    s_cmp_eq_u32 s53, 0
    s_cselect_b64 vcc, -1, 0
    v_cndmask_b32 v24, 0, v24, vcc
    v_lshl_add_u32 v24, v1, 3, v24
    s_mul_i32 s57, s51, 40
    s_mul_i32 s61, s48, 5
    s_add_u32 s57, s57, s61
    s_mul_i32 s57, s57, s63
    s_add_u32 s57, s57, s62
    v_add_u32 v24, s57, v24
    s_lshl_b32 s57, s59, 1
    v_cmp_gt_u32 vcc, s57, v1
    s_nop 1
    v_cndmask_b32 v15, v13, v24, vcc
    s_lshl_b32 s57, s54, 12
    s_add_u32 s57, s57, 34816
    v_xor_b32 v24, v3, v2
    v_and_b32 v24, 7, v24
    v_lshl_add_u32 v24, v2, 3, v24
    v_lshlrev_b32 v24, 4, v24
    v_add_u32 v228, s57, v24
    v_xor_b32 v229, 64, v228
    v_and_b32 v26, 3, v1
    v_mul_u32_u24 v27, 40, v26
    v_lshlrev_b32 v26, 3, v26
    s_lshl_b32 s57, s59, 3
    s_mul_i32 s57, s57, s55
    v_add_u32 v26, s57, v26
    s_cmp_eq_u32 s53, 0
    s_cselect_b64 vcc, -1, 0
    v_cndmask_b32 v26, v26, v27, vcc
    v_lshrrev_b32 v24, 2, v1
    v_and_b32 v24, 3, v24
    v_lshl_add_u32 v24, v3, 3, v24
    v_and_b32 v25, 1, v3
    v_lshlrev_b32 v25, 2, v25
    v_add_u32 v27, v24, v25
    v_xor_b32 v25, 4, v25
    v_add_u32 v28, v24, v25
    v_mul_u32_u24 v27, s65, v27
    v_mul_u32_u24 v28, s65, v28
    v_add_u32 v230, v27, v26
    v_add_u32 v231, v28, v26
    v_add_u32 v232, 51200, v228
    v_add_u32 v233, 51200, v229
    v_add_u32 v234, 51200, v230
    v_add_u32 v235, 51200, v231
    v_add_u32 v236, 102400, v228
    v_add_u32 v237, 102400, v229
    v_add_u32 v238, 102400, v230
    v_add_u32 v239, 102400, v231
    v_mov_b32 v224, 0x3f803f80
    v_mov_b32 v225, 0x3f803f80
    v_mov_b32 v226, 0x3f803f80
    v_mov_b32 v227, 0x3f803f80
    v_lshlrev_b32 v24, 4, v0
    s_mul_i32 s57, s52, 3200
    v_add_u32 v25, s57, v24
    v_cmp_gt_u32 vcc, 3200, v24
    s_nop 1
    v_cndmask_b32 v16, v13, v25, vcc
    s_mov_b32 s61, 0
    s_mov_b32 s60, 0
    s_lshl_b32 s56, s63, 6
    s_lshl_b32 s73, s72, 10
    s_lshl_b32 s74, s48, 11
    s_add_u32 s74, s74, 34816
    s_sub_u32 s75, s64, s72
    s_waitcnt lgkmcnt(0)
    s_mov_b32 s24, s4
    s_mov_b32 s25, s5
    s_mov_b32 s26, 2621440
    s_mov_b32 s27, 0x00020000
    s_cmp_eq_u32 s53, 0
    s_cselect_b32 s28, s6, s14
    s_cselect_b32 s29, s7, s15
    s_mov_b32 s30, 2211840
    s_cselect_b32 s30, 2457600, s30
    s_mov_b32 s31, 0x00020000
    s_mul_i32 s57, s52, 15360
    s_add_u32 s57, s57, 15876096
    s_add_u32 s40, s22, s57
    s_addc_u32 s41, s23, 0
    s_mov_b32 s42, 15360
    s_mov_b32 s43, 0x00020000
    s_mov_b32 s32, s22
    s_mov_b32 s33, s23
    s_mov_b32 s34, 16285696
    s_mov_b32 s35, 0x00020000
    s_mov_b32 s44, s20
    s_mov_b32 s45, s21
    s_mov_b32 s46, 256
    s_mov_b32 s47, 0x00020000
    s_mov_b32 s36, s8
    s_mov_b32 s37, s9
    s_mov_b32 s38, 25600
    s_mov_b32 s39, 0x00020000
    s_or_b32 s57, s51, s53
    s_cmp_eq_u32 s57, 0
    s_cbranch_scc0 K1_NOZERO
    v_lshlrev_b32 v24, 4, v0
    v_mov_b32 v28, 0
    v_mov_b32 v29, 0
    v_mov_b32 v30, 0
    v_mov_b32 v31, 0
    s_mov_b32 s57, 0
    buffer_store_dwordx4 v[28:31], v24, s[40:43], s57 offen sc0 sc1
    s_mov_b32 s57, 8192
    buffer_store_dwordx4 v[28:31], v24, s[40:43], s57 offen sc0 sc1
    s_cmp_eq_u32 s52, 0
    s_cbranch_scc0 K1_NOZERO
    s_mov_b32 s57, 16277504
    buffer_store_dwordx4 v[28:31], v24, s[32:35], s57 offen sc0 sc1
K1_NOZERO:
    s_cmp_eq_u32 s68, 1
    s_cbranch_scc1 K1_T1
    s_cmp_eq_u32 s68, 2
    s_cbranch_scc1 K1_T2
    s_cmp_eq_u32 s68, 3
    s_cbranch_scc1 K1_T3
K1_T0:
    buffer_load_dwordx4 v[128:131], v14, s[24:27], 0 offen
    buffer_load_dwordx4 v[132:135], v14, s[24:27], 0 offen offset:16
    s_mov_b32 s57, 0
    buffer_load_dwordx2 v[136:137], v15, s[28:31], s57 offen
    s_add_u32 s57, s57, s63
    buffer_load_dwordx2 v[138:139], v15, s[28:31], s57 offen
    s_add_u32 s57, s57, s63
    buffer_load_dwordx2 v[140:141], v15, s[28:31], s57 offen
    s_add_u32 s57, s57, s63
    buffer_load_dwordx2 v[142:143], v15, s[28:31], s57 offen
    s_add_u32 s57, s57, s63
    buffer_load_dwordx2 v[144:145], v15, s[28:31], s57 offen
    s_add_u32 m0, s73, 0
    s_nop 0
    buffer_load_dwordx4 v4, s[28:31], s61 offen lds
    s_add_u32 m0, s73, 1024
    s_nop 0
    buffer_load_dwordx4 v5, s[28:31], s61 offen lds
    s_cmp_gt_i32 s75, 2
    s_cselect_b64 exec, -1, 1
    s_cselect_b32 s57, s73, 152576
    s_add_u32 m0, s57, 2048
    s_nop 0
    buffer_load_dwordx4 v6, s[28:31], s61 offen lds
    s_mov_b64 exec, -1
    s_cmp_gt_i32 s75, 3
    s_cselect_b64 exec, -1, 1
    s_cselect_b32 s57, s73, 151552
    s_add_u32 m0, s57, 3072
    s_nop 0
    buffer_load_dwordx4 v7, s[28:31], s61 offen lds
    s_mov_b64 exec, -1
    s_add_u32 s61, s61, s56
    s_add_u32 m0, s74, 0
    s_nop 0
    buffer_load_dwordx4 v9, s[24:27], s60 offen lds
    s_add_u32 m0, s74, 1024
    s_nop 0
    buffer_load_dwordx4 v10, s[24:27], s60 offen lds
    s_add_u32 s60, s60, 128
    s_barrier
    s_add_u32 m0, s73, 51200
    s_nop 0
    buffer_load_dwordx4 v4, s[28:31], s61 offen lds
    s_add_u32 m0, s73, 52224
    s_nop 0
    buffer_load_dwordx4 v5, s[28:31], s61 offen lds
    s_cmp_gt_i32 s75, 2
    s_cselect_b64 exec, -1, 1
    s_cselect_b32 s57, s73, 101376
    s_add_u32 m0, s57, 53248
    s_nop 0
    buffer_load_dwordx4 v6, s[28:31], s61 offen lds
    s_mov_b64 exec, -1
    s_cmp_gt_i32 s75, 3
    s_cselect_b64 exec, -1, 1
    s_cselect_b32 s57, s73, 100352
    s_add_u32 m0, s57, 54272
    s_nop 0
    buffer_load_dwordx4 v7, s[28:31], s61 offen lds
    s_mov_b64 exec, -1
    s_add_u32 s61, s61, s56
    s_add_u32 m0, s74, 51200
    s_nop 0
    buffer_load_dwordx4 v9, s[24:27], s60 offen lds
    s_add_u32 m0, s74, 52224
    s_nop 0
    buffer_load_dwordx4 v10, s[24:27], s60 offen lds
    s_add_u32 s60, s60, 128
    s_waitcnt vmcnt(12)
    v_lshlrev_b32 v148, 16, v136
    v_and_b32 v149, 0xffff0000, v136
    v_lshlrev_b32 v150, 16, v137
    v_and_b32 v151, 0xffff0000, v137
    v_lshlrev_b32 v152, 16, v138
    v_and_b32 v153, 0xffff0000, v138
    v_lshlrev_b32 v154, 16, v139
    v_and_b32 v155, 0xffff0000, v139
    v_lshlrev_b32 v156, 16, v140
    v_and_b32 v157, 0xffff0000, v140
    v_lshlrev_b32 v158, 16, v141
    v_and_b32 v159, 0xffff0000, v141
    v_lshlrev_b32 v160, 16, v142
    v_and_b32 v161, 0xffff0000, v142
    v_lshlrev_b32 v162, 16, v143
    v_and_b32 v163, 0xffff0000, v143
    v_lshlrev_b32 v164, 16, v144
    v_and_b32 v165, 0xffff0000, v144
    v_lshlrev_b32 v166, 16, v145
    v_and_b32 v167, 0xffff0000, v145
    v_pk_add_f32 v[148:149], v[148:149], v[152:153]
    v_pk_add_f32 v[150:151], v[150:151], v[154:155]
    v_pk_add_f32 v[148:149], v[148:149], v[156:157]
    v_pk_add_f32 v[150:151], v[150:151], v[158:159]
    v_pk_add_f32 v[148:149], v[148:149], v[160:161]
    v_pk_add_f32 v[150:151], v[150:151], v[162:163]
    v_pk_add_f32 v[148:149], v[148:149], v[164:165]
    v_pk_add_f32 v[150:151], v[150:151], v[166:167]
    v_lshlrev_b32 v24, 4, v0
    v_add_u32 v24, 155648, v24
    ds_write_b128 v24, v[148:151]
    v_lshlrev_b32 v168, 16, v128
    v_and_b32 v169, 0xffff0000, v128
    v_lshlrev_b32 v170, 16, v129
    v_and_b32 v171, 0xffff0000, v129
    v_lshlrev_b32 v172, 16, v130
    v_and_b32 v173, 0xffff0000, v130
    v_lshlrev_b32 v174, 16, v131
    v_and_b32 v175, 0xffff0000, v131
    v_lshlrev_b32 v176, 16, v132
    v_and_b32 v177, 0xffff0000, v132
    v_lshlrev_b32 v178, 16, v133
    v_and_b32 v179, 0xffff0000, v133
    v_lshlrev_b32 v180, 16, v134
    v_and_b32 v181, 0xffff0000, v134
    v_lshlrev_b32 v182, 16, v135
    v_and_b32 v183, 0xffff0000, v135
    v_pk_add_f32 v[184:185], v[168:169], v[170:171]
    v_pk_add_f32 v[184:185], v[184:185], v[172:173]
    v_pk_add_f32 v[184:185], v[184:185], v[174:175]
    v_pk_add_f32 v[184:185], v[184:185], v[176:177]
    v_pk_add_f32 v[184:185], v[184:185], v[178:179]
    v_pk_add_f32 v[184:185], v[184:185], v[180:181]
    v_pk_add_f32 v[184:185], v[184:185], v[182:183]
    v_add_f32 v184, v184, v185
    s_nop 1
    v_add_f32_dpp v184, v184, v184 row_shr:1 row_mask:0xf bank_mask:0xf bound_ctrl:0
    s_nop 1
    v_add_f32_dpp v184, v184, v184 row_shr:2 row_mask:0xf bank_mask:0xf bound_ctrl:0
    s_nop 1
    v_add_f32_dpp v184, v184, v184 row_shr:4 row_mask:0xf bank_mask:0xf bound_ctrl:0
    s_nop 1
    v_add_f32_dpp v184, v184, v184 row_shr:8 row_mask:0xf bank_mask:0xf bound_ctrl:0
    s_nop 1
    v_add_f32_dpp v184, v184, v184 row_bcast:15 row_mask:0xa bank_mask:0xf
    s_nop 1
    v_add_f32_dpp v184, v184, v184 row_bcast:31 row_mask:0xc bank_mask:0xf
    s_nop 0
    v_readlane_b32 s57, v184, 63
    v_mov_b32 v186, 0x3acccccd
    s_nop 0
    v_mul_f32 v186, s57, v186
    v_mov_b32 v184, 0
    v_mov_b32 v185, 0
    s_mov_b32 exec_hi, 0xff
    v_pk_add_f32 v[168:169], v[168:169], v[186:187] op_sel_hi:[1,0] neg_lo:[0,1] neg_hi:[0,1]
    v_pk_add_f32 v[170:171], v[170:171], v[186:187] op_sel_hi:[1,0] neg_lo:[0,1] neg_hi:[0,1]
    v_pk_add_f32 v[172:173], v[172:173], v[186:187] op_sel_hi:[1,0] neg_lo:[0,1] neg_hi:[0,1]
    v_pk_add_f32 v[174:175], v[174:175], v[186:187] op_sel_hi:[1,0] neg_lo:[0,1] neg_hi:[0,1]
    v_pk_add_f32 v[176:177], v[176:177], v[186:187] op_sel_hi:[1,0] neg_lo:[0,1] neg_hi:[0,1]
    v_pk_add_f32 v[178:179], v[178:179], v[186:187] op_sel_hi:[1,0] neg_lo:[0,1] neg_hi:[0,1]
    v_pk_add_f32 v[180:181], v[180:181], v[186:187] op_sel_hi:[1,0] neg_lo:[0,1] neg_hi:[0,1]
    v_pk_add_f32 v[182:183], v[182:183], v[186:187] op_sel_hi:[1,0] neg_lo:[0,1] neg_hi:[0,1]
    v_pk_fma_f32 v[184:185], v[168:169], v[168:169], v[184:185]
    v_pk_fma_f32 v[184:185], v[170:171], v[170:171], v[184:185]
    v_pk_fma_f32 v[184:185], v[172:173], v[172:173], v[184:185]
    v_pk_fma_f32 v[184:185], v[174:175], v[174:175], v[184:185]
    v_pk_fma_f32 v[184:185], v[176:177], v[176:177], v[184:185]
    v_pk_fma_f32 v[184:185], v[178:179], v[178:179], v[184:185]
    v_pk_fma_f32 v[184:185], v[180:181], v[180:181], v[184:185]
    v_pk_fma_f32 v[184:185], v[182:183], v[182:183], v[184:185]
    s_mov_b64 exec, -1
    v_add_f32 v184, v184, v185
    s_nop 1
    v_add_f32_dpp v184, v184, v184 row_shr:1 row_mask:0xf bank_mask:0xf bound_ctrl:0
    s_nop 1
    v_add_f32_dpp v184, v184, v184 row_shr:2 row_mask:0xf bank_mask:0xf bound_ctrl:0
    s_nop 1
    v_add_f32_dpp v184, v184, v184 row_shr:4 row_mask:0xf bank_mask:0xf bound_ctrl:0
    s_nop 1
    v_add_f32_dpp v184, v184, v184 row_shr:8 row_mask:0xf bank_mask:0xf bound_ctrl:0
    s_nop 1
    v_add_f32_dpp v184, v184, v184 row_bcast:15 row_mask:0xa bank_mask:0xf
    s_nop 1
    v_add_f32_dpp v184, v184, v184 row_bcast:31 row_mask:0xc bank_mask:0xf
    s_nop 0
    v_readlane_b32 s57, v184, 63
    v_mov_b32 v187, 0x3acccccd
    s_nop 0
    v_mul_f32 v187, s57, v187
    v_cvt_pk_bf16_f32 v186, v186, v186
    v_lshlrev_b32 v186, 16, v186
    v_cvt_pk_bf16_f32 v187, v187, v187
    v_lshlrev_b32 v187, 16, v187
    v_add_f32 v187, 0x3727c5ac, v187
    v_cvt_pk_bf16_f32 v187, v187, v187
    v_lshlrev_b32 v187, 16, v187
    v_sqrt_f32 v187, v187
    s_nop 0
    v_cvt_pk_bf16_f32 v187, v187, v187
    v_lshlrev_b32 v187, 16, v187
    v_rcp_f32 v187, v187
    s_lshl_b32 s57, s49, 3
    s_add_u32 s57, s57, 15998976
    v_mov_b32 v24, 0
    s_mov_b64 exec, 1
    buffer_store_dwordx2 v[186:187], v24, s[32:35], s57 offen sc0 sc1
    s_mov_b64 exec, -1
    buffer_load_dwordx4 v[252:255], v16, s[36:39], 0 offen
    s_waitcnt vmcnt(8) lgkmcnt(0)
    s_barrier
    s_cmp_eq_u32 s48, 7
    s_cbranch_scc0 K1_NCP0
    v_lshlrev_b32 v24, 4, v1
    v_add_u32 v25, 155648, v24
    ds_read_b128 v[168:171], v25 offset:0
    ds_read_b128 v[172:175], v25 offset:1024
    ds_read_b128 v[176:179], v25 offset:2048
    ds_read_b128 v[180:183], v25 offset:3072
    ds_read_b128 v[184:187], v25 offset:4096
    ds_read_b128 v[188:191], v25 offset:5120
    ds_read_b128 v[192:195], v25 offset:6144
    ds_read_b128 v[196:199], v25 offset:7168
    s_waitcnt lgkmcnt(0)
    v_pk_add_f32 v[168:169], v[168:169], v[172:173]
    v_pk_add_f32 v[170:171], v[170:171], v[174:175]
    v_pk_add_f32 v[168:169], v[168:169], v[176:177]
    v_pk_add_f32 v[170:171], v[170:171], v[178:179]
    v_pk_add_f32 v[168:169], v[168:169], v[180:181]
    v_pk_add_f32 v[170:171], v[170:171], v[182:183]
    v_pk_add_f32 v[168:169], v[168:169], v[184:185]
    v_pk_add_f32 v[170:171], v[170:171], v[186:187]
    v_pk_add_f32 v[168:169], v[168:169], v[188:189]
    v_pk_add_f32 v[170:171], v[170:171], v[190:191]
    v_pk_add_f32 v[168:169], v[168:169], v[192:193]
    v_pk_add_f32 v[170:171], v[170:171], v[194:195]
    v_pk_add_f32 v[168:169], v[168:169], v[196:197]
    v_pk_add_f32 v[170:171], v[170:171], v[198:199]
    s_lshl_b32 s57, s71, 4
    s_add_u32 s57, s57, s51
    s_lshl_b32 s57, s57, 10
    s_add_u32 s57, s57, 16015360
    buffer_store_dwordx4 v[168:171], v24, s[32:35], s57 offen sc0 sc1
    s_nop 1
K1_NCP0:
    s_or_b32 s57, s51, s48
    s_cmp_eq_u32 s57, 0
    s_cbranch_scc0 K1_NOFLAG
    s_lshl_b32 s57, s52, 2
    v_mov_b32 v24, s57
    v_mov_b32 v25, 1
    s_mov_b64 exec, 1
    buffer_atomic_add v25, v24, s[44:47], 0 offen
    s_mov_b64 exec, -1
K1_NOFLAG:
    ds_read_b128 v[128:131], v228
    ds_read_b128 v[132:135], v228 offset:2048
    ds_read_b64_tr_b16 v[136:137], v230 offset:160
    ds_read_b64_tr_b16 v[138:139], v231 offset:160
    ds_read_b64_tr_b16 v[140:141], v230 offset:168
    ds_read_b64_tr_b16 v[142:143], v231 offset:168
    ds_read_b64_tr_b16 v[144:145], v230 offset:176
    ds_read_b64_tr_b16 v[146:147], v231 offset:176
    ds_read_b64_tr_b16 v[148:149], v230 offset:184
    ds_read_b64_tr_b16 v[150:151], v231 offset:184
    ds_read_b64_tr_b16 v[152:153], v230 offset:192
    ds_read_b64_tr_b16 v[154:155], v231 offset:192
    ds_read_b64_tr_b16 v[156:157], v230 offset:320
    ds_read_b64_tr_b16 v[158:159], v231 offset:320
    ds_read_b64_tr_b16 v[160:161], v230 offset:328
    ds_read_b64_tr_b16 v[162:163], v231 offset:328
    ds_read_b64_tr_b16 v[164:165], v230 offset:336
    ds_read_b64_tr_b16 v[166:167], v231 offset:336
    s_waitcnt lgkmcnt(0)
    v_mfma_f32_16x16x32_bf16 v[64:67], v[136:139], v[128:131], 0
    ds_read_b128 v[168:171], v229
    ds_read_b128 v[172:175], v229 offset:2048
    v_mfma_f32_16x16x32_bf16 v[68:71], v[136:139], v[132:135], 0
    s_add_u32 m0, s73, 102400
    s_nop 0
    buffer_load_dwordx4 v4, s[28:31], s61 offen lds
    ds_read_b64_tr_b16 v[176:177], v230 offset:15520
    v_mfma_f32_16x16x32_bf16 v[72:75], v[140:143], v[128:131], 0
    ds_read_b64_tr_b16 v[178:179], v231 offset:15520
    s_add_u32 m0, s73, 103424
    s_nop 0
    buffer_load_dwordx4 v5, s[28:31], s61 offen lds
    v_mfma_f32_16x16x32_bf16 v[76:79], v[140:143], v[132:135], 0
    ds_read_b64_tr_b16 v[180:181], v230 offset:15528
    ds_read_b64_tr_b16 v[182:183], v231 offset:15528
    v_mfma_f32_16x16x32_bf16 v[80:83], v[144:147], v[128:131], 0
    s_cmp_gt_i32 s75, 2
    s_cselect_b64 exec, -1, 1
    s_cselect_b32 s57, s73, 50176
    s_add_u32 m0, s57, 104448
    s_nop 0
    buffer_load_dwordx4 v6, s[28:31], s61 offen lds
    s_mov_b64 exec, -1
    ds_read_b64_tr_b16 v[184:185], v230 offset:15536
    v_mfma_f32_16x16x32_bf16 v[84:87], v[144:147], v[132:135], 0
    ds_read_b64_tr_b16 v[186:187], v231 offset:15536
    s_cmp_gt_i32 s75, 3
    s_cselect_b64 exec, -1, 1
    s_cselect_b32 s57, s73, 49152
    s_add_u32 m0, s57, 105472
    s_nop 0
    buffer_load_dwordx4 v7, s[28:31], s61 offen lds
    s_mov_b64 exec, -1
    s_add_u32 s61, s61, s56
    v_mfma_f32_16x16x32_bf16 v[88:91], v[148:151], v[128:131], 0
    ds_read_b64_tr_b16 v[188:189], v230 offset:15544
    ds_read_b64_tr_b16 v[190:191], v231 offset:15544
    v_mfma_f32_16x16x32_bf16 v[92:95], v[148:151], v[132:135], 0
    s_add_u32 m0, s74, 102400
    s_nop 0
    buffer_load_dwordx4 v9, s[24:27], s60 offen lds
    ds_read_b64_tr_b16 v[192:193], v230 offset:15552
    v_mfma_f32_16x16x32_bf16 v[96:99], v[152:155], v[128:131], 0
    ds_read_b64_tr_b16 v[194:195], v231 offset:15552
    s_add_u32 m0, s74, 103424
    s_nop 0
    buffer_load_dwordx4 v10, s[24:27], s60 offen lds
    s_add_u32 s60, s60, 128
    v_mfma_f32_16x16x32_bf16 v[100:103], v[152:155], v[132:135], 0
    ds_read_b64_tr_b16 v[196:197], v230 offset:15680
    ds_read_b64_tr_b16 v[198:199], v231 offset:15680
    v_mfma_f32_16x16x32_bf16 v[104:107], v[156:159], v[128:131], 0
    ds_read_b64_tr_b16 v[200:201], v230 offset:15688
    ds_read_b64_tr_b16 v[202:203], v231 offset:15688
    v_mfma_f32_16x16x32_bf16 v[108:111], v[156:159], v[132:135], 0
    ds_read_b64_tr_b16 v[204:205], v230 offset:15696
    ds_read_b64_tr_b16 v[206:207], v231 offset:15696
    v_mfma_f32_16x16x32_bf16 v[112:115], v[160:163], v[128:131], 0
    v_mfma_f32_16x16x32_bf16 v[116:119], v[160:163], v[132:135], 0
    v_mfma_f32_16x16x32_bf16 v[120:123], v[164:167], v[128:131], 0
    v_mfma_f32_16x16x32_bf16 v[124:127], v[164:167], v[132:135], 0
    s_waitcnt vmcnt(8) lgkmcnt(0)
    s_barrier
    v_mfma_f32_16x16x32_bf16 v[64:67], v[176:179], v[168:171], v[64:67]
    ds_read_b128 v[128:131], v232
    ds_read_b128 v[132:135], v232 offset:2048
    v_mfma_f32_16x16x32_bf16 v[68:71], v[176:179], v[172:175], v[68:71]
    s_add_u32 m0, s73, 0
    s_nop 0
    buffer_load_dwordx4 v4, s[28:31], s61 offen lds
    ds_read_b64_tr_b16 v[136:137], v234 offset:160
    v_mfma_f32_16x16x32_bf16 v[72:75], v[180:183], v[168:171], v[72:75]
    ds_read_b64_tr_b16 v[138:139], v235 offset:160
    s_add_u32 m0, s73, 1024
    s_nop 0
    buffer_load_dwordx4 v5, s[28:31], s61 offen lds
    v_mfma_f32_16x16x32_bf16 v[76:79], v[180:183], v[172:175], v[76:79]
    ds_read_b64_tr_b16 v[140:141], v234 offset:168
    ds_read_b64_tr_b16 v[142:143], v235 offset:168
    v_mfma_f32_16x16x32_bf16 v[80:83], v[184:187], v[168:171], v[80:83]
    s_cmp_gt_i32 s75, 2
    s_cselect_b64 exec, -1, 1
    s_cselect_b32 s57, s73, 152576
    s_add_u32 m0, s57, 2048
    s_nop 0
    buffer_load_dwordx4 v6, s[28:31], s61 offen lds
    s_mov_b64 exec, -1
    ds_read_b64_tr_b16 v[144:145], v234 offset:176
    v_mfma_f32_16x16x32_bf16 v[84:87], v[184:187], v[172:175], v[84:87]
    ds_read_b64_tr_b16 v[146:147], v235 offset:176
    s_cmp_gt_i32 s75, 3
    s_cselect_b64 exec, -1, 1
    s_cselect_b32 s57, s73, 151552
    s_add_u32 m0, s57, 3072
    s_nop 0
    buffer_load_dwordx4 v7, s[28:31], s61 offen lds
    s_mov_b64 exec, -1
    s_add_u32 s61, s61, s56
    v_mfma_f32_16x16x32_bf16 v[88:91], v[188:191], v[168:171], v[88:91]
    ds_read_b64_tr_b16 v[148:149], v234 offset:184
    ds_read_b64_tr_b16 v[150:151], v235 offset:184
    v_mfma_f32_16x16x32_bf16 v[92:95], v[188:191], v[172:175], v[92:95]
    s_add_u32 m0, s74, 0
    s_nop 0
    buffer_load_dwordx4 v9, s[24:27], s60 offen lds
    ds_read_b64_tr_b16 v[152:153], v234 offset:192
    v_mfma_f32_16x16x32_bf16 v[96:99], v[192:195], v[168:171], v[96:99]
    ds_read_b64_tr_b16 v[154:155], v235 offset:192
    s_add_u32 m0, s74, 1024
    s_nop 0
    buffer_load_dwordx4 v10, s[24:27], s60 offen lds
    s_add_u32 s60, s60, 128
    v_mfma_f32_16x16x32_bf16 v[100:103], v[192:195], v[172:175], v[100:103]
    ds_read_b64_tr_b16 v[156:157], v234 offset:320
    ds_read_b64_tr_b16 v[158:159], v235 offset:320
    v_mfma_f32_16x16x32_bf16 v[104:107], v[196:199], v[168:171], v[104:107]
    ds_read_b64_tr_b16 v[160:161], v234 offset:328
    ds_read_b64_tr_b16 v[162:163], v235 offset:328
    v_mfma_f32_16x16x32_bf16 v[108:111], v[196:199], v[172:175], v[108:111]
    ds_read_b64_tr_b16 v[164:165], v234 offset:336
    ds_read_b64_tr_b16 v[166:167], v235 offset:336
    v_mfma_f32_16x16x32_bf16 v[112:115], v[200:203], v[168:171], v[112:115]
    v_mfma_f32_16x16x32_bf16 v[116:119], v[200:203], v[172:175], v[116:119]
    v_mfma_f32_16x16x32_bf16 v[120:123], v[204:207], v[168:171], v[120:123]
    v_mfma_f32_16x16x32_bf16 v[124:127], v[204:207], v[172:175], v[124:127]
    s_waitcnt lgkmcnt(0)
    v_mfma_f32_16x16x32_bf16 v[64:67], v[136:139], v[128:131], v[64:67]
    ds_read_b128 v[168:171], v233
    ds_read_b128 v[172:175], v233 offset:2048
    v_mfma_f32_16x16x32_bf16 v[68:71], v[136:139], v[132:135], v[68:71]
    ds_read_b64_tr_b16 v[176:177], v234 offset:15520
    ds_read_b64_tr_b16 v[178:179], v235 offset:15520
    v_mfma_f32_16x16x32_bf16 v[72:75], v[140:143], v[128:131], v[72:75]
    ds_read_b64_tr_b16 v[180:181], v234 offset:15528
    ds_read_b64_tr_b16 v[182:183], v235 offset:15528
    v_mfma_f32_16x16x32_bf16 v[76:79], v[140:143], v[132:135], v[76:79]
    ds_read_b64_tr_b16 v[184:185], v234 offset:15536
    ds_read_b64_tr_b16 v[186:187], v235 offset:15536
    v_mfma_f32_16x16x32_bf16 v[80:83], v[144:147], v[128:131], v[80:83]
    ds_read_b64_tr_b16 v[188:189], v234 offset:15544
    ds_read_b64_tr_b16 v[190:191], v235 offset:15544
    v_mfma_f32_16x16x32_bf16 v[84:87], v[144:147], v[132:135], v[84:87]
    ds_read_b64_tr_b16 v[192:193], v234 offset:15552
    ds_read_b64_tr_b16 v[194:195], v235 offset:15552
    v_mfma_f32_16x16x32_bf16 v[88:91], v[148:151], v[128:131], v[88:91]
    ds_read_b64_tr_b16 v[196:197], v234 offset:15680
    ds_read_b64_tr_b16 v[198:199], v235 offset:15680
    v_mfma_f32_16x16x32_bf16 v[92:95], v[148:151], v[132:135], v[92:95]
    ds_read_b64_tr_b16 v[200:201], v234 offset:15688
    ds_read_b64_tr_b16 v[202:203], v235 offset:15688
    v_mfma_f32_16x16x32_bf16 v[96:99], v[152:155], v[128:131], v[96:99]
    ds_read_b64_tr_b16 v[204:205], v234 offset:15696
    ds_read_b64_tr_b16 v[206:207], v235 offset:15696
    v_mfma_f32_16x16x32_bf16 v[100:103], v[152:155], v[132:135], v[100:103]
    v_mfma_f32_16x16x32_bf16 v[104:107], v[156:159], v[128:131], v[104:107]
    v_mfma_f32_16x16x32_bf16 v[108:111], v[156:159], v[132:135], v[108:111]
    v_mfma_f32_16x16x32_bf16 v[112:115], v[160:163], v[128:131], v[112:115]
    v_mfma_f32_16x16x32_bf16 v[116:119], v[160:163], v[132:135], v[116:119]
    v_mfma_f32_16x16x32_bf16 v[120:123], v[164:167], v[128:131], v[120:123]
    v_mfma_f32_16x16x32_bf16 v[124:127], v[164:167], v[132:135], v[124:127]
    s_waitcnt vmcnt(6) lgkmcnt(0)
    s_barrier
    v_mfma_f32_16x16x32_bf16 v[64:67], v[176:179], v[168:171], v[64:67]
    ds_read_b128 v[128:131], v236
    ds_read_b128 v[132:135], v236 offset:2048
    v_mfma_f32_16x16x32_bf16 v[68:71], v[176:179], v[172:175], v[68:71]
    s_add_u32 m0, s73, 51200
    s_nop 0
    buffer_load_dwordx4 v4, s[28:31], s61 offen lds
    ds_read_b64_tr_b16 v[136:137], v238 offset:160
    v_mfma_f32_16x16x32_bf16 v[72:75], v[180:183], v[168:171], v[72:75]
    ds_read_b64_tr_b16 v[138:139], v239 offset:160
    s_add_u32 m0, s73, 52224
    s_nop 0
    buffer_load_dwordx4 v5, s[28:31], s61 offen lds
    v_mfma_f32_16x16x32_bf16 v[76:79], v[180:183], v[172:175], v[76:79]
    ds_read_b64_tr_b16 v[140:141], v238 offset:168
    ds_read_b64_tr_b16 v[142:143], v239 offset:168
    v_mfma_f32_16x16x32_bf16 v[80:83], v[184:187], v[168:171], v[80:83]
    s_cmp_gt_i32 s75, 2
    s_cselect_b64 exec, -1, 1
    s_cselect_b32 s57, s73, 101376
    s_add_u32 m0, s57, 53248
    s_nop 0
    buffer_load_dwordx4 v6, s[28:31], s61 offen lds
    s_mov_b64 exec, -1
    ds_read_b64_tr_b16 v[144:145], v238 offset:176
    v_mfma_f32_16x16x32_bf16 v[84:87], v[184:187], v[172:175], v[84:87]
    ds_read_b64_tr_b16 v[146:147], v239 offset:176
    s_cmp_gt_i32 s75, 3
    s_cselect_b64 exec, -1, 1
    s_cselect_b32 s57, s73, 100352
    s_add_u32 m0, s57, 54272
    s_nop 0
    buffer_load_dwordx4 v7, s[28:31], s61 offen lds
    s_mov_b64 exec, -1
    s_add_u32 s61, s61, s56
    v_mfma_f32_16x16x32_bf16 v[88:91], v[188:191], v[168:171], v[88:91]
    ds_read_b64_tr_b16 v[148:149], v238 offset:184
    ds_read_b64_tr_b16 v[150:151], v239 offset:184
    v_mfma_f32_16x16x32_bf16 v[92:95], v[188:191], v[172:175], v[92:95]
    s_add_u32 m0, s74, 51200
    s_nop 0
    buffer_load_dwordx4 v9, s[24:27], s60 offen lds
    ds_read_b64_tr_b16 v[152:153], v238 offset:192
    v_mfma_f32_16x16x32_bf16 v[96:99], v[192:195], v[168:171], v[96:99]
    ds_read_b64_tr_b16 v[154:155], v239 offset:192
    s_add_u32 m0, s74, 52224
    s_nop 0
    buffer_load_dwordx4 v10, s[24:27], s60 offen lds
    s_add_u32 s60, s60, 128
    v_mfma_f32_16x16x32_bf16 v[100:103], v[192:195], v[172:175], v[100:103]
    ds_read_b64_tr_b16 v[156:157], v238 offset:320
    ds_read_b64_tr_b16 v[158:159], v239 offset:320
    v_mfma_f32_16x16x32_bf16 v[104:107], v[196:199], v[168:171], v[104:107]
    ds_read_b64_tr_b16 v[160:161], v238 offset:328
    ds_read_b64_tr_b16 v[162:163], v239 offset:328
    v_mfma_f32_16x16x32_bf16 v[108:111], v[196:199], v[172:175], v[108:111]
    ds_read_b64_tr_b16 v[164:165], v238 offset:336
    ds_read_b64_tr_b16 v[166:167], v239 offset:336
    v_mfma_f32_16x16x32_bf16 v[112:115], v[200:203], v[168:171], v[112:115]
    v_mfma_f32_16x16x32_bf16 v[116:119], v[200:203], v[172:175], v[116:119]
    v_mfma_f32_16x16x32_bf16 v[120:123], v[204:207], v[168:171], v[120:123]
    v_mfma_f32_16x16x32_bf16 v[124:127], v[204:207], v[172:175], v[124:127]
    s_waitcnt lgkmcnt(0)
    v_mfma_f32_16x16x32_bf16 v[64:67], v[136:139], v[128:131], v[64:67]
    ds_read_b128 v[168:171], v237
    ds_read_b128 v[172:175], v237 offset:2048
    v_mfma_f32_16x16x32_bf16 v[68:71], v[136:139], v[132:135], v[68:71]
    ds_read_b64_tr_b16 v[176:177], v238 offset:15520
    ds_read_b64_tr_b16 v[178:179], v239 offset:15520
    v_mfma_f32_16x16x32_bf16 v[72:75], v[140:143], v[128:131], v[72:75]
    ds_read_b64_tr_b16 v[180:181], v238 offset:15528
    ds_read_b64_tr_b16 v[182:183], v239 offset:15528
    v_mfma_f32_16x16x32_bf16 v[76:79], v[140:143], v[132:135], v[76:79]
    ds_read_b64_tr_b16 v[184:185], v238 offset:15536
    ds_read_b64_tr_b16 v[186:187], v239 offset:15536
    v_mfma_f32_16x16x32_bf16 v[80:83], v[144:147], v[128:131], v[80:83]
    ds_read_b64_tr_b16 v[188:189], v238 offset:15544
    ds_read_b64_tr_b16 v[190:191], v239 offset:15544
    v_mfma_f32_16x16x32_bf16 v[84:87], v[144:147], v[132:135], v[84:87]
    ds_read_b64_tr_b16 v[192:193], v238 offset:15552
    ds_read_b64_tr_b16 v[194:195], v239 offset:15552
    v_mfma_f32_16x16x32_bf16 v[88:91], v[148:151], v[128:131], v[88:91]
    ds_read_b64_tr_b16 v[196:197], v238 offset:15680
    ds_read_b64_tr_b16 v[198:199], v239 offset:15680
    v_mfma_f32_16x16x32_bf16 v[92:95], v[148:151], v[132:135], v[92:95]
    ds_read_b64_tr_b16 v[200:201], v238 offset:15688
    ds_read_b64_tr_b16 v[202:203], v239 offset:15688
    v_mfma_f32_16x16x32_bf16 v[96:99], v[152:155], v[128:131], v[96:99]
    ds_read_b64_tr_b16 v[204:205], v238 offset:15696
    ds_read_b64_tr_b16 v[206:207], v239 offset:15696
    v_mfma_f32_16x16x32_bf16 v[100:103], v[152:155], v[132:135], v[100:103]
    v_mfma_f32_16x16x32_bf16 v[104:107], v[156:159], v[128:131], v[104:107]
    v_mfma_f32_16x16x32_bf16 v[108:111], v[156:159], v[132:135], v[108:111]
    v_mfma_f32_16x16x32_bf16 v[112:115], v[160:163], v[128:131], v[112:115]
    v_mfma_f32_16x16x32_bf16 v[116:119], v[160:163], v[132:135], v[116:119]
    v_mfma_f32_16x16x32_bf16 v[120:123], v[164:167], v[128:131], v[120:123]
    v_mfma_f32_16x16x32_bf16 v[124:127], v[164:167], v[132:135], v[124:127]
    s_waitcnt vmcnt(6) lgkmcnt(0)
    s_barrier
    v_mfma_f32_16x16x32_bf16 v[64:67], v[176:179], v[168:171], v[64:67]
    ds_read_b128 v[128:131], v228
    ds_read_b128 v[132:135], v228 offset:2048
    v_mfma_f32_16x16x32_bf16 v[68:71], v[176:179], v[172:175], v[68:71]
    s_add_u32 m0, s73, 102400
    s_nop 0
    buffer_load_dwordx4 v4, s[28:31], s61 offen lds
    ds_read_b64_tr_b16 v[136:137], v230 offset:160
    v_mfma_f32_16x16x32_bf16 v[72:75], v[180:183], v[168:171], v[72:75]
    ds_read_b64_tr_b16 v[138:139], v231 offset:160
    s_add_u32 m0, s73, 103424
    s_nop 0
    buffer_load_dwordx4 v5, s[28:31], s61 offen lds
    v_mfma_f32_16x16x32_bf16 v[76:79], v[180:183], v[172:175], v[76:79]
    ds_read_b64_tr_b16 v[140:141], v230 offset:168
    ds_read_b64_tr_b16 v[142:143], v231 offset:168
    v_mfma_f32_16x16x32_bf16 v[80:83], v[184:187], v[168:171], v[80:83]
    s_cmp_gt_i32 s75, 2
    s_cselect_b64 exec, -1, 1
    s_cselect_b32 s57, s73, 50176
    s_add_u32 m0, s57, 104448
    s_nop 0
    buffer_load_dwordx4 v6, s[28:31], s61 offen lds
    s_mov_b64 exec, -1
    ds_read_b64_tr_b16 v[144:145], v230 offset:176
    v_mfma_f32_16x16x32_bf16 v[84:87], v[184:187], v[172:175], v[84:87]
    ds_read_b64_tr_b16 v[146:147], v231 offset:176
    s_cmp_gt_i32 s75, 3
    s_cselect_b64 exec, -1, 1
    s_cselect_b32 s57, s73, 49152
    s_add_u32 m0, s57, 105472
    s_nop 0
    buffer_load_dwordx4 v7, s[28:31], s61 offen lds
    s_mov_b64 exec, -1
    s_add_u32 s61, s61, s56
    v_mfma_f32_16x16x32_bf16 v[88:91], v[188:191], v[168:171], v[88:91]
    ds_read_b64_tr_b16 v[148:149], v230 offset:184
    ds_read_b64_tr_b16 v[150:151], v231 offset:184
    v_mfma_f32_16x16x32_bf16 v[92:95], v[188:191], v[172:175], v[92:95]
    s_add_u32 m0, s74, 102400
    s_nop 0
    buffer_load_dwordx4 v9, s[24:27], s60 offen lds
    ds_read_b64_tr_b16 v[152:153], v230 offset:192
    v_mfma_f32_16x16x32_bf16 v[96:99], v[192:195], v[168:171], v[96:99]
    ds_read_b64_tr_b16 v[154:155], v231 offset:192
    s_add_u32 m0, s74, 103424
    s_nop 0
    buffer_load_dwordx4 v10, s[24:27], s60 offen lds
    s_add_u32 s60, s60, 128
    v_mfma_f32_16x16x32_bf16 v[100:103], v[192:195], v[172:175], v[100:103]
    ds_read_b64_tr_b16 v[156:157], v230 offset:320
    ds_read_b64_tr_b16 v[158:159], v231 offset:320
    v_mfma_f32_16x16x32_bf16 v[104:107], v[196:199], v[168:171], v[104:107]
    ds_read_b64_tr_b16 v[160:161], v230 offset:328
    ds_read_b64_tr_b16 v[162:163], v231 offset:328
    v_mfma_f32_16x16x32_bf16 v[108:111], v[196:199], v[172:175], v[108:111]
    ds_read_b64_tr_b16 v[164:165], v230 offset:336
    ds_read_b64_tr_b16 v[166:167], v231 offset:336
    v_mfma_f32_16x16x32_bf16 v[112:115], v[200:203], v[168:171], v[112:115]
    s_cmp_eq_u32 s48, 0
    s_cbranch_scc0 K1_NSG0
    s_lshl_b32 s57, s51, 2
    s_add_u32 s57, s57, 64
    v_mov_b32 v24, s57
    s_lshl_b32 s57, s71, 2
    s_add_u32 s57, s57, 128
    v_mov_b32 v26, s57
    v_mov_b32 v25, 1
    s_mov_b64 exec, 1
    buffer_atomic_add v25, v24, s[44:47], 0 offen
    buffer_atomic_add v25, v26, s[44:47], 0 offen
    s_mov_b64 exec, -1
K1_NSG0:
    v_mfma_f32_16x16x32_bf16 v[116:119], v[200:203], v[172:175], v[116:119]
    v_mfma_f32_16x16x32_bf16 v[120:123], v[204:207], v[168:171], v[120:123]
    v_mfma_f32_16x16x32_bf16 v[124:127], v[204:207], v[172:175], v[124:127]
    s_waitcnt lgkmcnt(0)
    v_mfma_f32_16x16x32_bf16 v[64:67], v[136:139], v[128:131], v[64:67]
    ds_read_b128 v[168:171], v229
    ds_read_b128 v[172:175], v229 offset:2048
    v_mfma_f32_16x16x32_bf16 v[68:71], v[136:139], v[132:135], v[68:71]
    ds_read_b64_tr_b16 v[176:177], v230 offset:15520
    ds_read_b64_tr_b16 v[178:179], v231 offset:15520
    v_mfma_f32_16x16x32_bf16 v[72:75], v[140:143], v[128:131], v[72:75]
    ds_read_b64_tr_b16 v[180:181], v230 offset:15528
    ds_read_b64_tr_b16 v[182:183], v231 offset:15528
    v_mfma_f32_16x16x32_bf16 v[76:79], v[140:143], v[132:135], v[76:79]
    ds_read_b64_tr_b16 v[184:185], v230 offset:15536
    ds_read_b64_tr_b16 v[186:187], v231 offset:15536
    v_mfma_f32_16x16x32_bf16 v[80:83], v[144:147], v[128:131], v[80:83]
    ds_read_b64_tr_b16 v[188:189], v230 offset:15544
    ds_read_b64_tr_b16 v[190:191], v231 offset:15544
    v_mfma_f32_16x16x32_bf16 v[84:87], v[144:147], v[132:135], v[84:87]
    ds_read_b64_tr_b16 v[192:193], v230 offset:15552
    ds_read_b64_tr_b16 v[194:195], v231 offset:15552
    v_mfma_f32_16x16x32_bf16 v[88:91], v[148:151], v[128:131], v[88:91]
    ds_read_b64_tr_b16 v[196:197], v230 offset:15680
    ds_read_b64_tr_b16 v[198:199], v231 offset:15680
    v_mfma_f32_16x16x32_bf16 v[92:95], v[148:151], v[132:135], v[92:95]
    ds_read_b64_tr_b16 v[200:201], v230 offset:15688
    ds_read_b64_tr_b16 v[202:203], v231 offset:15688
    v_mfma_f32_16x16x32_bf16 v[96:99], v[152:155], v[128:131], v[96:99]
    ds_read_b64_tr_b16 v[204:205], v230 offset:15696
    ds_read_b64_tr_b16 v[206:207], v231 offset:15696
    v_mfma_f32_16x16x32_bf16 v[100:103], v[152:155], v[132:135], v[100:103]
    v_mfma_f32_16x16x32_bf16 v[104:107], v[156:159], v[128:131], v[104:107]
    v_mfma_f32_16x16x32_bf16 v[108:111], v[156:159], v[132:135], v[108:111]
    v_mfma_f32_16x16x32_bf16 v[112:115], v[160:163], v[128:131], v[112:115]
    v_mfma_f32_16x16x32_bf16 v[116:119], v[160:163], v[132:135], v[116:119]
    v_mfma_f32_16x16x32_bf16 v[120:123], v[164:167], v[128:131], v[120:123]
    v_mfma_f32_16x16x32_bf16 v[124:127], v[164:167], v[132:135], v[124:127]
    s_waitcnt vmcnt(6) lgkmcnt(0)
    s_barrier
    v_mfma_f32_16x16x32_bf16 v[64:67], v[176:179], v[168:171], v[64:67]
    ds_read_b128 v[128:131], v232
    ds_read_b128 v[132:135], v232 offset:2048
    v_mfma_f32_16x16x32_bf16 v[68:71], v[176:179], v[172:175], v[68:71]
    s_add_u32 m0, s73, 0
    s_nop 0
    buffer_load_dwordx4 v4, s[28:31], s61 offen lds
    ds_read_b64_tr_b16 v[136:137], v234 offset:160
    v_mfma_f32_16x16x32_bf16 v[72:75], v[180:183], v[168:171], v[72:75]
    ds_read_b64_tr_b16 v[138:139], v235 offset:160
    s_add_u32 m0, s73, 1024
    s_nop 0
    buffer_load_dwordx4 v5, s[28:31], s61 offen lds
    v_mfma_f32_16x16x32_bf16 v[76:79], v[180:183], v[172:175], v[76:79]
    ds_read_b64_tr_b16 v[140:141], v234 offset:168
    ds_read_b64_tr_b16 v[142:143], v235 offset:168
    v_mfma_f32_16x16x32_bf16 v[80:83], v[184:187], v[168:171], v[80:83]
    s_cmp_gt_i32 s75, 2
    s_cselect_b64 exec, -1, 1
    s_cselect_b32 s57, s73, 152576
    s_add_u32 m0, s57, 2048
    s_nop 0
    buffer_load_dwordx4 v6, s[28:31], s61 offen lds
    s_mov_b64 exec, -1
    ds_read_b64_tr_b16 v[144:145], v234 offset:176
    v_mfma_f32_16x16x32_bf16 v[84:87], v[184:187], v[172:175], v[84:87]
    ds_read_b64_tr_b16 v[146:147], v235 offset:176
    s_cmp_gt_i32 s75, 3
    s_cselect_b64 exec, -1, 1
    s_cselect_b32 s57, s73, 151552
    s_add_u32 m0, s57, 3072
    s_nop 0
    buffer_load_dwordx4 v7, s[28:31], s61 offen lds
    s_mov_b64 exec, -1
    s_add_u32 s61, s61, s56
    v_mfma_f32_16x16x32_bf16 v[88:91], v[188:191], v[168:171], v[88:91]
    ds_read_b64_tr_b16 v[148:149], v234 offset:184
    ds_read_b64_tr_b16 v[150:151], v235 offset:184
    v_mfma_f32_16x16x32_bf16 v[92:95], v[188:191], v[172:175], v[92:95]
    s_add_u32 m0, s74, 0
    s_nop 0
    buffer_load_dwordx4 v9, s[24:27], s60 offen lds
    ds_read_b64_tr_b16 v[152:153], v234 offset:192
    v_mfma_f32_16x16x32_bf16 v[96:99], v[192:195], v[168:171], v[96:99]
    ds_read_b64_tr_b16 v[154:155], v235 offset:192
    s_add_u32 m0, s74, 1024
    s_nop 0
    buffer_load_dwordx4 v10, s[24:27], s60 offen lds
    s_add_u32 s60, s60, 128
    v_mfma_f32_16x16x32_bf16 v[100:103], v[192:195], v[172:175], v[100:103]
    ds_read_b64_tr_b16 v[156:157], v234 offset:320
    ds_read_b64_tr_b16 v[158:159], v235 offset:320
    v_mfma_f32_16x16x32_bf16 v[104:107], v[196:199], v[168:171], v[104:107]
    ds_read_b64_tr_b16 v[160:161], v234 offset:328
    ds_read_b64_tr_b16 v[162:163], v235 offset:328
    v_mfma_f32_16x16x32_bf16 v[108:111], v[196:199], v[172:175], v[108:111]
    ds_read_b64_tr_b16 v[164:165], v234 offset:336
    ds_read_b64_tr_b16 v[166:167], v235 offset:336
    v_mfma_f32_16x16x32_bf16 v[112:115], v[200:203], v[168:171], v[112:115]
    v_mfma_f32_16x16x32_bf16 v[116:119], v[200:203], v[172:175], v[116:119]
    v_mfma_f32_16x16x32_bf16 v[120:123], v[204:207], v[168:171], v[120:123]
    v_mfma_f32_16x16x32_bf16 v[124:127], v[204:207], v[172:175], v[124:127]
    s_waitcnt lgkmcnt(0)
    v_mfma_f32_16x16x32_bf16 v[64:67], v[136:139], v[128:131], v[64:67]
    ds_read_b128 v[168:171], v233
    ds_read_b128 v[172:175], v233 offset:2048
    v_mfma_f32_16x16x32_bf16 v[68:71], v[136:139], v[132:135], v[68:71]
    ds_read_b64_tr_b16 v[176:177], v234 offset:15520
    ds_read_b64_tr_b16 v[178:179], v235 offset:15520
    v_mfma_f32_16x16x32_bf16 v[72:75], v[140:143], v[128:131], v[72:75]
    ds_read_b64_tr_b16 v[180:181], v234 offset:15528
    ds_read_b64_tr_b16 v[182:183], v235 offset:15528
    v_mfma_f32_16x16x32_bf16 v[76:79], v[140:143], v[132:135], v[76:79]
    ds_read_b64_tr_b16 v[184:185], v234 offset:15536
    ds_read_b64_tr_b16 v[186:187], v235 offset:15536
    v_mfma_f32_16x16x32_bf16 v[80:83], v[144:147], v[128:131], v[80:83]
    ds_read_b64_tr_b16 v[188:189], v234 offset:15544
    ds_read_b64_tr_b16 v[190:191], v235 offset:15544
    v_mfma_f32_16x16x32_bf16 v[84:87], v[144:147], v[132:135], v[84:87]
    ds_read_b64_tr_b16 v[192:193], v234 offset:15552
    ds_read_b64_tr_b16 v[194:195], v235 offset:15552
    v_mfma_f32_16x16x32_bf16 v[88:91], v[148:151], v[128:131], v[88:91]
    ds_read_b64_tr_b16 v[196:197], v234 offset:15680
    ds_read_b64_tr_b16 v[198:199], v235 offset:15680
    v_mfma_f32_16x16x32_bf16 v[92:95], v[148:151], v[132:135], v[92:95]
    ds_read_b64_tr_b16 v[200:201], v234 offset:15688
    ds_read_b64_tr_b16 v[202:203], v235 offset:15688
    v_mfma_f32_16x16x32_bf16 v[96:99], v[152:155], v[128:131], v[96:99]
    ds_read_b64_tr_b16 v[204:205], v234 offset:15696
    ds_read_b64_tr_b16 v[206:207], v235 offset:15696
    v_mfma_f32_16x16x32_bf16 v[100:103], v[152:155], v[132:135], v[100:103]
    v_mfma_f32_16x16x32_bf16 v[104:107], v[156:159], v[128:131], v[104:107]
    v_mfma_f32_16x16x32_bf16 v[108:111], v[156:159], v[132:135], v[108:111]
    v_mfma_f32_16x16x32_bf16 v[112:115], v[160:163], v[128:131], v[112:115]
    v_mfma_f32_16x16x32_bf16 v[116:119], v[160:163], v[132:135], v[116:119]
    v_mfma_f32_16x16x32_bf16 v[120:123], v[164:167], v[128:131], v[120:123]
    v_mfma_f32_16x16x32_bf16 v[124:127], v[164:167], v[132:135], v[124:127]
    s_waitcnt vmcnt(6) lgkmcnt(0)
    s_barrier
    v_mfma_f32_16x16x32_bf16 v[64:67], v[176:179], v[168:171], v[64:67]
    ds_read_b128 v[128:131], v236
    ds_read_b128 v[132:135], v236 offset:2048
    v_mfma_f32_16x16x32_bf16 v[68:71], v[176:179], v[172:175], v[68:71]
    s_add_u32 m0, s73, 51200
    s_nop 0
    buffer_load_dwordx4 v4, s[28:31], s61 offen lds
    ds_read_b64_tr_b16 v[136:137], v238 offset:160
    v_mfma_f32_16x16x32_bf16 v[72:75], v[180:183], v[168:171], v[72:75]
    ds_read_b64_tr_b16 v[138:139], v239 offset:160
    s_add_u32 m0, s73, 52224
    s_nop 0
    buffer_load_dwordx4 v5, s[28:31], s61 offen lds
    v_mfma_f32_16x16x32_bf16 v[76:79], v[180:183], v[172:175], v[76:79]
    ds_read_b64_tr_b16 v[140:141], v238 offset:168
    ds_read_b64_tr_b16 v[142:143], v239 offset:168
    v_mfma_f32_16x16x32_bf16 v[80:83], v[184:187], v[168:171], v[80:83]
    s_cmp_gt_i32 s75, 2
    s_cselect_b64 exec, -1, 1
    s_cselect_b32 s57, s73, 101376
    s_add_u32 m0, s57, 53248
    s_nop 0
    buffer_load_dwordx4 v6, s[28:31], s61 offen lds
    s_mov_b64 exec, -1
    ds_read_b64_tr_b16 v[144:145], v238 offset:176
    v_mfma_f32_16x16x32_bf16 v[84:87], v[184:187], v[172:175], v[84:87]
    ds_read_b64_tr_b16 v[146:147], v239 offset:176
    s_cmp_gt_i32 s75, 3
    s_cselect_b64 exec, -1, 1
    s_cselect_b32 s57, s73, 100352
    s_add_u32 m0, s57, 54272
    s_nop 0
    buffer_load_dwordx4 v7, s[28:31], s61 offen lds
    s_mov_b64 exec, -1
    s_add_u32 s61, s61, s56
    v_mfma_f32_16x16x32_bf16 v[88:91], v[188:191], v[168:171], v[88:91]
    ds_read_b64_tr_b16 v[148:149], v238 offset:184
    ds_read_b64_tr_b16 v[150:151], v239 offset:184
    v_mfma_f32_16x16x32_bf16 v[92:95], v[188:191], v[172:175], v[92:95]
    s_add_u32 m0, s74, 51200
    s_nop 0
    buffer_load_dwordx4 v9, s[24:27], s60 offen lds
    ds_read_b64_tr_b16 v[152:153], v238 offset:192
    v_mfma_f32_16x16x32_bf16 v[96:99], v[192:195], v[168:171], v[96:99]
    ds_read_b64_tr_b16 v[154:155], v239 offset:192
    s_add_u32 m0, s74, 52224
    s_nop 0
    buffer_load_dwordx4 v10, s[24:27], s60 offen lds
    s_add_u32 s60, s60, 128
    v_mfma_f32_16x16x32_bf16 v[100:103], v[192:195], v[172:175], v[100:103]
    ds_read_b64_tr_b16 v[156:157], v238 offset:320
    ds_read_b64_tr_b16 v[158:159], v239 offset:320
    v_mfma_f32_16x16x32_bf16 v[104:107], v[196:199], v[168:171], v[104:107]
    ds_read_b64_tr_b16 v[160:161], v238 offset:328
    ds_read_b64_tr_b16 v[162:163], v239 offset:328
    v_mfma_f32_16x16x32_bf16 v[108:111], v[196:199], v[172:175], v[108:111]
    ds_read_b64_tr_b16 v[164:165], v238 offset:336
    ds_read_b64_tr_b16 v[166:167], v239 offset:336
    v_mfma_f32_16x16x32_bf16 v[112:115], v[200:203], v[168:171], v[112:115]
    v_mfma_f32_16x16x32_bf16 v[116:119], v[200:203], v[172:175], v[116:119]
    v_mfma_f32_16x16x32_bf16 v[120:123], v[204:207], v[168:171], v[120:123]
    v_mfma_f32_16x16x32_bf16 v[124:127], v[204:207], v[172:175], v[124:127]
    s_waitcnt lgkmcnt(0)
    v_mfma_f32_16x16x32_bf16 v[64:67], v[136:139], v[128:131], v[64:67]
    ds_read_b128 v[168:171], v237
    ds_read_b128 v[172:175], v237 offset:2048
    v_mfma_f32_16x16x32_bf16 v[68:71], v[136:139], v[132:135], v[68:71]
    ds_read_b64_tr_b16 v[176:177], v238 offset:15520
    ds_read_b64_tr_b16 v[178:179], v239 offset:15520
    v_mfma_f32_16x16x32_bf16 v[72:75], v[140:143], v[128:131], v[72:75]
    ds_read_b64_tr_b16 v[180:181], v238 offset:15528
    ds_read_b64_tr_b16 v[182:183], v239 offset:15528
    v_mfma_f32_16x16x32_bf16 v[76:79], v[140:143], v[132:135], v[76:79]
    ds_read_b64_tr_b16 v[184:185], v238 offset:15536
    ds_read_b64_tr_b16 v[186:187], v239 offset:15536
    v_mfma_f32_16x16x32_bf16 v[80:83], v[144:147], v[128:131], v[80:83]
    ds_read_b64_tr_b16 v[188:189], v238 offset:15544
    ds_read_b64_tr_b16 v[190:191], v239 offset:15544
    v_mfma_f32_16x16x32_bf16 v[84:87], v[144:147], v[132:135], v[84:87]
    ds_read_b64_tr_b16 v[192:193], v238 offset:15552
    ds_read_b64_tr_b16 v[194:195], v239 offset:15552
    v_mfma_f32_16x16x32_bf16 v[88:91], v[148:151], v[128:131], v[88:91]
    ds_read_b64_tr_b16 v[196:197], v238 offset:15680
    ds_read_b64_tr_b16 v[198:199], v239 offset:15680
    v_mfma_f32_16x16x32_bf16 v[92:95], v[148:151], v[132:135], v[92:95]
    ds_read_b64_tr_b16 v[200:201], v238 offset:15688
    ds_read_b64_tr_b16 v[202:203], v239 offset:15688
    v_mfma_f32_16x16x32_bf16 v[96:99], v[152:155], v[128:131], v[96:99]
    ds_read_b64_tr_b16 v[204:205], v238 offset:15696
    ds_read_b64_tr_b16 v[206:207], v239 offset:15696
    v_mfma_f32_16x16x32_bf16 v[100:103], v[152:155], v[132:135], v[100:103]
    v_mfma_f32_16x16x32_bf16 v[104:107], v[156:159], v[128:131], v[104:107]
    v_mfma_f32_16x16x32_bf16 v[108:111], v[156:159], v[132:135], v[108:111]
    v_mfma_f32_16x16x32_bf16 v[112:115], v[160:163], v[128:131], v[112:115]
    v_mfma_f32_16x16x32_bf16 v[116:119], v[160:163], v[132:135], v[116:119]
    v_mfma_f32_16x16x32_bf16 v[120:123], v[164:167], v[128:131], v[120:123]
    v_mfma_f32_16x16x32_bf16 v[124:127], v[164:167], v[132:135], v[124:127]
    s_waitcnt vmcnt(6) lgkmcnt(0)
    s_barrier
    v_mfma_f32_16x16x32_bf16 v[64:67], v[176:179], v[168:171], v[64:67]
    ds_read_b128 v[128:131], v228
    ds_read_b128 v[132:135], v228 offset:2048
    v_mfma_f32_16x16x32_bf16 v[68:71], v[176:179], v[172:175], v[68:71]
    s_add_u32 m0, s73, 102400
    s_nop 0
    buffer_load_dwordx4 v4, s[28:31], s61 offen lds
    ds_read_b64_tr_b16 v[136:137], v230 offset:160
    v_mfma_f32_16x16x32_bf16 v[72:75], v[180:183], v[168:171], v[72:75]
    ds_read_b64_tr_b16 v[138:139], v231 offset:160
    s_add_u32 m0, s73, 103424
    s_nop 0
    buffer_load_dwordx4 v5, s[28:31], s61 offen lds
    v_mfma_f32_16x16x32_bf16 v[76:79], v[180:183], v[172:175], v[76:79]
    ds_read_b64_tr_b16 v[140:141], v230 offset:168
    ds_read_b64_tr_b16 v[142:143], v231 offset:168
    v_mfma_f32_16x16x32_bf16 v[80:83], v[184:187], v[168:171], v[80:83]
    s_cmp_gt_i32 s75, 2
    s_cselect_b64 exec, -1, 1
    s_cselect_b32 s57, s73, 50176
    s_add_u32 m0, s57, 104448
    s_nop 0
    buffer_load_dwordx4 v6, s[28:31], s61 offen lds
    s_mov_b64 exec, -1
    ds_read_b64_tr_b16 v[144:145], v230 offset:176
    v_mfma_f32_16x16x32_bf16 v[84:87], v[184:187], v[172:175], v[84:87]
    ds_read_b64_tr_b16 v[146:147], v231 offset:176
    s_cmp_gt_i32 s75, 3
    s_cselect_b64 exec, -1, 1
    s_cselect_b32 s57, s73, 49152
    s_add_u32 m0, s57, 105472
    s_nop 0
    buffer_load_dwordx4 v7, s[28:31], s61 offen lds
    s_mov_b64 exec, -1
    s_add_u32 s61, s61, s56
    v_mfma_f32_16x16x32_bf16 v[88:91], v[188:191], v[168:171], v[88:91]
    ds_read_b64_tr_b16 v[148:149], v230 offset:184
    ds_read_b64_tr_b16 v[150:151], v231 offset:184
    v_mfma_f32_16x16x32_bf16 v[92:95], v[188:191], v[172:175], v[92:95]
    s_add_u32 m0, s74, 102400
    s_nop 0
    buffer_load_dwordx4 v9, s[24:27], s60 offen lds
    ds_read_b64_tr_b16 v[152:153], v230 offset:192
    v_mfma_f32_16x16x32_bf16 v[96:99], v[192:195], v[168:171], v[96:99]
    ds_read_b64_tr_b16 v[154:155], v231 offset:192
    s_add_u32 m0, s74, 103424
    s_nop 0
    buffer_load_dwordx4 v10, s[24:27], s60 offen lds
    s_add_u32 s60, s60, 128
    v_mfma_f32_16x16x32_bf16 v[100:103], v[192:195], v[172:175], v[100:103]
    ds_read_b64_tr_b16 v[156:157], v230 offset:320
    ds_read_b64_tr_b16 v[158:159], v231 offset:320
    v_mfma_f32_16x16x32_bf16 v[104:107], v[196:199], v[168:171], v[104:107]
    ds_read_b64_tr_b16 v[160:161], v230 offset:328
    ds_read_b64_tr_b16 v[162:163], v231 offset:328
    v_mfma_f32_16x16x32_bf16 v[108:111], v[196:199], v[172:175], v[108:111]
    ds_read_b64_tr_b16 v[164:165], v230 offset:336
    ds_read_b64_tr_b16 v[166:167], v231 offset:336
    v_mfma_f32_16x16x32_bf16 v[112:115], v[200:203], v[168:171], v[112:115]
    v_mfma_f32_16x16x32_bf16 v[116:119], v[200:203], v[172:175], v[116:119]
    v_mfma_f32_16x16x32_bf16 v[120:123], v[204:207], v[168:171], v[120:123]
    v_mfma_f32_16x16x32_bf16 v[124:127], v[204:207], v[172:175], v[124:127]
    s_waitcnt lgkmcnt(0)
    v_mfma_f32_16x16x32_bf16 v[64:67], v[136:139], v[128:131], v[64:67]
    ds_read_b128 v[168:171], v229
    ds_read_b128 v[172:175], v229 offset:2048
    v_mfma_f32_16x16x32_bf16 v[68:71], v[136:139], v[132:135], v[68:71]
    ds_read_b64_tr_b16 v[176:177], v230 offset:15520
    ds_read_b64_tr_b16 v[178:179], v231 offset:15520
    v_mfma_f32_16x16x32_bf16 v[72:75], v[140:143], v[128:131], v[72:75]
    ds_read_b64_tr_b16 v[180:181], v230 offset:15528
    ds_read_b64_tr_b16 v[182:183], v231 offset:15528
    v_mfma_f32_16x16x32_bf16 v[76:79], v[140:143], v[132:135], v[76:79]
    ds_read_b64_tr_b16 v[184:185], v230 offset:15536
    ds_read_b64_tr_b16 v[186:187], v231 offset:15536
    v_mfma_f32_16x16x32_bf16 v[80:83], v[144:147], v[128:131], v[80:83]
    ds_read_b64_tr_b16 v[188:189], v230 offset:15544
    ds_read_b64_tr_b16 v[190:191], v231 offset:15544
    v_mfma_f32_16x16x32_bf16 v[84:87], v[144:147], v[132:135], v[84:87]
    ds_read_b64_tr_b16 v[192:193], v230 offset:15552
    ds_read_b64_tr_b16 v[194:195], v231 offset:15552
    v_mfma_f32_16x16x32_bf16 v[88:91], v[148:151], v[128:131], v[88:91]
    ds_read_b64_tr_b16 v[196:197], v230 offset:15680
    ds_read_b64_tr_b16 v[198:199], v231 offset:15680
    v_mfma_f32_16x16x32_bf16 v[92:95], v[148:151], v[132:135], v[92:95]
    ds_read_b64_tr_b16 v[200:201], v230 offset:15688
    ds_read_b64_tr_b16 v[202:203], v231 offset:15688
    v_mfma_f32_16x16x32_bf16 v[96:99], v[152:155], v[128:131], v[96:99]
    ds_read_b64_tr_b16 v[204:205], v230 offset:15696
    ds_read_b64_tr_b16 v[206:207], v231 offset:15696
    v_mfma_f32_16x16x32_bf16 v[100:103], v[152:155], v[132:135], v[100:103]
    v_mfma_f32_16x16x32_bf16 v[104:107], v[156:159], v[128:131], v[104:107]
    v_mfma_f32_16x16x32_bf16 v[108:111], v[156:159], v[132:135], v[108:111]
    v_mfma_f32_16x16x32_bf16 v[112:115], v[160:163], v[128:131], v[112:115]
    v_mfma_f32_16x16x32_bf16 v[116:119], v[160:163], v[132:135], v[116:119]
    v_mfma_f32_16x16x32_bf16 v[120:123], v[164:167], v[128:131], v[120:123]
    v_mfma_f32_16x16x32_bf16 v[124:127], v[164:167], v[132:135], v[124:127]
    s_waitcnt vmcnt(6) lgkmcnt(0)
    s_barrier
    v_mfma_f32_16x16x32_bf16 v[64:67], v[176:179], v[168:171], v[64:67]
    ds_read_b128 v[128:131], v232
    ds_read_b128 v[132:135], v232 offset:2048
    v_mfma_f32_16x16x32_bf16 v[68:71], v[176:179], v[172:175], v[68:71]
    s_add_u32 m0, s73, 0
    s_nop 0
    buffer_load_dwordx4 v4, s[28:31], s61 offen lds
    ds_read_b64_tr_b16 v[136:137], v234 offset:160
    v_mfma_f32_16x16x32_bf16 v[72:75], v[180:183], v[168:171], v[72:75]
    ds_read_b64_tr_b16 v[138:139], v235 offset:160
    s_add_u32 m0, s73, 1024
    s_nop 0
    buffer_load_dwordx4 v5, s[28:31], s61 offen lds
    v_mfma_f32_16x16x32_bf16 v[76:79], v[180:183], v[172:175], v[76:79]
    ds_read_b64_tr_b16 v[140:141], v234 offset:168
    ds_read_b64_tr_b16 v[142:143], v235 offset:168
    v_mfma_f32_16x16x32_bf16 v[80:83], v[184:187], v[168:171], v[80:83]
    s_cmp_gt_i32 s75, 2
    s_cselect_b64 exec, -1, 1
    s_cselect_b32 s57, s73, 152576
    s_add_u32 m0, s57, 2048
    s_nop 0
    buffer_load_dwordx4 v6, s[28:31], s61 offen lds
    s_mov_b64 exec, -1
    ds_read_b64_tr_b16 v[144:145], v234 offset:176
    v_mfma_f32_16x16x32_bf16 v[84:87], v[184:187], v[172:175], v[84:87]
    ds_read_b64_tr_b16 v[146:147], v235 offset:176
    s_cmp_gt_i32 s75, 3
    s_cselect_b64 exec, -1, 1
    s_cselect_b32 s57, s73, 151552
    s_add_u32 m0, s57, 3072
    s_nop 0
    buffer_load_dwordx4 v7, s[28:31], s61 offen lds
    s_mov_b64 exec, -1
    s_add_u32 s61, s61, s56
    v_mfma_f32_16x16x32_bf16 v[88:91], v[188:191], v[168:171], v[88:91]
    ds_read_b64_tr_b16 v[148:149], v234 offset:184
    ds_read_b64_tr_b16 v[150:151], v235 offset:184
    v_mfma_f32_16x16x32_bf16 v[92:95], v[188:191], v[172:175], v[92:95]
    s_add_u32 m0, s74, 0
    s_nop 0
    buffer_load_dwordx4 v9, s[24:27], s60 offen lds
    ds_read_b64_tr_b16 v[152:153], v234 offset:192
    v_mfma_f32_16x16x32_bf16 v[96:99], v[192:195], v[168:171], v[96:99]
    ds_read_b64_tr_b16 v[154:155], v235 offset:192
    s_add_u32 m0, s74, 1024
    s_nop 0
    buffer_load_dwordx4 v10, s[24:27], s60 offen lds
    s_add_u32 s60, s60, 128
    v_mfma_f32_16x16x32_bf16 v[100:103], v[192:195], v[172:175], v[100:103]
    ds_read_b64_tr_b16 v[156:157], v234 offset:320
    ds_read_b64_tr_b16 v[158:159], v235 offset:320
    v_mfma_f32_16x16x32_bf16 v[104:107], v[196:199], v[168:171], v[104:107]
    ds_read_b64_tr_b16 v[160:161], v234 offset:328
    ds_read_b64_tr_b16 v[162:163], v235 offset:328
    v_mfma_f32_16x16x32_bf16 v[108:111], v[196:199], v[172:175], v[108:111]
    ds_read_b64_tr_b16 v[164:165], v234 offset:336
    ds_read_b64_tr_b16 v[166:167], v235 offset:336
    v_mfma_f32_16x16x32_bf16 v[112:115], v[200:203], v[168:171], v[112:115]
    v_mfma_f32_16x16x32_bf16 v[116:119], v[200:203], v[172:175], v[116:119]
    v_mfma_f32_16x16x32_bf16 v[120:123], v[204:207], v[168:171], v[120:123]
    v_mfma_f32_16x16x32_bf16 v[124:127], v[204:207], v[172:175], v[124:127]
    s_waitcnt lgkmcnt(0)
    v_mfma_f32_16x16x32_bf16 v[64:67], v[136:139], v[128:131], v[64:67]
    ds_read_b128 v[168:171], v233
    ds_read_b128 v[172:175], v233 offset:2048
    v_mfma_f32_16x16x32_bf16 v[68:71], v[136:139], v[132:135], v[68:71]
    ds_read_b64_tr_b16 v[176:177], v234 offset:15520
    ds_read_b64_tr_b16 v[178:179], v235 offset:15520
    v_mfma_f32_16x16x32_bf16 v[72:75], v[140:143], v[128:131], v[72:75]
    ds_read_b64_tr_b16 v[180:181], v234 offset:15528
    ds_read_b64_tr_b16 v[182:183], v235 offset:15528
    v_mfma_f32_16x16x32_bf16 v[76:79], v[140:143], v[132:135], v[76:79]
    ds_read_b64_tr_b16 v[184:185], v234 offset:15536
    ds_read_b64_tr_b16 v[186:187], v235 offset:15536
    v_mfma_f32_16x16x32_bf16 v[80:83], v[144:147], v[128:131], v[80:83]
    ds_read_b64_tr_b16 v[188:189], v234 offset:15544
    ds_read_b64_tr_b16 v[190:191], v235 offset:15544
    v_mfma_f32_16x16x32_bf16 v[84:87], v[144:147], v[132:135], v[84:87]
    ds_read_b64_tr_b16 v[192:193], v234 offset:15552
    ds_read_b64_tr_b16 v[194:195], v235 offset:15552
    v_mfma_f32_16x16x32_bf16 v[88:91], v[148:151], v[128:131], v[88:91]
    ds_read_b64_tr_b16 v[196:197], v234 offset:15680
    ds_read_b64_tr_b16 v[198:199], v235 offset:15680
    v_mfma_f32_16x16x32_bf16 v[92:95], v[148:151], v[132:135], v[92:95]
    ds_read_b64_tr_b16 v[200:201], v234 offset:15688
    ds_read_b64_tr_b16 v[202:203], v235 offset:15688
    v_mfma_f32_16x16x32_bf16 v[96:99], v[152:155], v[128:131], v[96:99]
    ds_read_b64_tr_b16 v[204:205], v234 offset:15696
    ds_read_b64_tr_b16 v[206:207], v235 offset:15696
    v_mfma_f32_16x16x32_bf16 v[100:103], v[152:155], v[132:135], v[100:103]
    v_mfma_f32_16x16x32_bf16 v[104:107], v[156:159], v[128:131], v[104:107]
    v_mfma_f32_16x16x32_bf16 v[108:111], v[156:159], v[132:135], v[108:111]
    v_mfma_f32_16x16x32_bf16 v[112:115], v[160:163], v[128:131], v[112:115]
    v_mfma_f32_16x16x32_bf16 v[116:119], v[160:163], v[132:135], v[116:119]
    v_mfma_f32_16x16x32_bf16 v[120:123], v[164:167], v[128:131], v[120:123]
    v_mfma_f32_16x16x32_bf16 v[124:127], v[164:167], v[132:135], v[124:127]
    s_waitcnt vmcnt(6) lgkmcnt(0)
    s_barrier
    v_mfma_f32_16x16x32_bf16 v[64:67], v[176:179], v[168:171], v[64:67]
    ds_read_b128 v[128:131], v236
    ds_read_b128 v[132:135], v236 offset:2048
    v_mfma_f32_16x16x32_bf16 v[68:71], v[176:179], v[172:175], v[68:71]
    ds_read_b64_tr_b16 v[136:137], v238 offset:160
    ds_read_b64_tr_b16 v[138:139], v239 offset:160
    v_mfma_f32_16x16x32_bf16 v[72:75], v[180:183], v[168:171], v[72:75]
    ds_read_b64_tr_b16 v[140:141], v238 offset:168
    ds_read_b64_tr_b16 v[142:143], v239 offset:168
    v_mfma_f32_16x16x32_bf16 v[76:79], v[180:183], v[172:175], v[76:79]
    ds_read_b64_tr_b16 v[144:145], v238 offset:176
    ds_read_b64_tr_b16 v[146:147], v239 offset:176
    v_mfma_f32_16x16x32_bf16 v[80:83], v[184:187], v[168:171], v[80:83]
    ds_read_b64_tr_b16 v[148:149], v238 offset:184
    ds_read_b64_tr_b16 v[150:151], v239 offset:184
    v_mfma_f32_16x16x32_bf16 v[84:87], v[184:187], v[172:175], v[84:87]
    ds_read_b64_tr_b16 v[152:153], v238 offset:192
    ds_read_b64_tr_b16 v[154:155], v239 offset:192
    v_mfma_f32_16x16x32_bf16 v[88:91], v[188:191], v[168:171], v[88:91]
    ds_read_b64_tr_b16 v[156:157], v238 offset:320
    ds_read_b64_tr_b16 v[158:159], v239 offset:320
    v_mfma_f32_16x16x32_bf16 v[92:95], v[188:191], v[172:175], v[92:95]
    ds_read_b64_tr_b16 v[160:161], v238 offset:328
    ds_read_b64_tr_b16 v[162:163], v239 offset:328
    v_mfma_f32_16x16x32_bf16 v[96:99], v[192:195], v[168:171], v[96:99]
    ds_read_b64_tr_b16 v[164:165], v238 offset:336
    ds_read_b64_tr_b16 v[166:167], v239 offset:336
    v_mfma_f32_16x16x32_bf16 v[100:103], v[192:195], v[172:175], v[100:103]
    v_mfma_f32_16x16x32_bf16 v[104:107], v[196:199], v[168:171], v[104:107]
    v_mfma_f32_16x16x32_bf16 v[108:111], v[196:199], v[172:175], v[108:111]
    v_mfma_f32_16x16x32_bf16 v[112:115], v[200:203], v[168:171], v[112:115]
    v_mov_b32 v17, 0
    buffer_load_dword v17, v17, s[44:47], 0 offen sc0 sc1
    s_lshl_b32 s57, s51, 2
    s_add_u32 s57, s57, 64
    v_mov_b32 v56, s57
    s_lshl_b32 s57, s71, 2
    s_add_u32 s57, s57, 128
    v_mov_b32 v57, s57
    buffer_load_dword v58, v56, s[44:47], 0 offen sc0 sc1
    buffer_load_dword v59, v57, s[44:47], 0 offen sc0 sc1
    v_mfma_f32_16x16x32_bf16 v[116:119], v[200:203], v[172:175], v[116:119]
    v_mfma_f32_16x16x32_bf16 v[120:123], v[204:207], v[168:171], v[120:123]
    v_mfma_f32_16x16x32_bf16 v[124:127], v[204:207], v[172:175], v[124:127]
    s_waitcnt lgkmcnt(0)
    v_mfma_f32_16x16x32_bf16 v[64:67], v[136:139], v[128:131], v[64:67]
    ds_read_b128 v[168:171], v237
    ds_read_b128 v[172:175], v237 offset:2048
    v_mfma_f32_16x16x32_bf16 v[68:71], v[136:139], v[132:135], v[68:71]
    ds_read_b64_tr_b16 v[176:177], v238 offset:15520
    ds_read_b64_tr_b16 v[178:179], v239 offset:15520
    v_mfma_f32_16x16x32_bf16 v[72:75], v[140:143], v[128:131], v[72:75]
    ds_read_b64_tr_b16 v[180:181], v238 offset:15528
    ds_read_b64_tr_b16 v[182:183], v239 offset:15528
    v_mfma_f32_16x16x32_bf16 v[76:79], v[140:143], v[132:135], v[76:79]
    ds_read_b64_tr_b16 v[184:185], v238 offset:15536
    ds_read_b64_tr_b16 v[186:187], v239 offset:15536
    v_mfma_f32_16x16x32_bf16 v[80:83], v[144:147], v[128:131], v[80:83]
    ds_read_b64_tr_b16 v[188:189], v238 offset:15544
    ds_read_b64_tr_b16 v[190:191], v239 offset:15544
    v_mfma_f32_16x16x32_bf16 v[84:87], v[144:147], v[132:135], v[84:87]
    ds_read_b64_tr_b16 v[192:193], v238 offset:15552
    ds_read_b64_tr_b16 v[194:195], v239 offset:15552
    v_mfma_f32_16x16x32_bf16 v[88:91], v[148:151], v[128:131], v[88:91]
    ds_read_b64_tr_b16 v[196:197], v238 offset:15680
    ds_read_b64_tr_b16 v[198:199], v239 offset:15680
    v_mfma_f32_16x16x32_bf16 v[92:95], v[148:151], v[132:135], v[92:95]
    ds_read_b64_tr_b16 v[200:201], v238 offset:15688
    ds_read_b64_tr_b16 v[202:203], v239 offset:15688
    v_mfma_f32_16x16x32_bf16 v[96:99], v[152:155], v[128:131], v[96:99]
    ds_read_b64_tr_b16 v[204:205], v238 offset:15696
    ds_read_b64_tr_b16 v[206:207], v239 offset:15696
    v_mfma_f32_16x16x32_bf16 v[100:103], v[152:155], v[132:135], v[100:103]
    v_mfma_f32_16x16x32_bf16 v[104:107], v[156:159], v[128:131], v[104:107]
    v_mfma_f32_16x16x32_bf16 v[108:111], v[156:159], v[132:135], v[108:111]
    v_mfma_f32_16x16x32_bf16 v[112:115], v[160:163], v[128:131], v[112:115]
    v_mfma_f32_16x16x32_bf16 v[116:119], v[160:163], v[132:135], v[116:119]
    v_mfma_f32_16x16x32_bf16 v[120:123], v[164:167], v[128:131], v[120:123]
    v_mfma_f32_16x16x32_bf16 v[124:127], v[164:167], v[132:135], v[124:127]
    s_waitcnt vmcnt(0) lgkmcnt(0)
    s_barrier
    v_mfma_f32_16x16x32_bf16 v[64:67], v[176:179], v[168:171], v[64:67]
    ds_read_b128 v[128:131], v228
    ds_read_b128 v[132:135], v228 offset:2048
    v_mfma_f32_16x16x32_bf16 v[68:71], v[176:179], v[172:175], v[68:71]
    ds_read_b64_tr_b16 v[136:137], v230 offset:160
    ds_read_b64_tr_b16 v[138:139], v231 offset:160
    v_mfma_f32_16x16x32_bf16 v[72:75], v[180:183], v[168:171], v[72:75]
    ds_read_b64_tr_b16 v[140:141], v230 offset:168
    ds_read_b64_tr_b16 v[142:143], v231 offset:168
    v_mfma_f32_16x16x32_bf16 v[76:79], v[180:183], v[172:175], v[76:79]
    ds_read_b64_tr_b16 v[144:145], v230 offset:176
    ds_read_b64_tr_b16 v[146:147], v231 offset:176
    v_mfma_f32_16x16x32_bf16 v[80:83], v[184:187], v[168:171], v[80:83]
    ds_read_b64_tr_b16 v[148:149], v230 offset:184
    ds_read_b64_tr_b16 v[150:151], v231 offset:184
    v_mfma_f32_16x16x32_bf16 v[84:87], v[184:187], v[172:175], v[84:87]
    ds_read_b64_tr_b16 v[152:153], v230 offset:192
    ds_read_b64_tr_b16 v[154:155], v231 offset:192
    v_mfma_f32_16x16x32_bf16 v[88:91], v[188:191], v[168:171], v[88:91]
    ds_read_b64_tr_b16 v[156:157], v230 offset:320
    ds_read_b64_tr_b16 v[158:159], v231 offset:320
    v_mfma_f32_16x16x32_bf16 v[92:95], v[188:191], v[172:175], v[92:95]
    ds_read_b64_tr_b16 v[160:161], v230 offset:328
    ds_read_b64_tr_b16 v[162:163], v231 offset:328
    v_mfma_f32_16x16x32_bf16 v[96:99], v[192:195], v[168:171], v[96:99]
    ds_read_b64_tr_b16 v[164:165], v230 offset:336
    ds_read_b64_tr_b16 v[166:167], v231 offset:336
    v_mfma_f32_16x16x32_bf16 v[100:103], v[192:195], v[172:175], v[100:103]
    v_mfma_f32_16x16x32_bf16 v[104:107], v[196:199], v[168:171], v[104:107]
    v_mfma_f32_16x16x32_bf16 v[108:111], v[196:199], v[172:175], v[108:111]
    v_mfma_f32_16x16x32_bf16 v[112:115], v[200:203], v[168:171], v[112:115]
    s_mov_b32 s60, 0
    s_waitcnt vmcnt(0)
K1_PS0:
    v_readfirstlane_b32 s57, v58
    v_readfirstlane_b32 s61, v59
    s_and_b32 s57, s57, 0xff
    s_min_u32 s57, s57, s61
    s_cmp_ge_u32 s57, 16
    s_cbranch_scc1 K1_PSD0
    s_add_u32 s60, s60, 1
    s_cmp_ge_u32 s60, 100000
    s_cbranch_scc1 K1_PSD0
    s_sleep 8
    buffer_load_dword v58, v56, s[44:47], 0 offen sc0 sc1
    buffer_load_dword v59, v57, s[44:47], 0 offen sc0 sc1
    s_waitcnt vmcnt(0)
    s_branch K1_PS0
K1_PSD0:
    s_lshl_b32 s57, s51, 2
    s_add_u32 s57, s57, s54
    s_lshl_b32 s57, s57, 8
    s_add_u32 s57, s57, 15998976
    v_lshlrev_b32 v24, 3, v2
    buffer_load_dwordx2 v[20:21], v24, s[32:35], s57 offen sc0 sc1
    buffer_load_dwordx2 v[22:23], v24, s[32:35], s57 offen offset:128 sc0 sc1
    s_cmp_lt_u32 s48, 4
    s_cbranch_scc0 K1_NCL0
    s_lshl_b32 s57, s71, 14
    s_add_u32 s57, s57, 16015360
    s_lshl_b32 s61, s48, 2
    s_add_u32 s57, s57, s61
    v_lshlrev_b32 v24, 4, v1
    buffer_load_dword v40, v24, s[32:35], s57 offen offset:0 sc0 sc1
    buffer_load_dword v41, v24, s[32:35], s57 offen offset:1024 sc0 sc1
    buffer_load_dword v42, v24, s[32:35], s57 offen offset:2048 sc0 sc1
    buffer_load_dword v43, v24, s[32:35], s57 offen offset:3072 sc0 sc1
    s_add_u32 s57, s57, 4096
    buffer_load_dword v44, v24, s[32:35], s57 offen offset:0 sc0 sc1
    buffer_load_dword v45, v24, s[32:35], s57 offen offset:1024 sc0 sc1
    buffer_load_dword v46, v24, s[32:35], s57 offen offset:2048 sc0 sc1
    buffer_load_dword v47, v24, s[32:35], s57 offen offset:3072 sc0 sc1
    s_add_u32 s57, s57, 4096
    buffer_load_dword v48, v24, s[32:35], s57 offen offset:0 sc0 sc1
    buffer_load_dword v49, v24, s[32:35], s57 offen offset:1024 sc0 sc1
    buffer_load_dword v50, v24, s[32:35], s57 offen offset:2048 sc0 sc1
    buffer_load_dword v51, v24, s[32:35], s57 offen offset:3072 sc0 sc1
    s_add_u32 s57, s57, 4096
    buffer_load_dword v52, v24, s[32:35], s57 offen offset:0 sc0 sc1
    buffer_load_dword v53, v24, s[32:35], s57 offen offset:1024 sc0 sc1
    buffer_load_dword v54, v24, s[32:35], s57 offen offset:2048 sc0 sc1
    buffer_load_dword v55, v24, s[32:35], s57 offen offset:3072 sc0 sc1
    s_add_u32 s57, s57, 4096
K1_NCL0:
    v_mfma_f32_16x16x32_bf16 v[116:119], v[200:203], v[172:175], v[116:119]
    v_mfma_f32_16x16x32_bf16 v[120:123], v[204:207], v[168:171], v[120:123]
    v_mfma_f32_16x16x32_bf16 v[124:127], v[204:207], v[172:175], v[124:127]
    s_waitcnt lgkmcnt(0)
    v_mfma_f32_16x16x32_bf16 v[64:67], v[136:139], v[128:131], v[64:67]
    ds_read_b128 v[168:171], v229
    ds_read_b128 v[172:175], v229 offset:2048
    v_mfma_f32_16x16x32_bf16 v[68:71], v[136:139], v[132:135], v[68:71]
    ds_read_b64_tr_b16 v[176:177], v230 offset:15520
    ds_read_b64_tr_b16 v[178:179], v231 offset:15520
    v_mfma_f32_16x16x32_bf16 v[72:75], v[140:143], v[128:131], v[72:75]
    ds_read_b64_tr_b16 v[180:181], v230 offset:15528
    ds_read_b64_tr_b16 v[182:183], v231 offset:15528
    v_mfma_f32_16x16x32_bf16 v[76:79], v[140:143], v[132:135], v[76:79]
    ds_read_b64_tr_b16 v[184:185], v230 offset:15536
    ds_read_b64_tr_b16 v[186:187], v231 offset:15536
    v_mfma_f32_16x16x32_bf16 v[80:83], v[144:147], v[128:131], v[80:83]
    ds_read_b64_tr_b16 v[188:189], v230 offset:15544
    ds_read_b64_tr_b16 v[190:191], v231 offset:15544
    v_mfma_f32_16x16x32_bf16 v[84:87], v[144:147], v[132:135], v[84:87]
    ds_read_b64_tr_b16 v[192:193], v230 offset:15552
    ds_read_b64_tr_b16 v[194:195], v231 offset:15552
    v_mfma_f32_16x16x32_bf16 v[88:91], v[148:151], v[128:131], v[88:91]
    ds_read_b64_tr_b16 v[196:197], v230 offset:15680
    ds_read_b64_tr_b16 v[198:199], v231 offset:15680
    v_mfma_f32_16x16x32_bf16 v[92:95], v[148:151], v[132:135], v[92:95]
    ds_read_b64_tr_b16 v[200:201], v230 offset:15688
    ds_read_b64_tr_b16 v[202:203], v231 offset:15688
    v_mfma_f32_16x16x32_bf16 v[96:99], v[152:155], v[128:131], v[96:99]
    ds_read_b64_tr_b16 v[204:205], v230 offset:15696
    ds_read_b64_tr_b16 v[206:207], v231 offset:15696
    v_mfma_f32_16x16x32_bf16 v[100:103], v[152:155], v[132:135], v[100:103]
    v_mfma_f32_16x16x32_bf16 v[104:107], v[156:159], v[128:131], v[104:107]
    v_mfma_f32_16x16x32_bf16 v[108:111], v[156:159], v[132:135], v[108:111]
    v_mfma_f32_16x16x32_bf16 v[112:115], v[160:163], v[128:131], v[112:115]
    v_mfma_f32_16x16x32_bf16 v[116:119], v[160:163], v[132:135], v[116:119]
    v_mfma_f32_16x16x32_bf16 v[120:123], v[164:167], v[128:131], v[120:123]
    v_mfma_f32_16x16x32_bf16 v[124:127], v[164:167], v[132:135], v[124:127]
    s_waitcnt lgkmcnt(0)
    s_barrier
    v_mfma_f32_16x16x32_bf16 v[64:67], v[176:179], v[168:171], v[64:67]
    v_mfma_f32_16x16x32_bf16 v[68:71], v[176:179], v[172:175], v[68:71]
    v_mfma_f32_16x16x32_bf16 v[72:75], v[180:183], v[168:171], v[72:75]
    v_mfma_f32_16x16x32_bf16 v[76:79], v[180:183], v[172:175], v[76:79]
    v_mfma_f32_16x16x32_bf16 v[80:83], v[184:187], v[168:171], v[80:83]
    v_mfma_f32_16x16x32_bf16 v[84:87], v[184:187], v[172:175], v[84:87]
    v_mfma_f32_16x16x32_bf16 v[88:91], v[188:191], v[168:171], v[88:91]
    v_mfma_f32_16x16x32_bf16 v[92:95], v[188:191], v[172:175], v[92:95]
    v_mfma_f32_16x16x32_bf16 v[96:99], v[192:195], v[168:171], v[96:99]
    v_mfma_f32_16x16x32_bf16 v[100:103], v[192:195], v[172:175], v[100:103]
    v_mfma_f32_16x16x32_bf16 v[104:107], v[196:199], v[168:171], v[104:107]
    v_mfma_f32_16x16x32_bf16 v[108:111], v[196:199], v[172:175], v[108:111]
    v_mfma_f32_16x16x32_bf16 v[112:115], v[200:203], v[168:171], v[112:115]
    v_mfma_f32_16x16x32_bf16 v[116:119], v[200:203], v[172:175], v[116:119]
    v_mfma_f32_16x16x32_bf16 v[120:123], v[204:207], v[168:171], v[120:123]
    v_mfma_f32_16x16x32_bf16 v[124:127], v[204:207], v[172:175], v[124:127]
    s_lshl_b32 s57, s52, 2
    v_mov_b32 v60, s57
    buffer_load_dword v61, v60, s[44:47], 0 offen sc0 sc1
    s_waitcnt vmcnt(1)
    s_cmp_lt_u32 s48, 4
    s_cbranch_scc0 K1_NCS0
    v_pk_add_f32 v[40:41], v[40:41], v[42:43]
    v_pk_add_f32 v[40:41], v[40:41], v[44:45]
    v_pk_add_f32 v[40:41], v[40:41], v[46:47]
    v_pk_add_f32 v[40:41], v[40:41], v[48:49]
    v_pk_add_f32 v[40:41], v[40:41], v[50:51]
    v_pk_add_f32 v[40:41], v[40:41], v[52:53]
    v_pk_add_f32 v[40:41], v[40:41], v[54:55]
    v_add_f32 v40, v40, v41
    s_lshl_b32 s57, s48, 2
    s_add_u32 s57, s57, 153600
    v_lshlrev_b32 v24, 4, v1
    v_add_u32 v24, s57, v24
    ds_write_b32 v24, v40
    v_lshlrev_b32 v25, 4, v0
    v_add_u32 v25, 73728, v25
    ds_write_b128 v25, v[252:255]
K1_NCS0:
    s_waitcnt lgkmcnt(0)
    s_barrier
    s_cmp_eq_u32 s48, 0
    s_cbranch_scc0 K1_NZ0
    v_readfirstlane_b32 s57, v17
    s_nop 0
    s_cmp_lg_u32 s57, 0
    s_cbranch_scc1 K1_ZOK0
    v_mov_b32 v24, 0
    s_mov_b32 s68, 0
K1_SZ0:
    buffer_load_dword v25, v24, s[44:47], 0 offen sc0 sc1
    s_waitcnt vmcnt(0)
    v_readfirstlane_b32 s57, v25
    s_nop 0
    s_cmp_lg_u32 s57, 0
    s_cbranch_scc1 K1_SZ0_D
    s_add_u32 s68, s68, 1
    s_cmp_ge_u32 s68, 100000
    s_cbranch_scc1 K1_SZ0_D
    s_sleep 12
    s_branch K1_SZ0
K1_SZ0_D:
K1_ZOK0:
K1_NZ0:
    v_mul_u32_u24 v26, 80, v3
    v_add_u32 v26, 153600, v26
    ds_read_b128 v[128:131], v26 offset:320
    ds_read_b128 v[132:135], v26 offset:336
    ds_read_b128 v[136:139], v26 offset:352
    ds_read_b128 v[140:143], v26 offset:368
    ds_read_b128 v[144:147], v26 offset:384
    ds_read_b128 v[148:151], v26 offset:640
    ds_read_b128 v[152:155], v26 offset:656
    ds_read_b128 v[156:159], v26 offset:672
    v_mov_b32 v28, v20
    v_mov_b32 v32, v21
    v_mov_b32 v30, v22
    v_mov_b32 v34, v23
    s_waitcnt lgkmcnt(0)
    v_pk_fma_f32 v[64:65], v[128:129], v[28:29], v[64:65] op_sel_hi:[1,0,1] neg_lo:[0,1,0] neg_hi:[0,1,0]
    v_pk_fma_f32 v[66:67], v[130:131], v[28:29], v[66:67] op_sel_hi:[1,0,1] neg_lo:[0,1,0] neg_hi:[0,1,0]
    v_pk_fma_f32 v[68:69], v[128:129], v[30:31], v[68:69] op_sel_hi:[1,0,1] neg_lo:[0,1,0] neg_hi:[0,1,0]
    v_pk_fma_f32 v[70:71], v[130:131], v[30:31], v[70:71] op_sel_hi:[1,0,1] neg_lo:[0,1,0] neg_hi:[0,1,0]
    v_pk_fma_f32 v[72:73], v[132:133], v[28:29], v[72:73] op_sel_hi:[1,0,1] neg_lo:[0,1,0] neg_hi:[0,1,0]
    v_pk_fma_f32 v[74:75], v[134:135], v[28:29], v[74:75] op_sel_hi:[1,0,1] neg_lo:[0,1,0] neg_hi:[0,1,0]
    v_pk_fma_f32 v[76:77], v[132:133], v[30:31], v[76:77] op_sel_hi:[1,0,1] neg_lo:[0,1,0] neg_hi:[0,1,0]
    v_pk_fma_f32 v[78:79], v[134:135], v[30:31], v[78:79] op_sel_hi:[1,0,1] neg_lo:[0,1,0] neg_hi:[0,1,0]
    v_pk_fma_f32 v[80:81], v[136:137], v[28:29], v[80:81] op_sel_hi:[1,0,1] neg_lo:[0,1,0] neg_hi:[0,1,0]
    v_pk_fma_f32 v[82:83], v[138:139], v[28:29], v[82:83] op_sel_hi:[1,0,1] neg_lo:[0,1,0] neg_hi:[0,1,0]
    v_pk_fma_f32 v[84:85], v[136:137], v[30:31], v[84:85] op_sel_hi:[1,0,1] neg_lo:[0,1,0] neg_hi:[0,1,0]
    v_pk_fma_f32 v[86:87], v[138:139], v[30:31], v[86:87] op_sel_hi:[1,0,1] neg_lo:[0,1,0] neg_hi:[0,1,0]
    v_pk_fma_f32 v[88:89], v[140:141], v[28:29], v[88:89] op_sel_hi:[1,0,1] neg_lo:[0,1,0] neg_hi:[0,1,0]
    v_pk_fma_f32 v[90:91], v[142:143], v[28:29], v[90:91] op_sel_hi:[1,0,1] neg_lo:[0,1,0] neg_hi:[0,1,0]
    v_pk_fma_f32 v[92:93], v[140:141], v[30:31], v[92:93] op_sel_hi:[1,0,1] neg_lo:[0,1,0] neg_hi:[0,1,0]
    v_pk_fma_f32 v[94:95], v[142:143], v[30:31], v[94:95] op_sel_hi:[1,0,1] neg_lo:[0,1,0] neg_hi:[0,1,0]
    v_pk_fma_f32 v[96:97], v[144:145], v[28:29], v[96:97] op_sel_hi:[1,0,1] neg_lo:[0,1,0] neg_hi:[0,1,0]
    v_pk_fma_f32 v[98:99], v[146:147], v[28:29], v[98:99] op_sel_hi:[1,0,1] neg_lo:[0,1,0] neg_hi:[0,1,0]
    v_pk_fma_f32 v[100:101], v[144:145], v[30:31], v[100:101] op_sel_hi:[1,0,1] neg_lo:[0,1,0] neg_hi:[0,1,0]
    v_pk_fma_f32 v[102:103], v[146:147], v[30:31], v[102:103] op_sel_hi:[1,0,1] neg_lo:[0,1,0] neg_hi:[0,1,0]
    v_pk_fma_f32 v[104:105], v[148:149], v[28:29], v[104:105] op_sel_hi:[1,0,1] neg_lo:[0,1,0] neg_hi:[0,1,0]
    v_pk_fma_f32 v[106:107], v[150:151], v[28:29], v[106:107] op_sel_hi:[1,0,1] neg_lo:[0,1,0] neg_hi:[0,1,0]
    v_pk_fma_f32 v[108:109], v[148:149], v[30:31], v[108:109] op_sel_hi:[1,0,1] neg_lo:[0,1,0] neg_hi:[0,1,0]
    v_pk_fma_f32 v[110:111], v[150:151], v[30:31], v[110:111] op_sel_hi:[1,0,1] neg_lo:[0,1,0] neg_hi:[0,1,0]
    v_pk_fma_f32 v[112:113], v[152:153], v[28:29], v[112:113] op_sel_hi:[1,0,1] neg_lo:[0,1,0] neg_hi:[0,1,0]
    v_pk_fma_f32 v[114:115], v[154:155], v[28:29], v[114:115] op_sel_hi:[1,0,1] neg_lo:[0,1,0] neg_hi:[0,1,0]
    v_pk_fma_f32 v[116:117], v[152:153], v[30:31], v[116:117] op_sel_hi:[1,0,1] neg_lo:[0,1,0] neg_hi:[0,1,0]
    v_pk_fma_f32 v[118:119], v[154:155], v[30:31], v[118:119] op_sel_hi:[1,0,1] neg_lo:[0,1,0] neg_hi:[0,1,0]
    v_pk_fma_f32 v[120:121], v[156:157], v[28:29], v[120:121] op_sel_hi:[1,0,1] neg_lo:[0,1,0] neg_hi:[0,1,0]
    v_pk_fma_f32 v[122:123], v[158:159], v[28:29], v[122:123] op_sel_hi:[1,0,1] neg_lo:[0,1,0] neg_hi:[0,1,0]
    v_pk_fma_f32 v[124:125], v[156:157], v[30:31], v[124:125] op_sel_hi:[1,0,1] neg_lo:[0,1,0] neg_hi:[0,1,0]
    v_pk_fma_f32 v[126:127], v[158:159], v[30:31], v[126:127] op_sel_hi:[1,0,1] neg_lo:[0,1,0] neg_hi:[0,1,0]
    v_pk_mul_f32 v[64:65], v[64:65], v[32:33] op_sel_hi:[1,0]
    v_pk_mul_f32 v[66:67], v[66:67], v[32:33] op_sel_hi:[1,0]
    v_pk_mul_f32 v[68:69], v[68:69], v[34:35] op_sel_hi:[1,0]
    v_pk_mul_f32 v[70:71], v[70:71], v[34:35] op_sel_hi:[1,0]
    v_pk_mul_f32 v[72:73], v[72:73], v[32:33] op_sel_hi:[1,0]
    v_pk_mul_f32 v[74:75], v[74:75], v[32:33] op_sel_hi:[1,0]
    v_pk_mul_f32 v[76:77], v[76:77], v[34:35] op_sel_hi:[1,0]
    v_pk_mul_f32 v[78:79], v[78:79], v[34:35] op_sel_hi:[1,0]
    v_pk_mul_f32 v[80:81], v[80:81], v[32:33] op_sel_hi:[1,0]
    v_pk_mul_f32 v[82:83], v[82:83], v[32:33] op_sel_hi:[1,0]
    v_pk_mul_f32 v[84:85], v[84:85], v[34:35] op_sel_hi:[1,0]
    v_pk_mul_f32 v[86:87], v[86:87], v[34:35] op_sel_hi:[1,0]
    v_pk_mul_f32 v[88:89], v[88:89], v[32:33] op_sel_hi:[1,0]
    v_pk_mul_f32 v[90:91], v[90:91], v[32:33] op_sel_hi:[1,0]
    v_pk_mul_f32 v[92:93], v[92:93], v[34:35] op_sel_hi:[1,0]
    v_pk_mul_f32 v[94:95], v[94:95], v[34:35] op_sel_hi:[1,0]
    v_pk_mul_f32 v[96:97], v[96:97], v[32:33] op_sel_hi:[1,0]
    v_pk_mul_f32 v[98:99], v[98:99], v[32:33] op_sel_hi:[1,0]
    v_pk_mul_f32 v[100:101], v[100:101], v[34:35] op_sel_hi:[1,0]
    v_pk_mul_f32 v[102:103], v[102:103], v[34:35] op_sel_hi:[1,0]
    v_pk_mul_f32 v[104:105], v[104:105], v[32:33] op_sel_hi:[1,0]
    v_pk_mul_f32 v[106:107], v[106:107], v[32:33] op_sel_hi:[1,0]
    v_pk_mul_f32 v[108:109], v[108:109], v[34:35] op_sel_hi:[1,0]
    v_pk_mul_f32 v[110:111], v[110:111], v[34:35] op_sel_hi:[1,0]
    v_pk_mul_f32 v[112:113], v[112:113], v[32:33] op_sel_hi:[1,0]
    v_pk_mul_f32 v[114:115], v[114:115], v[32:33] op_sel_hi:[1,0]
    v_pk_mul_f32 v[116:117], v[116:117], v[34:35] op_sel_hi:[1,0]
    v_pk_mul_f32 v[118:119], v[118:119], v[34:35] op_sel_hi:[1,0]
    v_pk_mul_f32 v[120:121], v[120:121], v[32:33] op_sel_hi:[1,0]
    v_pk_mul_f32 v[122:123], v[122:123], v[32:33] op_sel_hi:[1,0]
    v_pk_mul_f32 v[124:125], v[124:125], v[34:35] op_sel_hi:[1,0]
    v_pk_mul_f32 v[126:127], v[126:127], v[34:35] op_sel_hi:[1,0]
    v_cvt_pk_bf16_f32 v160, v64, v65
    v_cvt_pk_bf16_f32 v161, v66, v67
    v_cvt_pk_bf16_f32 v162, v72, v73
    v_cvt_pk_bf16_f32 v163, v74, v75
    v_cvt_pk_bf16_f32 v164, v80, v81
    v_cvt_pk_bf16_f32 v165, v82, v83
    v_cvt_pk_bf16_f32 v166, v88, v89
    v_cvt_pk_bf16_f32 v167, v90, v91
    v_cvt_pk_bf16_f32 v168, v96, v97
    v_cvt_pk_bf16_f32 v169, v98, v99
    v_cvt_pk_bf16_f32 v184, v104, v105
    v_cvt_pk_bf16_f32 v185, v106, v107
    v_cvt_pk_bf16_f32 v186, v112, v113
    v_cvt_pk_bf16_f32 v187, v114, v115
    v_cvt_pk_bf16_f32 v188, v120, v121
    v_cvt_pk_bf16_f32 v189, v122, v123
    v_cvt_pk_bf16_f32 v172, v68, v69
    v_cvt_pk_bf16_f32 v173, v70, v71
    v_cvt_pk_bf16_f32 v174, v76, v77
    v_cvt_pk_bf16_f32 v175, v78, v79
    v_cvt_pk_bf16_f32 v176, v84, v85
    v_cvt_pk_bf16_f32 v177, v86, v87
    v_cvt_pk_bf16_f32 v178, v92, v93
    v_cvt_pk_bf16_f32 v179, v94, v95
    v_cvt_pk_bf16_f32 v180, v100, v101
    v_cvt_pk_bf16_f32 v181, v102, v103
    v_cvt_pk_bf16_f32 v190, v108, v109
    v_cvt_pk_bf16_f32 v191, v110, v111
    v_cvt_pk_bf16_f32 v192, v116, v117
    v_cvt_pk_bf16_f32 v193, v118, v119
    v_cvt_pk_bf16_f32 v194, v124, v125
    v_cvt_pk_bf16_f32 v195, v126, v127
    v_mov_b32 v170, 0
    v_mov_b32 v171, 0
    v_mov_b32 v182, 0
    v_mov_b32 v183, 0
    v_mov_b32 v206, 0
    v_mov_b32 v207, 0
    v_mov_b32 v218, 0
    v_mov_b32 v219, 0
    v_lshlrev_b32 v48, 4, v1
    s_mul_i32 s57, s54, 3072
    s_add_u32 s57, s57, 97280
    v_add_u32 v49, s57, v48
    ds_write_b128 v49, v[172:175] offset:0
    ds_write_b128 v49, v[176:179] offset:1024
    ds_write_b128 v49, v[180:183] offset:2048
    s_lshl_b32 s57, s54, 5
    v_add_u32 v24, s57, v2
    v_mul_u32_u24 v25, 224, v24
    v_mul_u32_u24 v26, 48, v3
    v_add_u32 v25, v25, v26
    v_add_u32 v25, 45056, v25
    ds_write_b64 v25, v[184:185] offset:0
    ds_write_b64 v25, v[186:187] offset:8
    ds_write_b64 v25, v[188:189] offset:16
    ds_write_b64 v25, v[190:191] offset:3584
    ds_write_b64 v25, v[192:193] offset:3592
    ds_write_b64 v25, v[194:195] offset:3600
    v_lshrrev_b32 v26, 2, v1
    v_and_b32 v26, 3, v26
    v_and_b32 v27, 3, v1
    v_mul_u32_u24 v28, 800, v3
    v_mul_u32_u24 v29, 40, v26
    v_add_u32 v28, v28, v29
    v_add_u32 v28, 73728, v28
    v_mov_b32 v29, 76928
    v_cmp_eq_u32 vcc, v27, v3
    v_add_u32 v30, 0, v28
    s_nop 0
    v_cndmask_b32 v34, v29, v30, vcc
    v_add_u32 v30, 160, v28
    v_cndmask_b32 v35, v29, v30, vcc
    v_add_u32 v30, 320, v28
    v_cndmask_b32 v36, v29, v30, vcc
    v_add_u32 v30, 480, v28
    v_cndmask_b32 v37, v29, v30, vcc
    v_add_u32 v30, 640, v28
    v_cndmask_b32 v38, v29, v30, vcc
    s_waitcnt lgkmcnt(0)
    s_barrier
K1_QC:
    ds_read_b64_tr_b16 v[196:197], v34 offset:0
    ds_read_b64_tr_b16 v[198:199], v35 offset:0
    ds_read_b64_tr_b16 v[200:201], v36 offset:0
    ds_read_b64_tr_b16 v[202:203], v37 offset:0
    ds_read_b64_tr_b16 v[204:205], v38 offset:0
    ds_read_b64_tr_b16 v[208:209], v34 offset:8
    ds_read_b64_tr_b16 v[210:211], v35 offset:8
    ds_read_b64_tr_b16 v[212:213], v36 offset:8
    ds_read_b64_tr_b16 v[214:215], v37 offset:8
    ds_read_b64_tr_b16 v[216:217], v38 offset:8
    s_waitcnt lgkmcnt(5)
    v_mfma_f32_16x16x32_bf16 v[64:67], v[196:199], v[160:163], 0
    v_mfma_f32_16x16x32_bf16 v[64:67], v[200:203], v[164:167], v[64:67]
    v_mfma_f32_16x16x32_bf16 v[64:67], v[204:207], v[168:171], v[64:67]
    ds_read_b64_tr_b16 v[196:197], v34 offset:16
    ds_read_b64_tr_b16 v[198:199], v35 offset:16
    ds_read_b64_tr_b16 v[200:201], v36 offset:16
    ds_read_b64_tr_b16 v[202:203], v37 offset:16
    ds_read_b64_tr_b16 v[204:205], v38 offset:16
    s_waitcnt lgkmcnt(5)
    v_mfma_f32_16x16x32_bf16 v[68:71], v[208:211], v[160:163], 0
    v_mfma_f32_16x16x32_bf16 v[68:71], v[212:215], v[164:167], v[68:71]
    v_mfma_f32_16x16x32_bf16 v[68:71], v[216:219], v[168:171], v[68:71]
    ds_read_b64_tr_b16 v[208:209], v34 offset:24
    ds_read_b64_tr_b16 v[210:211], v35 offset:24
    ds_read_b64_tr_b16 v[212:213], v36 offset:24
    ds_read_b64_tr_b16 v[214:215], v37 offset:24
    ds_read_b64_tr_b16 v[216:217], v38 offset:24
    s_waitcnt lgkmcnt(5)
    v_mfma_f32_16x16x32_bf16 v[72:75], v[196:199], v[160:163], 0
    v_mfma_f32_16x16x32_bf16 v[72:75], v[200:203], v[164:167], v[72:75]
    v_mfma_f32_16x16x32_bf16 v[72:75], v[204:207], v[168:171], v[72:75]
    ds_read_b64_tr_b16 v[196:197], v34 offset:32
    ds_read_b64_tr_b16 v[198:199], v35 offset:32
    ds_read_b64_tr_b16 v[200:201], v36 offset:32
    ds_read_b64_tr_b16 v[202:203], v37 offset:32
    ds_read_b64_tr_b16 v[204:205], v38 offset:32
    s_waitcnt lgkmcnt(5)
    v_mfma_f32_16x16x32_bf16 v[76:79], v[208:211], v[160:163], 0
    v_mfma_f32_16x16x32_bf16 v[76:79], v[212:215], v[164:167], v[76:79]
    v_mfma_f32_16x16x32_bf16 v[76:79], v[216:219], v[168:171], v[76:79]
    s_waitcnt lgkmcnt(0)
    v_mfma_f32_16x16x32_bf16 v[80:83], v[196:199], v[160:163], 0
    v_mfma_f32_16x16x32_bf16 v[80:83], v[200:203], v[164:167], v[80:83]
    v_mfma_f32_16x16x32_bf16 v[80:83], v[204:207], v[168:171], v[80:83]
    s_mov_b32 s56, 1069066811
    s_mov_b32 s57, 1069066811
    v_max3_f32 v40, v64, v65, v66
    v_min3_f32 v42, v64, v65, v66
    v_max3_f32 v40, v40, v67, v68
    v_min3_f32 v42, v42, v67, v68
    v_max3_f32 v40, v40, v69, v70
    v_min3_f32 v42, v42, v69, v70
    v_max3_f32 v40, v40, v71, v72
    v_min3_f32 v42, v42, v71, v72
    v_max3_f32 v40, v40, v73, v74
    v_min3_f32 v42, v42, v73, v74
    v_max3_f32 v40, v40, v75, v76
    v_min3_f32 v42, v42, v75, v76
    v_max3_f32 v40, v40, v77, v78
    v_min3_f32 v42, v42, v77, v78
    v_max3_f32 v40, v40, v79, v80
    v_min3_f32 v42, v42, v79, v80
    v_max3_f32 v40, v40, v81, v82
    v_min3_f32 v42, v42, v81, v82
    v_max_f32 v40, v40, v83
    v_min_f32 v42, v42, v83
    v_mul_f32 v40, s56, v40
    v_mul_f32 v42, s56, v42
    v_pk_fma_f32 v[104:105], v[64:65], s[56:57], v[40:41] op_sel_hi:[1,0,0] neg_lo:[0,0,1] neg_hi:[0,0,1]
    v_pk_fma_f32 v[64:65], v[64:65], s[56:57], v[42:43] op_sel_hi:[1,0,0] neg_lo:[1,0,0] neg_hi:[1,0,0]
    v_pk_fma_f32 v[106:107], v[66:67], s[56:57], v[40:41] op_sel_hi:[1,0,0] neg_lo:[0,0,1] neg_hi:[0,0,1]
    v_pk_fma_f32 v[66:67], v[66:67], s[56:57], v[42:43] op_sel_hi:[1,0,0] neg_lo:[1,0,0] neg_hi:[1,0,0]
    v_pk_fma_f32 v[108:109], v[68:69], s[56:57], v[40:41] op_sel_hi:[1,0,0] neg_lo:[0,0,1] neg_hi:[0,0,1]
    v_pk_fma_f32 v[68:69], v[68:69], s[56:57], v[42:43] op_sel_hi:[1,0,0] neg_lo:[1,0,0] neg_hi:[1,0,0]
    v_pk_fma_f32 v[110:111], v[70:71], s[56:57], v[40:41] op_sel_hi:[1,0,0] neg_lo:[0,0,1] neg_hi:[0,0,1]
    v_pk_fma_f32 v[70:71], v[70:71], s[56:57], v[42:43] op_sel_hi:[1,0,0] neg_lo:[1,0,0] neg_hi:[1,0,0]
    v_pk_fma_f32 v[112:113], v[72:73], s[56:57], v[40:41] op_sel_hi:[1,0,0] neg_lo:[0,0,1] neg_hi:[0,0,1]
    v_pk_fma_f32 v[72:73], v[72:73], s[56:57], v[42:43] op_sel_hi:[1,0,0] neg_lo:[1,0,0] neg_hi:[1,0,0]
    v_pk_fma_f32 v[114:115], v[74:75], s[56:57], v[40:41] op_sel_hi:[1,0,0] neg_lo:[0,0,1] neg_hi:[0,0,1]
    v_pk_fma_f32 v[74:75], v[74:75], s[56:57], v[42:43] op_sel_hi:[1,0,0] neg_lo:[1,0,0] neg_hi:[1,0,0]
    v_pk_fma_f32 v[116:117], v[76:77], s[56:57], v[40:41] op_sel_hi:[1,0,0] neg_lo:[0,0,1] neg_hi:[0,0,1]
    v_pk_fma_f32 v[76:77], v[76:77], s[56:57], v[42:43] op_sel_hi:[1,0,0] neg_lo:[1,0,0] neg_hi:[1,0,0]
    v_pk_fma_f32 v[118:119], v[78:79], s[56:57], v[40:41] op_sel_hi:[1,0,0] neg_lo:[0,0,1] neg_hi:[0,0,1]
    v_pk_fma_f32 v[78:79], v[78:79], s[56:57], v[42:43] op_sel_hi:[1,0,0] neg_lo:[1,0,0] neg_hi:[1,0,0]
    v_pk_fma_f32 v[120:121], v[80:81], s[56:57], v[40:41] op_sel_hi:[1,0,0] neg_lo:[0,0,1] neg_hi:[0,0,1]
    v_pk_fma_f32 v[80:81], v[80:81], s[56:57], v[42:43] op_sel_hi:[1,0,0] neg_lo:[1,0,0] neg_hi:[1,0,0]
    v_pk_fma_f32 v[122:123], v[82:83], s[56:57], v[40:41] op_sel_hi:[1,0,0] neg_lo:[0,0,1] neg_hi:[0,0,1]
    v_pk_fma_f32 v[82:83], v[82:83], s[56:57], v[42:43] op_sel_hi:[1,0,0] neg_lo:[1,0,0] neg_hi:[1,0,0]
    v_exp_f32 v104, v104
    v_exp_f32 v64, v64
    v_exp_f32 v105, v105
    v_exp_f32 v65, v65
    v_exp_f32 v106, v106
    v_exp_f32 v66, v66
    v_exp_f32 v107, v107
    v_exp_f32 v67, v67
    v_exp_f32 v108, v108
    v_exp_f32 v68, v68
    v_exp_f32 v109, v109
    v_exp_f32 v69, v69
    v_exp_f32 v110, v110
    v_exp_f32 v70, v70
    v_exp_f32 v111, v111
    v_exp_f32 v71, v71
    v_exp_f32 v112, v112
    v_exp_f32 v72, v72
    v_exp_f32 v113, v113
    v_exp_f32 v73, v73
    v_exp_f32 v114, v114
    v_exp_f32 v74, v74
    v_exp_f32 v115, v115
    v_exp_f32 v75, v75
    v_exp_f32 v116, v116
    v_exp_f32 v76, v76
    v_exp_f32 v117, v117
    v_exp_f32 v77, v77
    v_exp_f32 v118, v118
    v_exp_f32 v78, v78
    v_exp_f32 v119, v119
    v_exp_f32 v79, v79
    v_exp_f32 v120, v120
    v_exp_f32 v80, v80
    v_exp_f32 v121, v121
    v_exp_f32 v81, v81
    v_exp_f32 v122, v122
    v_exp_f32 v82, v82
    v_exp_f32 v123, v123
    v_exp_f32 v83, v83
    v_pk_add_f32 v[44:45], v[104:105], v[106:107]
    v_pk_add_f32 v[46:47], v[64:65], v[66:67]
    v_pk_add_f32 v[44:45], v[44:45], v[108:109]
    v_pk_add_f32 v[46:47], v[46:47], v[68:69]
    v_pk_add_f32 v[44:45], v[44:45], v[110:111]
    v_pk_add_f32 v[46:47], v[46:47], v[70:71]
    v_pk_add_f32 v[44:45], v[44:45], v[112:113]
    v_pk_add_f32 v[46:47], v[46:47], v[72:73]
    v_pk_add_f32 v[44:45], v[44:45], v[114:115]
    v_pk_add_f32 v[46:47], v[46:47], v[74:75]
    v_pk_add_f32 v[44:45], v[44:45], v[116:117]
    v_pk_add_f32 v[46:47], v[46:47], v[76:77]
    v_pk_add_f32 v[44:45], v[44:45], v[118:119]
    v_pk_add_f32 v[46:47], v[46:47], v[78:79]
    v_pk_add_f32 v[44:45], v[44:45], v[120:121]
    v_pk_add_f32 v[46:47], v[46:47], v[80:81]
    v_pk_add_f32 v[44:45], v[44:45], v[122:123]
    v_pk_add_f32 v[46:47], v[46:47], v[82:83]
    v_add_f32 v44, v44, v45
    v_add_f32 v46, v46, v47
    v_rcp_f32 v44, v44
    v_rcp_f32 v46, v46
    v_pk_mul_f32 v[104:105], v[104:105], v[44:45] op_sel_hi:[1,0]
    v_pk_mul_f32 v[64:65], v[64:65], v[46:47] op_sel_hi:[1,0]
    v_pk_mul_f32 v[106:107], v[106:107], v[44:45] op_sel_hi:[1,0]
    v_pk_mul_f32 v[66:67], v[66:67], v[46:47] op_sel_hi:[1,0]
    v_pk_mul_f32 v[108:109], v[108:109], v[44:45] op_sel_hi:[1,0]
    v_pk_mul_f32 v[68:69], v[68:69], v[46:47] op_sel_hi:[1,0]
    v_pk_mul_f32 v[110:111], v[110:111], v[44:45] op_sel_hi:[1,0]
    v_pk_mul_f32 v[70:71], v[70:71], v[46:47] op_sel_hi:[1,0]
    v_pk_mul_f32 v[112:113], v[112:113], v[44:45] op_sel_hi:[1,0]
    v_pk_mul_f32 v[72:73], v[72:73], v[46:47] op_sel_hi:[1,0]
    v_pk_mul_f32 v[114:115], v[114:115], v[44:45] op_sel_hi:[1,0]
    v_pk_mul_f32 v[74:75], v[74:75], v[46:47] op_sel_hi:[1,0]
    v_pk_mul_f32 v[116:117], v[116:117], v[44:45] op_sel_hi:[1,0]
    v_pk_mul_f32 v[76:77], v[76:77], v[46:47] op_sel_hi:[1,0]
    v_pk_mul_f32 v[118:119], v[118:119], v[44:45] op_sel_hi:[1,0]
    v_pk_mul_f32 v[78:79], v[78:79], v[46:47] op_sel_hi:[1,0]
    v_pk_mul_f32 v[120:121], v[120:121], v[44:45] op_sel_hi:[1,0]
    v_pk_mul_f32 v[80:81], v[80:81], v[46:47] op_sel_hi:[1,0]
    v_pk_mul_f32 v[122:123], v[122:123], v[44:45] op_sel_hi:[1,0]
    v_pk_mul_f32 v[82:83], v[82:83], v[46:47] op_sel_hi:[1,0]
    v_cvt_pk_bf16_f32 v140, v104, v105
    v_cvt_pk_bf16_f32 v150, v64, v65
    v_cvt_pk_bf16_f32 v141, v106, v107
    v_cvt_pk_bf16_f32 v151, v66, v67
    v_cvt_pk_bf16_f32 v142, v108, v109
    v_cvt_pk_bf16_f32 v152, v68, v69
    v_cvt_pk_bf16_f32 v143, v110, v111
    v_cvt_pk_bf16_f32 v153, v70, v71
    v_cvt_pk_bf16_f32 v144, v112, v113
    v_cvt_pk_bf16_f32 v154, v72, v73
    v_cvt_pk_bf16_f32 v145, v114, v115
    v_cvt_pk_bf16_f32 v155, v74, v75
    v_cvt_pk_bf16_f32 v146, v116, v117
    v_cvt_pk_bf16_f32 v156, v76, v77
    v_cvt_pk_bf16_f32 v147, v118, v119
    v_cvt_pk_bf16_f32 v157, v78, v79
    v_cvt_pk_bf16_f32 v148, v120, v121
    v_cvt_pk_bf16_f32 v158, v80, v81
    v_cvt_pk_bf16_f32 v149, v122, v123
    v_cvt_pk_bf16_f32 v159, v82, v83
    s_lshl_b32 s57, s55, 4
    v_add_u32 v48, s57, v24
    v_mul_u32_u24 v48, 352, v48
    v_mul_u32_u24 v49, 80, v3
    v_add_u32 v48, v48, v49
    ds_write_b128 v48, v[140:143] offset:0
    ds_write_b128 v48, v[144:147] offset:16
    ds_write_b128 v48, v[148:151] offset:32
    ds_write_b128 v48, v[152:155] offset:48
    ds_write_b128 v48, v[156:159] offset:64
    s_waitcnt vmcnt(0) lgkmcnt(0)
    s_barrier
    s_cmp_eq_u32 s48, 0
    s_cbranch_scc0 K1_NQS
    s_lshl_b32 s57, s51, 7
    s_add_u32 s57, s57, 16277512
    v_mov_b32 v28, s57
    v_mov_b32 v29, 1
    s_mov_b64 exec, 1
    buffer_atomic_add v29, v28, s[32:35], 0 offen
    s_mov_b64 exec, -1
K1_NQS:
    s_lshr_b32 s58, s48, 1
    s_and_b32 s59, s48, 1
    v_lshl_add_u32 v28, v3, 2, v26
    v_mul_u32_u24 v29, 352, v28
    v_lshl_add_u32 v29, v27, 3, v29
    s_mul_i32 s57, s58, 80
    v_add_u32 v29, s57, v29
    v_mul_u32_u24 v30, 224, v28
    v_lshl_add_u32 v30, v27, 3, v30
    s_mul_i32 s57, s58, 48
    s_lshl_b32 s60, s59, 5
    s_add_u32 s57, s57, s60
    s_add_u32 s57, s57, 45056
    v_add_u32 v30, s57, v30
    ds_read_b64_tr_b16 v[168:169], v30 offset:0
    ds_read_b64_tr_b16 v[170:171], v30 offset:3584
    ds_read_b64_tr_b16 v[172:173], v29 offset:0
    ds_read_b64_tr_b16 v[174:175], v29 offset:5632
    ds_read_b64_tr_b16 v[176:177], v29 offset:32
    ds_read_b64_tr_b16 v[178:179], v29 offset:5664
    ds_read_b64_tr_b16 v[180:181], v29 offset:64
    ds_read_b64_tr_b16 v[182:183], v29 offset:5696
    ds_read_b64_tr_b16 v[184:185], v30 offset:7168
    ds_read_b64_tr_b16 v[186:187], v30 offset:10752
    ds_read_b64_tr_b16 v[188:189], v29 offset:11264
    ds_read_b64_tr_b16 v[190:191], v29 offset:16896
    ds_read_b64_tr_b16 v[192:193], v29 offset:11296
    ds_read_b64_tr_b16 v[194:195], v29 offset:16928
    ds_read_b64_tr_b16 v[196:197], v29 offset:11328
    ds_read_b64_tr_b16 v[198:199], v29 offset:16960
    ds_read_b64_tr_b16 v[200:201], v30 offset:14336
    ds_read_b64_tr_b16 v[202:203], v30 offset:17920
    ds_read_b64_tr_b16 v[204:205], v29 offset:22528
    ds_read_b64_tr_b16 v[206:207], v29 offset:28160
    ds_read_b64_tr_b16 v[208:209], v29 offset:22560
    ds_read_b64_tr_b16 v[210:211], v29 offset:28192
    ds_read_b64_tr_b16 v[212:213], v29 offset:22592
    ds_read_b64_tr_b16 v[214:215], v29 offset:28224
    ds_read_b64_tr_b16 v[216:217], v30 offset:21504
    ds_read_b64_tr_b16 v[218:219], v30 offset:25088
    ds_read_b64_tr_b16 v[220:221], v29 offset:33792
    ds_read_b64_tr_b16 v[222:223], v29 offset:39424
    ds_read_b64_tr_b16 v[224:225], v29 offset:33824
    ds_read_b64_tr_b16 v[226:227], v29 offset:39456
    ds_read_b64_tr_b16 v[228:229], v29 offset:33856
    ds_read_b64_tr_b16 v[230:231], v29 offset:39488
    s_lshl_b32 s57, s59, 4
    v_add_u32 v28, s57, v2
    v_lshrrev_b32 v29, 2, v28
    v_mul_u32_u24 v29, 2560, v29
    v_lshl_add_u32 v29, v3, 8, v29
    v_and_b32 v31, 3, v28
    v_lshl_add_u32 v29, v31, 4, v29
    s_lshl_b32 s57, s58, 6
    s_add_u32 s57, s57, 77824
    v_add_u32 v35, s57, v29
    v_lshlrev_b32 v30, 4, v1
    v_add_u32 v30, 93184, v30
    v_cmp_gt_u32 vcc, 21, v28
    s_nop 1
    v_cndmask_b32 v35, v30, v35, vcc
    v_cmp_gt_u32 vcc, 2, v3
    s_nop 1
    v_cndmask_b32 v36, v30, v35, vcc
    s_waitcnt lgkmcnt(15)
    v_mfma_f32_16x16x32_bf16 v[64:67], v[172:175], v[168:171], 0
    v_mfma_f32_16x16x32_bf16 v[68:71], v[176:179], v[168:171], 0
    v_mfma_f32_16x16x32_bf16 v[72:75], v[180:183], v[168:171], 0
    s_waitcnt lgkmcnt(15)
    v_mfma_f32_16x16x32_bf16 v[64:67], v[188:191], v[184:187], v[64:67]
    v_mfma_f32_16x16x32_bf16 v[68:71], v[192:195], v[184:187], v[68:71]
    v_mfma_f32_16x16x32_bf16 v[72:75], v[196:199], v[184:187], v[72:75]
    s_waitcnt lgkmcnt(8)
    v_mfma_f32_16x16x32_bf16 v[64:67], v[204:207], v[200:203], v[64:67]
    v_mfma_f32_16x16x32_bf16 v[68:71], v[208:211], v[200:203], v[68:71]
    v_mfma_f32_16x16x32_bf16 v[72:75], v[212:215], v[200:203], v[72:75]
    s_waitcnt lgkmcnt(0)
    v_mfma_f32_16x16x32_bf16 v[64:67], v[220:223], v[216:219], v[64:67]
    v_mfma_f32_16x16x32_bf16 v[68:71], v[224:227], v[216:219], v[68:71]
    v_mfma_f32_16x16x32_bf16 v[72:75], v[228:231], v[216:219], v[72:75]
    s_nop 5
    ds_write_b128 v35, v[64:67]
    ds_write_b128 v35, v[68:71] offset:1024
    ds_write_b128 v36, v[72:75] offset:2048
    s_mov_b32 s60, 0
    s_waitcnt vmcnt(0)
K1_POLL2:
    v_readfirstlane_b32 s57, v61
    s_nop 0
    s_cmp_lg_u32 s57, 0
    s_cbranch_scc1 K1_POLLDONE2
    s_add_u32 s60, s60, 1
    s_cmp_ge_u32 s60, 100000
    s_cbranch_scc1 K1_POLLDONE2
    buffer_load_dword v61, v60, s[44:47], 0 offen sc0 sc1
    s_waitcnt vmcnt(0)
    s_branch K1_POLL2
K1_POLLDONE2:
    s_waitcnt lgkmcnt(0)
    s_barrier
    v_lshlrev_b32 v24, 2, v0
    v_add_u32 v25, 77824, v24
    ds_read_b32 v28, v25 offset:0
    ds_read_b32 v29, v25 offset:2048
    ds_read_b32 v30, v25 offset:4096
    ds_read_b32 v31, v25 offset:6144
    ds_read_b32 v32, v25 offset:8192
    ds_read_b32 v33, v25 offset:10240
    ds_read_b32 v34, v25 offset:12288
    ds_read_b32 v35, v25 offset:14336
    v_lshrrev_b32 v40, 4, v24
    v_and_b32 v40, 3, v40
    v_mov_b32 v41, 1073741824
    v_cmp_eq_u32 vcc, 0, v40
    s_nop 1
    v_cndmask_b32 v42, v41, v24, vcc
    v_cmp_gt_u32 vcc, 512, v24
    s_nop 1
    v_cndmask_b32 v43, v42, v24, vcc
    s_waitcnt lgkmcnt(7)
    s_mov_b32 s57, 0
    buffer_atomic_add_f32 v28, v24, s[40:43], s57 offen
    s_waitcnt lgkmcnt(6)
    s_mov_b32 s57, 2048
    buffer_atomic_add_f32 v29, v24, s[40:43], s57 offen
    s_waitcnt lgkmcnt(5)
    s_mov_b32 s57, 4096
    buffer_atomic_add_f32 v30, v24, s[40:43], s57 offen
    s_waitcnt lgkmcnt(4)
    s_mov_b32 s57, 6144
    buffer_atomic_add_f32 v31, v24, s[40:43], s57 offen
    s_waitcnt lgkmcnt(3)
    s_mov_b32 s57, 8192
    buffer_atomic_add_f32 v32, v24, s[40:43], s57 offen
    s_waitcnt lgkmcnt(2)
    s_mov_b32 s57, 10240
    buffer_atomic_add_f32 v33, v24, s[40:43], s57 offen
    s_waitcnt lgkmcnt(1)
    s_mov_b32 s57, 12288
    buffer_atomic_add_f32 v34, v43, s[40:43], s57 offen
    s_waitcnt lgkmcnt(0)
    s_mov_b32 s57, 14336
    buffer_atomic_add_f32 v35, v42, s[40:43], s57 offen
    s_branch K1_P2
K1_T1:
    buffer_load_dwordx4 v[128:131], v14, s[24:27], 0 offen
    buffer_load_dwordx4 v[132:135], v14, s[24:27], 0 offen offset:16
    s_mov_b32 s57, 0
    buffer_load_dwordx2 v[136:137], v15, s[28:31], s57 offen
    s_add_u32 s57, s57, s63
    buffer_load_dwordx2 v[138:139], v15, s[28:31], s57 offen
    s_add_u32 s57, s57, s63
    buffer_load_dwordx2 v[140:141], v15, s[28:31], s57 offen
    s_add_u32 s57, s57, s63
    buffer_load_dwordx2 v[142:143], v15, s[28:31], s57 offen
    s_add_u32 s57, s57, s63
    buffer_load_dwordx2 v[144:145], v15, s[28:31], s57 offen
    s_add_u32 m0, s73, 0
    s_nop 0
    buffer_load_dwordx4 v4, s[28:31], s61 offen lds
    s_add_u32 m0, s73, 1024
    s_nop 0
    buffer_load_dwordx4 v5, s[28:31], s61 offen lds
    s_cmp_gt_i32 s75, 2
    s_cselect_b64 exec, -1, 1
    s_cselect_b32 s57, s73, 152576
    s_add_u32 m0, s57, 2048
    s_nop 0
    buffer_load_dwordx4 v6, s[28:31], s61 offen lds
    s_mov_b64 exec, -1
    s_cmp_gt_i32 s75, 3
    s_cselect_b64 exec, -1, 1
    s_cselect_b32 s57, s73, 151552
    s_add_u32 m0, s57, 3072
    s_nop 0
    buffer_load_dwordx4 v7, s[28:31], s61 offen lds
    s_mov_b64 exec, -1
    s_add_u32 s61, s61, s56
    s_add_u32 m0, s74, 0
    s_nop 0
    buffer_load_dwordx4 v9, s[24:27], s60 offen lds
    s_add_u32 m0, s74, 1024
    s_nop 0
    buffer_load_dwordx4 v10, s[24:27], s60 offen lds
    s_add_u32 s60, s60, 128
    s_barrier
    s_add_u32 m0, s73, 51200
    s_nop 0
    buffer_load_dwordx4 v4, s[28:31], s61 offen lds
    s_add_u32 m0, s73, 52224
    s_nop 0
    buffer_load_dwordx4 v5, s[28:31], s61 offen lds
    s_cmp_gt_i32 s75, 2
    s_cselect_b64 exec, -1, 1
    s_cselect_b32 s57, s73, 101376
    s_add_u32 m0, s57, 53248
    s_nop 0
    buffer_load_dwordx4 v6, s[28:31], s61 offen lds
    s_mov_b64 exec, -1
    s_cmp_gt_i32 s75, 3
    s_cselect_b64 exec, -1, 1
    s_cselect_b32 s57, s73, 100352
    s_add_u32 m0, s57, 54272
    s_nop 0
    buffer_load_dwordx4 v7, s[28:31], s61 offen lds
    s_mov_b64 exec, -1
    s_add_u32 s61, s61, s56
    s_add_u32 m0, s74, 51200
    s_nop 0
    buffer_load_dwordx4 v9, s[24:27], s60 offen lds
    s_add_u32 m0, s74, 52224
    s_nop 0
    buffer_load_dwordx4 v10, s[24:27], s60 offen lds
    s_add_u32 s60, s60, 128
    s_waitcnt vmcnt(12)
    v_lshlrev_b32 v148, 16, v136
    v_and_b32 v149, 0xffff0000, v136
    v_lshlrev_b32 v150, 16, v137
    v_and_b32 v151, 0xffff0000, v137
    v_lshlrev_b32 v152, 16, v138
    v_and_b32 v153, 0xffff0000, v138
    v_lshlrev_b32 v154, 16, v139
    v_and_b32 v155, 0xffff0000, v139
    v_lshlrev_b32 v156, 16, v140
    v_and_b32 v157, 0xffff0000, v140
    v_lshlrev_b32 v158, 16, v141
    v_and_b32 v159, 0xffff0000, v141
    v_lshlrev_b32 v160, 16, v142
    v_and_b32 v161, 0xffff0000, v142
    v_lshlrev_b32 v162, 16, v143
    v_and_b32 v163, 0xffff0000, v143
    v_lshlrev_b32 v164, 16, v144
    v_and_b32 v165, 0xffff0000, v144
    v_lshlrev_b32 v166, 16, v145
    v_and_b32 v167, 0xffff0000, v145
    v_pk_add_f32 v[148:149], v[148:149], v[152:153]
    v_pk_add_f32 v[150:151], v[150:151], v[154:155]
    v_pk_add_f32 v[148:149], v[148:149], v[156:157]
    v_pk_add_f32 v[150:151], v[150:151], v[158:159]
    v_pk_add_f32 v[148:149], v[148:149], v[160:161]
    v_pk_add_f32 v[150:151], v[150:151], v[162:163]
    v_pk_add_f32 v[148:149], v[148:149], v[164:165]
    v_pk_add_f32 v[150:151], v[150:151], v[166:167]
    v_lshlrev_b32 v24, 4, v0
    v_add_u32 v24, 155648, v24
    ds_write_b128 v24, v[148:151]
    v_lshlrev_b32 v168, 16, v128
    v_and_b32 v169, 0xffff0000, v128
    v_lshlrev_b32 v170, 16, v129
    v_and_b32 v171, 0xffff0000, v129
    v_lshlrev_b32 v172, 16, v130
    v_and_b32 v173, 0xffff0000, v130
    v_lshlrev_b32 v174, 16, v131
    v_and_b32 v175, 0xffff0000, v131
    v_lshlrev_b32 v176, 16, v132
    v_and_b32 v177, 0xffff0000, v132
    v_lshlrev_b32 v178, 16, v133
    v_and_b32 v179, 0xffff0000, v133
    v_lshlrev_b32 v180, 16, v134
    v_and_b32 v181, 0xffff0000, v134
    v_lshlrev_b32 v182, 16, v135
    v_and_b32 v183, 0xffff0000, v135
    v_pk_add_f32 v[184:185], v[168:169], v[170:171]
    v_pk_add_f32 v[184:185], v[184:185], v[172:173]
    v_pk_add_f32 v[184:185], v[184:185], v[174:175]
    v_pk_add_f32 v[184:185], v[184:185], v[176:177]
    v_pk_add_f32 v[184:185], v[184:185], v[178:179]
    v_pk_add_f32 v[184:185], v[184:185], v[180:181]
    v_pk_add_f32 v[184:185], v[184:185], v[182:183]
    v_add_f32 v184, v184, v185
    s_nop 1
    v_add_f32_dpp v184, v184, v184 row_shr:1 row_mask:0xf bank_mask:0xf bound_ctrl:0
    s_nop 1
    v_add_f32_dpp v184, v184, v184 row_shr:2 row_mask:0xf bank_mask:0xf bound_ctrl:0
    s_nop 1
    v_add_f32_dpp v184, v184, v184 row_shr:4 row_mask:0xf bank_mask:0xf bound_ctrl:0
    s_nop 1
    v_add_f32_dpp v184, v184, v184 row_shr:8 row_mask:0xf bank_mask:0xf bound_ctrl:0
    s_nop 1
    v_add_f32_dpp v184, v184, v184 row_bcast:15 row_mask:0xa bank_mask:0xf
    s_nop 1
    v_add_f32_dpp v184, v184, v184 row_bcast:31 row_mask:0xc bank_mask:0xf
    s_nop 0
    v_readlane_b32 s57, v184, 63
    v_mov_b32 v186, 0x3acccccd
    s_nop 0
    v_mul_f32 v186, s57, v186
    v_mov_b32 v184, 0
    v_mov_b32 v185, 0
    s_mov_b32 exec_hi, 0xff
    v_pk_add_f32 v[168:169], v[168:169], v[186:187] op_sel_hi:[1,0] neg_lo:[0,1] neg_hi:[0,1]
    v_pk_add_f32 v[170:171], v[170:171], v[186:187] op_sel_hi:[1,0] neg_lo:[0,1] neg_hi:[0,1]
    v_pk_add_f32 v[172:173], v[172:173], v[186:187] op_sel_hi:[1,0] neg_lo:[0,1] neg_hi:[0,1]
    v_pk_add_f32 v[174:175], v[174:175], v[186:187] op_sel_hi:[1,0] neg_lo:[0,1] neg_hi:[0,1]
    v_pk_add_f32 v[176:177], v[176:177], v[186:187] op_sel_hi:[1,0] neg_lo:[0,1] neg_hi:[0,1]
    v_pk_add_f32 v[178:179], v[178:179], v[186:187] op_sel_hi:[1,0] neg_lo:[0,1] neg_hi:[0,1]
    v_pk_add_f32 v[180:181], v[180:181], v[186:187] op_sel_hi:[1,0] neg_lo:[0,1] neg_hi:[0,1]
    v_pk_add_f32 v[182:183], v[182:183], v[186:187] op_sel_hi:[1,0] neg_lo:[0,1] neg_hi:[0,1]
    v_pk_fma_f32 v[184:185], v[168:169], v[168:169], v[184:185]
    v_pk_fma_f32 v[184:185], v[170:171], v[170:171], v[184:185]
    v_pk_fma_f32 v[184:185], v[172:173], v[172:173], v[184:185]
    v_pk_fma_f32 v[184:185], v[174:175], v[174:175], v[184:185]
    v_pk_fma_f32 v[184:185], v[176:177], v[176:177], v[184:185]
    v_pk_fma_f32 v[184:185], v[178:179], v[178:179], v[184:185]
    v_pk_fma_f32 v[184:185], v[180:181], v[180:181], v[184:185]
    v_pk_fma_f32 v[184:185], v[182:183], v[182:183], v[184:185]
    s_mov_b64 exec, -1
    v_add_f32 v184, v184, v185
    s_nop 1
    v_add_f32_dpp v184, v184, v184 row_shr:1 row_mask:0xf bank_mask:0xf bound_ctrl:0
    s_nop 1
    v_add_f32_dpp v184, v184, v184 row_shr:2 row_mask:0xf bank_mask:0xf bound_ctrl:0
    s_nop 1
    v_add_f32_dpp v184, v184, v184 row_shr:4 row_mask:0xf bank_mask:0xf bound_ctrl:0
    s_nop 1
    v_add_f32_dpp v184, v184, v184 row_shr:8 row_mask:0xf bank_mask:0xf bound_ctrl:0
    s_nop 1
    v_add_f32_dpp v184, v184, v184 row_bcast:15 row_mask:0xa bank_mask:0xf
    s_nop 1
    v_add_f32_dpp v184, v184, v184 row_bcast:31 row_mask:0xc bank_mask:0xf
    s_nop 0
    v_readlane_b32 s57, v184, 63
    v_mov_b32 v187, 0x3acccccd
    s_nop 0
    v_mul_f32 v187, s57, v187
    v_cvt_pk_bf16_f32 v186, v186, v186
    v_lshlrev_b32 v186, 16, v186
    v_cvt_pk_bf16_f32 v187, v187, v187
    v_lshlrev_b32 v187, 16, v187
    v_add_f32 v187, 0x3727c5ac, v187
    v_cvt_pk_bf16_f32 v187, v187, v187
    v_lshlrev_b32 v187, 16, v187
    v_sqrt_f32 v187, v187
    s_nop 0
    v_cvt_pk_bf16_f32 v187, v187, v187
    v_lshlrev_b32 v187, 16, v187
    v_rcp_f32 v187, v187
    s_lshl_b32 s57, s49, 3
    s_add_u32 s57, s57, 15998976
    v_mov_b32 v24, 0
    s_mov_b64 exec, 1
    buffer_store_dwordx2 v[186:187], v24, s[32:35], s57 offen sc0 sc1
    s_mov_b64 exec, -1
    buffer_load_dwordx4 v[252:255], v16, s[36:39], 0 offen
    s_waitcnt vmcnt(8) lgkmcnt(0)
    s_barrier
    s_cmp_eq_u32 s48, 7
    s_cbranch_scc0 K1_NCP1
    v_lshlrev_b32 v24, 4, v1
    v_add_u32 v25, 155648, v24
    ds_read_b128 v[168:171], v25 offset:0
    ds_read_b128 v[172:175], v25 offset:1024
    ds_read_b128 v[176:179], v25 offset:2048
    ds_read_b128 v[180:183], v25 offset:3072
    ds_read_b128 v[184:187], v25 offset:4096
    ds_read_b128 v[188:191], v25 offset:5120
    ds_read_b128 v[192:195], v25 offset:6144
    ds_read_b128 v[196:199], v25 offset:7168
    s_waitcnt lgkmcnt(0)
    v_pk_add_f32 v[168:169], v[168:169], v[172:173]
    v_pk_add_f32 v[170:171], v[170:171], v[174:175]
    v_pk_add_f32 v[168:169], v[168:169], v[176:177]
    v_pk_add_f32 v[170:171], v[170:171], v[178:179]
    v_pk_add_f32 v[168:169], v[168:169], v[180:181]
    v_pk_add_f32 v[170:171], v[170:171], v[182:183]
    v_pk_add_f32 v[168:169], v[168:169], v[184:185]
    v_pk_add_f32 v[170:171], v[170:171], v[186:187]
    v_pk_add_f32 v[168:169], v[168:169], v[188:189]
    v_pk_add_f32 v[170:171], v[170:171], v[190:191]
    v_pk_add_f32 v[168:169], v[168:169], v[192:193]
    v_pk_add_f32 v[170:171], v[170:171], v[194:195]
    v_pk_add_f32 v[168:169], v[168:169], v[196:197]
    v_pk_add_f32 v[170:171], v[170:171], v[198:199]
    s_lshl_b32 s57, s71, 4
    s_add_u32 s57, s57, s51
    s_lshl_b32 s57, s57, 10
    s_add_u32 s57, s57, 16015360
    buffer_store_dwordx4 v[168:171], v24, s[32:35], s57 offen sc0 sc1
    s_nop 1
K1_NCP1:
    ds_read_b128 v[128:131], v228
    ds_read_b128 v[132:135], v228 offset:2048
    ds_read_b64_tr_b16 v[136:137], v230 offset:0
    ds_read_b64_tr_b16 v[138:139], v231 offset:0
    ds_read_b64_tr_b16 v[140:141], v230 offset:8
    ds_read_b64_tr_b16 v[142:143], v231 offset:8
    ds_read_b64_tr_b16 v[144:145], v230 offset:16
    ds_read_b64_tr_b16 v[146:147], v231 offset:16
    ds_read_b64_tr_b16 v[148:149], v230 offset:24
    ds_read_b64_tr_b16 v[150:151], v231 offset:24
    ds_read_b64_tr_b16 v[152:153], v230 offset:32
    ds_read_b64_tr_b16 v[154:155], v231 offset:32
    ds_read_b64_tr_b16 v[156:157], v230 offset:344
    ds_read_b64_tr_b16 v[158:159], v231 offset:344
    ds_read_b64_tr_b16 v[160:161], v230 offset:352
    ds_read_b64_tr_b16 v[162:163], v231 offset:352
    s_waitcnt lgkmcnt(0)
    v_mfma_f32_16x16x32_bf16 v[64:67], v[136:139], v[128:131], 0
    ds_read_b128 v[168:171], v229
    ds_read_b128 v[172:175], v229 offset:2048
    s_add_u32 m0, s73, 102400
    s_nop 0
    buffer_load_dwordx4 v4, s[28:31], s61 offen lds
    v_mfma_f32_16x16x32_bf16 v[68:71], v[136:139], v[132:135], 0
    ds_read_b64_tr_b16 v[176:177], v230 offset:15360
    ds_read_b64_tr_b16 v[178:179], v231 offset:15360
    s_add_u32 m0, s73, 103424
    s_nop 0
    buffer_load_dwordx4 v5, s[28:31], s61 offen lds
    v_mfma_f32_16x16x32_bf16 v[72:75], v[140:143], v[128:131], 0
    ds_read_b64_tr_b16 v[180:181], v230 offset:15368
    ds_read_b64_tr_b16 v[182:183], v231 offset:15368
    s_cmp_gt_i32 s75, 2
    s_cselect_b64 exec, -1, 1
    s_cselect_b32 s57, s73, 50176
    s_add_u32 m0, s57, 104448
    s_nop 0
    buffer_load_dwordx4 v6, s[28:31], s61 offen lds
    s_mov_b64 exec, -1
    v_mfma_f32_16x16x32_bf16 v[76:79], v[140:143], v[132:135], 0
    ds_read_b64_tr_b16 v[184:185], v230 offset:15376
    ds_read_b64_tr_b16 v[186:187], v231 offset:15376
    s_cmp_gt_i32 s75, 3
    s_cselect_b64 exec, -1, 1
    s_cselect_b32 s57, s73, 49152
    s_add_u32 m0, s57, 105472
    s_nop 0
    buffer_load_dwordx4 v7, s[28:31], s61 offen lds
    s_mov_b64 exec, -1
    s_add_u32 s61, s61, s56
    v_mfma_f32_16x16x32_bf16 v[80:83], v[144:147], v[128:131], 0
    ds_read_b64_tr_b16 v[188:189], v230 offset:15384
    ds_read_b64_tr_b16 v[190:191], v231 offset:15384
    s_add_u32 m0, s74, 102400
    s_nop 0
    buffer_load_dwordx4 v9, s[24:27], s60 offen lds
    v_mfma_f32_16x16x32_bf16 v[84:87], v[144:147], v[132:135], 0
    ds_read_b64_tr_b16 v[192:193], v230 offset:15392
    ds_read_b64_tr_b16 v[194:195], v231 offset:15392
    s_add_u32 m0, s74, 103424
    s_nop 0
    buffer_load_dwordx4 v10, s[24:27], s60 offen lds
    s_add_u32 s60, s60, 128
    v_mfma_f32_16x16x32_bf16 v[88:91], v[148:151], v[128:131], 0
    ds_read_b64_tr_b16 v[196:197], v230 offset:15704
    ds_read_b64_tr_b16 v[198:199], v231 offset:15704
    ds_read_b64_tr_b16 v[200:201], v230 offset:15712
    v_mfma_f32_16x16x32_bf16 v[92:95], v[148:151], v[132:135], 0
    ds_read_b64_tr_b16 v[202:203], v231 offset:15712
    v_mfma_f32_16x16x32_bf16 v[96:99], v[152:155], v[128:131], 0
    v_mfma_f32_16x16x32_bf16 v[100:103], v[152:155], v[132:135], 0
    v_mfma_f32_16x16x32_bf16 v[104:107], v[156:159], v[128:131], 0
    v_mfma_f32_16x16x32_bf16 v[108:111], v[156:159], v[132:135], 0
    v_mfma_f32_16x16x32_bf16 v[112:115], v[160:163], v[128:131], 0
    v_mfma_f32_16x16x32_bf16 v[116:119], v[160:163], v[132:135], 0
    s_waitcnt vmcnt(8) lgkmcnt(0)
    s_barrier
    v_mfma_f32_16x16x32_bf16 v[64:67], v[176:179], v[168:171], v[64:67]
    ds_read_b128 v[128:131], v232
    ds_read_b128 v[132:135], v232 offset:2048
    s_add_u32 m0, s73, 0
    s_nop 0
    buffer_load_dwordx4 v4, s[28:31], s61 offen lds
    v_mfma_f32_16x16x32_bf16 v[68:71], v[176:179], v[172:175], v[68:71]
    ds_read_b64_tr_b16 v[136:137], v234 offset:0
    ds_read_b64_tr_b16 v[138:139], v235 offset:0
    s_add_u32 m0, s73, 1024
    s_nop 0
    buffer_load_dwordx4 v5, s[28:31], s61 offen lds
    v_mfma_f32_16x16x32_bf16 v[72:75], v[180:183], v[168:171], v[72:75]
    ds_read_b64_tr_b16 v[140:141], v234 offset:8
    ds_read_b64_tr_b16 v[142:143], v235 offset:8
    s_cmp_gt_i32 s75, 2
    s_cselect_b64 exec, -1, 1
    s_cselect_b32 s57, s73, 152576
    s_add_u32 m0, s57, 2048
    s_nop 0
    buffer_load_dwordx4 v6, s[28:31], s61 offen lds
    s_mov_b64 exec, -1
    v_mfma_f32_16x16x32_bf16 v[76:79], v[180:183], v[172:175], v[76:79]
    ds_read_b64_tr_b16 v[144:145], v234 offset:16
    ds_read_b64_tr_b16 v[146:147], v235 offset:16
    s_cmp_gt_i32 s75, 3
    s_cselect_b64 exec, -1, 1
    s_cselect_b32 s57, s73, 151552
    s_add_u32 m0, s57, 3072
    s_nop 0
    buffer_load_dwordx4 v7, s[28:31], s61 offen lds
    s_mov_b64 exec, -1
    s_add_u32 s61, s61, s56
    v_mfma_f32_16x16x32_bf16 v[80:83], v[184:187], v[168:171], v[80:83]
    ds_read_b64_tr_b16 v[148:149], v234 offset:24
    ds_read_b64_tr_b16 v[150:151], v235 offset:24
    s_add_u32 m0, s74, 0
    s_nop 0
    buffer_load_dwordx4 v9, s[24:27], s60 offen lds
    v_mfma_f32_16x16x32_bf16 v[84:87], v[184:187], v[172:175], v[84:87]
    ds_read_b64_tr_b16 v[152:153], v234 offset:32
    ds_read_b64_tr_b16 v[154:155], v235 offset:32
    s_add_u32 m0, s74, 1024
    s_nop 0
    buffer_load_dwordx4 v10, s[24:27], s60 offen lds
    s_add_u32 s60, s60, 128
    v_mfma_f32_16x16x32_bf16 v[88:91], v[188:191], v[168:171], v[88:91]
    ds_read_b64_tr_b16 v[156:157], v234 offset:344
    ds_read_b64_tr_b16 v[158:159], v235 offset:344
    ds_read_b64_tr_b16 v[160:161], v234 offset:352
    v_mfma_f32_16x16x32_bf16 v[92:95], v[188:191], v[172:175], v[92:95]
    ds_read_b64_tr_b16 v[162:163], v235 offset:352
    v_mfma_f32_16x16x32_bf16 v[96:99], v[192:195], v[168:171], v[96:99]
    v_mfma_f32_16x16x32_bf16 v[100:103], v[192:195], v[172:175], v[100:103]
    v_mfma_f32_16x16x32_bf16 v[104:107], v[196:199], v[168:171], v[104:107]
    v_mfma_f32_16x16x32_bf16 v[108:111], v[196:199], v[172:175], v[108:111]
    v_mfma_f32_16x16x32_bf16 v[112:115], v[200:203], v[168:171], v[112:115]
    v_mfma_f32_16x16x32_bf16 v[116:119], v[200:203], v[172:175], v[116:119]
    s_waitcnt lgkmcnt(0)
    v_mfma_f32_16x16x32_bf16 v[64:67], v[136:139], v[128:131], v[64:67]
    ds_read_b128 v[168:171], v233
    ds_read_b128 v[172:175], v233 offset:2048
    v_mfma_f32_16x16x32_bf16 v[68:71], v[136:139], v[132:135], v[68:71]
    ds_read_b64_tr_b16 v[176:177], v234 offset:15360
    ds_read_b64_tr_b16 v[178:179], v235 offset:15360
    v_mfma_f32_16x16x32_bf16 v[72:75], v[140:143], v[128:131], v[72:75]
    ds_read_b64_tr_b16 v[180:181], v234 offset:15368
    ds_read_b64_tr_b16 v[182:183], v235 offset:15368
    v_mfma_f32_16x16x32_bf16 v[76:79], v[140:143], v[132:135], v[76:79]
    ds_read_b64_tr_b16 v[184:185], v234 offset:15376
    ds_read_b64_tr_b16 v[186:187], v235 offset:15376
    v_mfma_f32_16x16x32_bf16 v[80:83], v[144:147], v[128:131], v[80:83]
    ds_read_b64_tr_b16 v[188:189], v234 offset:15384
    ds_read_b64_tr_b16 v[190:191], v235 offset:15384
    v_mfma_f32_16x16x32_bf16 v[84:87], v[144:147], v[132:135], v[84:87]
    ds_read_b64_tr_b16 v[192:193], v234 offset:15392
    ds_read_b64_tr_b16 v[194:195], v235 offset:15392
    v_mfma_f32_16x16x32_bf16 v[88:91], v[148:151], v[128:131], v[88:91]
    ds_read_b64_tr_b16 v[196:197], v234 offset:15704
    ds_read_b64_tr_b16 v[198:199], v235 offset:15704
    v_mfma_f32_16x16x32_bf16 v[92:95], v[148:151], v[132:135], v[92:95]
    ds_read_b64_tr_b16 v[200:201], v234 offset:15712
    ds_read_b64_tr_b16 v[202:203], v235 offset:15712
    v_mfma_f32_16x16x32_bf16 v[96:99], v[152:155], v[128:131], v[96:99]
    v_mfma_f32_16x16x32_bf16 v[100:103], v[152:155], v[132:135], v[100:103]
    v_mfma_f32_16x16x32_bf16 v[104:107], v[156:159], v[128:131], v[104:107]
    v_mfma_f32_16x16x32_bf16 v[108:111], v[156:159], v[132:135], v[108:111]
    v_mfma_f32_16x16x32_bf16 v[112:115], v[160:163], v[128:131], v[112:115]
    v_mfma_f32_16x16x32_bf16 v[116:119], v[160:163], v[132:135], v[116:119]
    s_waitcnt vmcnt(6) lgkmcnt(0)
    s_barrier
    v_mfma_f32_16x16x32_bf16 v[64:67], v[176:179], v[168:171], v[64:67]
    ds_read_b128 v[128:131], v236
    ds_read_b128 v[132:135], v236 offset:2048
    s_add_u32 m0, s73, 51200
    s_nop 0
    buffer_load_dwordx4 v4, s[28:31], s61 offen lds
    v_mfma_f32_16x16x32_bf16 v[68:71], v[176:179], v[172:175], v[68:71]
    ds_read_b64_tr_b16 v[136:137], v238 offset:0
    ds_read_b64_tr_b16 v[138:139], v239 offset:0
    s_add_u32 m0, s73, 52224
    s_nop 0
    buffer_load_dwordx4 v5, s[28:31], s61 offen lds
    v_mfma_f32_16x16x32_bf16 v[72:75], v[180:183], v[168:171], v[72:75]
    ds_read_b64_tr_b16 v[140:141], v238 offset:8
    ds_read_b64_tr_b16 v[142:143], v239 offset:8
    s_cmp_gt_i32 s75, 2
    s_cselect_b64 exec, -1, 1
    s_cselect_b32 s57, s73, 101376
    s_add_u32 m0, s57, 53248
    s_nop 0
    buffer_load_dwordx4 v6, s[28:31], s61 offen lds
    s_mov_b64 exec, -1
    v_mfma_f32_16x16x32_bf16 v[76:79], v[180:183], v[172:175], v[76:79]
    ds_read_b64_tr_b16 v[144:145], v238 offset:16
    ds_read_b64_tr_b16 v[146:147], v239 offset:16
    s_cmp_gt_i32 s75, 3
    s_cselect_b64 exec, -1, 1
    s_cselect_b32 s57, s73, 100352
    s_add_u32 m0, s57, 54272
    s_nop 0
    buffer_load_dwordx4 v7, s[28:31], s61 offen lds
    s_mov_b64 exec, -1
    s_add_u32 s61, s61, s56
    v_mfma_f32_16x16x32_bf16 v[80:83], v[184:187], v[168:171], v[80:83]
    ds_read_b64_tr_b16 v[148:149], v238 offset:24
    ds_read_b64_tr_b16 v[150:151], v239 offset:24
    s_add_u32 m0, s74, 51200
    s_nop 0
    buffer_load_dwordx4 v9, s[24:27], s60 offen lds
    v_mfma_f32_16x16x32_bf16 v[84:87], v[184:187], v[172:175], v[84:87]
    ds_read_b64_tr_b16 v[152:153], v238 offset:32
    ds_read_b64_tr_b16 v[154:155], v239 offset:32
    s_add_u32 m0, s74, 52224
    s_nop 0
    buffer_load_dwordx4 v10, s[24:27], s60 offen lds
    s_add_u32 s60, s60, 128
    v_mfma_f32_16x16x32_bf16 v[88:91], v[188:191], v[168:171], v[88:91]
    ds_read_b64_tr_b16 v[156:157], v238 offset:344
    ds_read_b64_tr_b16 v[158:159], v239 offset:344
    ds_read_b64_tr_b16 v[160:161], v238 offset:352
    v_mfma_f32_16x16x32_bf16 v[92:95], v[188:191], v[172:175], v[92:95]
    ds_read_b64_tr_b16 v[162:163], v239 offset:352
    v_mfma_f32_16x16x32_bf16 v[96:99], v[192:195], v[168:171], v[96:99]
    v_mfma_f32_16x16x32_bf16 v[100:103], v[192:195], v[172:175], v[100:103]
    v_mfma_f32_16x16x32_bf16 v[104:107], v[196:199], v[168:171], v[104:107]
    v_mfma_f32_16x16x32_bf16 v[108:111], v[196:199], v[172:175], v[108:111]
    v_mfma_f32_16x16x32_bf16 v[112:115], v[200:203], v[168:171], v[112:115]
    v_mfma_f32_16x16x32_bf16 v[116:119], v[200:203], v[172:175], v[116:119]
    s_waitcnt lgkmcnt(0)
    v_mfma_f32_16x16x32_bf16 v[64:67], v[136:139], v[128:131], v[64:67]
    ds_read_b128 v[168:171], v237
    ds_read_b128 v[172:175], v237 offset:2048
    v_mfma_f32_16x16x32_bf16 v[68:71], v[136:139], v[132:135], v[68:71]
    ds_read_b64_tr_b16 v[176:177], v238 offset:15360
    ds_read_b64_tr_b16 v[178:179], v239 offset:15360
    v_mfma_f32_16x16x32_bf16 v[72:75], v[140:143], v[128:131], v[72:75]
    ds_read_b64_tr_b16 v[180:181], v238 offset:15368
    ds_read_b64_tr_b16 v[182:183], v239 offset:15368
    v_mfma_f32_16x16x32_bf16 v[76:79], v[140:143], v[132:135], v[76:79]
    ds_read_b64_tr_b16 v[184:185], v238 offset:15376
    ds_read_b64_tr_b16 v[186:187], v239 offset:15376
    v_mfma_f32_16x16x32_bf16 v[80:83], v[144:147], v[128:131], v[80:83]
    ds_read_b64_tr_b16 v[188:189], v238 offset:15384
    ds_read_b64_tr_b16 v[190:191], v239 offset:15384
    v_mfma_f32_16x16x32_bf16 v[84:87], v[144:147], v[132:135], v[84:87]
    ds_read_b64_tr_b16 v[192:193], v238 offset:15392
    ds_read_b64_tr_b16 v[194:195], v239 offset:15392
    v_mfma_f32_16x16x32_bf16 v[88:91], v[148:151], v[128:131], v[88:91]
    ds_read_b64_tr_b16 v[196:197], v238 offset:15704
    ds_read_b64_tr_b16 v[198:199], v239 offset:15704
    v_mfma_f32_16x16x32_bf16 v[92:95], v[148:151], v[132:135], v[92:95]
    ds_read_b64_tr_b16 v[200:201], v238 offset:15712
    ds_read_b64_tr_b16 v[202:203], v239 offset:15712
    v_mfma_f32_16x16x32_bf16 v[96:99], v[152:155], v[128:131], v[96:99]
    v_mfma_f32_16x16x32_bf16 v[100:103], v[152:155], v[132:135], v[100:103]
    v_mfma_f32_16x16x32_bf16 v[104:107], v[156:159], v[128:131], v[104:107]
    v_mfma_f32_16x16x32_bf16 v[108:111], v[156:159], v[132:135], v[108:111]
    v_mfma_f32_16x16x32_bf16 v[112:115], v[160:163], v[128:131], v[112:115]
    v_mfma_f32_16x16x32_bf16 v[116:119], v[160:163], v[132:135], v[116:119]
    s_waitcnt vmcnt(6) lgkmcnt(0)
    s_barrier
    v_mfma_f32_16x16x32_bf16 v[64:67], v[176:179], v[168:171], v[64:67]
    ds_read_b128 v[128:131], v228
    ds_read_b128 v[132:135], v228 offset:2048
    s_add_u32 m0, s73, 102400
    s_nop 0
    buffer_load_dwordx4 v4, s[28:31], s61 offen lds
    v_mfma_f32_16x16x32_bf16 v[68:71], v[176:179], v[172:175], v[68:71]
    ds_read_b64_tr_b16 v[136:137], v230 offset:0
    ds_read_b64_tr_b16 v[138:139], v231 offset:0
    s_add_u32 m0, s73, 103424
    s_nop 0
    buffer_load_dwordx4 v5, s[28:31], s61 offen lds
    v_mfma_f32_16x16x32_bf16 v[72:75], v[180:183], v[168:171], v[72:75]
    ds_read_b64_tr_b16 v[140:141], v230 offset:8
    ds_read_b64_tr_b16 v[142:143], v231 offset:8
    s_cmp_gt_i32 s75, 2
    s_cselect_b64 exec, -1, 1
    s_cselect_b32 s57, s73, 50176
    s_add_u32 m0, s57, 104448
    s_nop 0
    buffer_load_dwordx4 v6, s[28:31], s61 offen lds
    s_mov_b64 exec, -1
    v_mfma_f32_16x16x32_bf16 v[76:79], v[180:183], v[172:175], v[76:79]
    ds_read_b64_tr_b16 v[144:145], v230 offset:16
    ds_read_b64_tr_b16 v[146:147], v231 offset:16
    s_cmp_gt_i32 s75, 3
    s_cselect_b64 exec, -1, 1
    s_cselect_b32 s57, s73, 49152
    s_add_u32 m0, s57, 105472
    s_nop 0
    buffer_load_dwordx4 v7, s[28:31], s61 offen lds
    s_mov_b64 exec, -1
    s_add_u32 s61, s61, s56
    v_mfma_f32_16x16x32_bf16 v[80:83], v[184:187], v[168:171], v[80:83]
    ds_read_b64_tr_b16 v[148:149], v230 offset:24
    ds_read_b64_tr_b16 v[150:151], v231 offset:24
    s_add_u32 m0, s74, 102400
    s_nop 0
    buffer_load_dwordx4 v9, s[24:27], s60 offen lds
    v_mfma_f32_16x16x32_bf16 v[84:87], v[184:187], v[172:175], v[84:87]
    ds_read_b64_tr_b16 v[152:153], v230 offset:32
    ds_read_b64_tr_b16 v[154:155], v231 offset:32
    s_add_u32 m0, s74, 103424
    s_nop 0
    buffer_load_dwordx4 v10, s[24:27], s60 offen lds
    s_add_u32 s60, s60, 128
    v_mfma_f32_16x16x32_bf16 v[88:91], v[188:191], v[168:171], v[88:91]
    ds_read_b64_tr_b16 v[156:157], v230 offset:344
    ds_read_b64_tr_b16 v[158:159], v231 offset:344
    ds_read_b64_tr_b16 v[160:161], v230 offset:352
    v_mfma_f32_16x16x32_bf16 v[92:95], v[188:191], v[172:175], v[92:95]
    ds_read_b64_tr_b16 v[162:163], v231 offset:352
    v_mfma_f32_16x16x32_bf16 v[96:99], v[192:195], v[168:171], v[96:99]
    v_mfma_f32_16x16x32_bf16 v[100:103], v[192:195], v[172:175], v[100:103]
    v_mfma_f32_16x16x32_bf16 v[104:107], v[196:199], v[168:171], v[104:107]
    s_cmp_eq_u32 s48, 0
    s_cbranch_scc0 K1_NSG1
    s_lshl_b32 s57, s51, 2
    s_add_u32 s57, s57, 64
    v_mov_b32 v24, s57
    s_lshl_b32 s57, s71, 2
    s_add_u32 s57, s57, 128
    v_mov_b32 v26, s57
    v_mov_b32 v25, 1
    s_mov_b64 exec, 1
    buffer_atomic_add v25, v24, s[44:47], 0 offen
    buffer_atomic_add v25, v26, s[44:47], 0 offen
    s_mov_b64 exec, -1
K1_NSG1:
    v_mfma_f32_16x16x32_bf16 v[108:111], v[196:199], v[172:175], v[108:111]
    v_mfma_f32_16x16x32_bf16 v[112:115], v[200:203], v[168:171], v[112:115]
    v_mfma_f32_16x16x32_bf16 v[116:119], v[200:203], v[172:175], v[116:119]
    s_waitcnt lgkmcnt(0)
    v_mfma_f32_16x16x32_bf16 v[64:67], v[136:139], v[128:131], v[64:67]
    ds_read_b128 v[168:171], v229
    ds_read_b128 v[172:175], v229 offset:2048
    v_mfma_f32_16x16x32_bf16 v[68:71], v[136:139], v[132:135], v[68:71]
    ds_read_b64_tr_b16 v[176:177], v230 offset:15360
    ds_read_b64_tr_b16 v[178:179], v231 offset:15360
    v_mfma_f32_16x16x32_bf16 v[72:75], v[140:143], v[128:131], v[72:75]
    ds_read_b64_tr_b16 v[180:181], v230 offset:15368
    ds_read_b64_tr_b16 v[182:183], v231 offset:15368
    v_mfma_f32_16x16x32_bf16 v[76:79], v[140:143], v[132:135], v[76:79]
    ds_read_b64_tr_b16 v[184:185], v230 offset:15376
    ds_read_b64_tr_b16 v[186:187], v231 offset:15376
    v_mfma_f32_16x16x32_bf16 v[80:83], v[144:147], v[128:131], v[80:83]
    ds_read_b64_tr_b16 v[188:189], v230 offset:15384
    ds_read_b64_tr_b16 v[190:191], v231 offset:15384
    v_mfma_f32_16x16x32_bf16 v[84:87], v[144:147], v[132:135], v[84:87]
    ds_read_b64_tr_b16 v[192:193], v230 offset:15392
    ds_read_b64_tr_b16 v[194:195], v231 offset:15392
    v_mfma_f32_16x16x32_bf16 v[88:91], v[148:151], v[128:131], v[88:91]
    ds_read_b64_tr_b16 v[196:197], v230 offset:15704
    ds_read_b64_tr_b16 v[198:199], v231 offset:15704
    v_mfma_f32_16x16x32_bf16 v[92:95], v[148:151], v[132:135], v[92:95]
    ds_read_b64_tr_b16 v[200:201], v230 offset:15712
    ds_read_b64_tr_b16 v[202:203], v231 offset:15712
    v_mfma_f32_16x16x32_bf16 v[96:99], v[152:155], v[128:131], v[96:99]
    v_mfma_f32_16x16x32_bf16 v[100:103], v[152:155], v[132:135], v[100:103]
    v_mfma_f32_16x16x32_bf16 v[104:107], v[156:159], v[128:131], v[104:107]
    v_mfma_f32_16x16x32_bf16 v[108:111], v[156:159], v[132:135], v[108:111]
    v_mfma_f32_16x16x32_bf16 v[112:115], v[160:163], v[128:131], v[112:115]
    v_mfma_f32_16x16x32_bf16 v[116:119], v[160:163], v[132:135], v[116:119]
    s_waitcnt vmcnt(6) lgkmcnt(0)
    s_barrier
    v_mfma_f32_16x16x32_bf16 v[64:67], v[176:179], v[168:171], v[64:67]
    ds_read_b128 v[128:131], v232
    ds_read_b128 v[132:135], v232 offset:2048
    s_add_u32 m0, s73, 0
    s_nop 0
    buffer_load_dwordx4 v4, s[28:31], s61 offen lds
    v_mfma_f32_16x16x32_bf16 v[68:71], v[176:179], v[172:175], v[68:71]
    ds_read_b64_tr_b16 v[136:137], v234 offset:0
    ds_read_b64_tr_b16 v[138:139], v235 offset:0
    s_add_u32 m0, s73, 1024
    s_nop 0
    buffer_load_dwordx4 v5, s[28:31], s61 offen lds
    v_mfma_f32_16x16x32_bf16 v[72:75], v[180:183], v[168:171], v[72:75]
    ds_read_b64_tr_b16 v[140:141], v234 offset:8
    ds_read_b64_tr_b16 v[142:143], v235 offset:8
    s_cmp_gt_i32 s75, 2
    s_cselect_b64 exec, -1, 1
    s_cselect_b32 s57, s73, 152576
    s_add_u32 m0, s57, 2048
    s_nop 0
    buffer_load_dwordx4 v6, s[28:31], s61 offen lds
    s_mov_b64 exec, -1
    v_mfma_f32_16x16x32_bf16 v[76:79], v[180:183], v[172:175], v[76:79]
    ds_read_b64_tr_b16 v[144:145], v234 offset:16
    ds_read_b64_tr_b16 v[146:147], v235 offset:16
    s_cmp_gt_i32 s75, 3
    s_cselect_b64 exec, -1, 1
    s_cselect_b32 s57, s73, 151552
    s_add_u32 m0, s57, 3072
    s_nop 0
    buffer_load_dwordx4 v7, s[28:31], s61 offen lds
    s_mov_b64 exec, -1
    s_add_u32 s61, s61, s56
    v_mfma_f32_16x16x32_bf16 v[80:83], v[184:187], v[168:171], v[80:83]
    ds_read_b64_tr_b16 v[148:149], v234 offset:24
    ds_read_b64_tr_b16 v[150:151], v235 offset:24
    s_add_u32 m0, s74, 0
    s_nop 0
    buffer_load_dwordx4 v9, s[24:27], s60 offen lds
    v_mfma_f32_16x16x32_bf16 v[84:87], v[184:187], v[172:175], v[84:87]
    ds_read_b64_tr_b16 v[152:153], v234 offset:32
    ds_read_b64_tr_b16 v[154:155], v235 offset:32
    s_add_u32 m0, s74, 1024
    s_nop 0
    buffer_load_dwordx4 v10, s[24:27], s60 offen lds
    s_add_u32 s60, s60, 128
    v_mfma_f32_16x16x32_bf16 v[88:91], v[188:191], v[168:171], v[88:91]
    ds_read_b64_tr_b16 v[156:157], v234 offset:344
    ds_read_b64_tr_b16 v[158:159], v235 offset:344
    ds_read_b64_tr_b16 v[160:161], v234 offset:352
    v_mfma_f32_16x16x32_bf16 v[92:95], v[188:191], v[172:175], v[92:95]
    ds_read_b64_tr_b16 v[162:163], v235 offset:352
    v_mfma_f32_16x16x32_bf16 v[96:99], v[192:195], v[168:171], v[96:99]
    v_mfma_f32_16x16x32_bf16 v[100:103], v[192:195], v[172:175], v[100:103]
    v_mfma_f32_16x16x32_bf16 v[104:107], v[196:199], v[168:171], v[104:107]
    v_mfma_f32_16x16x32_bf16 v[108:111], v[196:199], v[172:175], v[108:111]
    v_mfma_f32_16x16x32_bf16 v[112:115], v[200:203], v[168:171], v[112:115]
    v_mfma_f32_16x16x32_bf16 v[116:119], v[200:203], v[172:175], v[116:119]
    s_waitcnt lgkmcnt(0)
    v_mfma_f32_16x16x32_bf16 v[64:67], v[136:139], v[128:131], v[64:67]
    ds_read_b128 v[168:171], v233
    ds_read_b128 v[172:175], v233 offset:2048
    v_mfma_f32_16x16x32_bf16 v[68:71], v[136:139], v[132:135], v[68:71]
    ds_read_b64_tr_b16 v[176:177], v234 offset:15360
    ds_read_b64_tr_b16 v[178:179], v235 offset:15360
    v_mfma_f32_16x16x32_bf16 v[72:75], v[140:143], v[128:131], v[72:75]
    ds_read_b64_tr_b16 v[180:181], v234 offset:15368
    ds_read_b64_tr_b16 v[182:183], v235 offset:15368
    v_mfma_f32_16x16x32_bf16 v[76:79], v[140:143], v[132:135], v[76:79]
    ds_read_b64_tr_b16 v[184:185], v234 offset:15376
    ds_read_b64_tr_b16 v[186:187], v235 offset:15376
    v_mfma_f32_16x16x32_bf16 v[80:83], v[144:147], v[128:131], v[80:83]
    ds_read_b64_tr_b16 v[188:189], v234 offset:15384
    ds_read_b64_tr_b16 v[190:191], v235 offset:15384
    v_mfma_f32_16x16x32_bf16 v[84:87], v[144:147], v[132:135], v[84:87]
    ds_read_b64_tr_b16 v[192:193], v234 offset:15392
    ds_read_b64_tr_b16 v[194:195], v235 offset:15392
    v_mfma_f32_16x16x32_bf16 v[88:91], v[148:151], v[128:131], v[88:91]
    ds_read_b64_tr_b16 v[196:197], v234 offset:15704
    ds_read_b64_tr_b16 v[198:199], v235 offset:15704
    v_mfma_f32_16x16x32_bf16 v[92:95], v[148:151], v[132:135], v[92:95]
    ds_read_b64_tr_b16 v[200:201], v234 offset:15712
    ds_read_b64_tr_b16 v[202:203], v235 offset:15712
    v_mfma_f32_16x16x32_bf16 v[96:99], v[152:155], v[128:131], v[96:99]
    v_mfma_f32_16x16x32_bf16 v[100:103], v[152:155], v[132:135], v[100:103]
    v_mfma_f32_16x16x32_bf16 v[104:107], v[156:159], v[128:131], v[104:107]
    v_mfma_f32_16x16x32_bf16 v[108:111], v[156:159], v[132:135], v[108:111]
    v_mfma_f32_16x16x32_bf16 v[112:115], v[160:163], v[128:131], v[112:115]
    v_mfma_f32_16x16x32_bf16 v[116:119], v[160:163], v[132:135], v[116:119]
    s_waitcnt vmcnt(6) lgkmcnt(0)
    s_barrier
    v_mfma_f32_16x16x32_bf16 v[64:67], v[176:179], v[168:171], v[64:67]
    ds_read_b128 v[128:131], v236
    ds_read_b128 v[132:135], v236 offset:2048
    s_add_u32 m0, s73, 51200
    s_nop 0
    buffer_load_dwordx4 v4, s[28:31], s61 offen lds
    v_mfma_f32_16x16x32_bf16 v[68:71], v[176:179], v[172:175], v[68:71]
    ds_read_b64_tr_b16 v[136:137], v238 offset:0
    ds_read_b64_tr_b16 v[138:139], v239 offset:0
    s_add_u32 m0, s73, 52224
    s_nop 0
    buffer_load_dwordx4 v5, s[28:31], s61 offen lds
    v_mfma_f32_16x16x32_bf16 v[72:75], v[180:183], v[168:171], v[72:75]
    ds_read_b64_tr_b16 v[140:141], v238 offset:8
    ds_read_b64_tr_b16 v[142:143], v239 offset:8
    s_cmp_gt_i32 s75, 2
    s_cselect_b64 exec, -1, 1
    s_cselect_b32 s57, s73, 101376
    s_add_u32 m0, s57, 53248
    s_nop 0
    buffer_load_dwordx4 v6, s[28:31], s61 offen lds
    s_mov_b64 exec, -1
    v_mfma_f32_16x16x32_bf16 v[76:79], v[180:183], v[172:175], v[76:79]
    ds_read_b64_tr_b16 v[144:145], v238 offset:16
    ds_read_b64_tr_b16 v[146:147], v239 offset:16
    s_cmp_gt_i32 s75, 3
    s_cselect_b64 exec, -1, 1
    s_cselect_b32 s57, s73, 100352
    s_add_u32 m0, s57, 54272
    s_nop 0
    buffer_load_dwordx4 v7, s[28:31], s61 offen lds
    s_mov_b64 exec, -1
    s_add_u32 s61, s61, s56
    v_mfma_f32_16x16x32_bf16 v[80:83], v[184:187], v[168:171], v[80:83]
    ds_read_b64_tr_b16 v[148:149], v238 offset:24
    ds_read_b64_tr_b16 v[150:151], v239 offset:24
    s_add_u32 m0, s74, 51200
    s_nop 0
    buffer_load_dwordx4 v9, s[24:27], s60 offen lds
    v_mfma_f32_16x16x32_bf16 v[84:87], v[184:187], v[172:175], v[84:87]
    ds_read_b64_tr_b16 v[152:153], v238 offset:32
    ds_read_b64_tr_b16 v[154:155], v239 offset:32
    s_add_u32 m0, s74, 52224
    s_nop 0
    buffer_load_dwordx4 v10, s[24:27], s60 offen lds
    s_add_u32 s60, s60, 128
    v_mfma_f32_16x16x32_bf16 v[88:91], v[188:191], v[168:171], v[88:91]
    ds_read_b64_tr_b16 v[156:157], v238 offset:344
    ds_read_b64_tr_b16 v[158:159], v239 offset:344
    ds_read_b64_tr_b16 v[160:161], v238 offset:352
    v_mfma_f32_16x16x32_bf16 v[92:95], v[188:191], v[172:175], v[92:95]
    ds_read_b64_tr_b16 v[162:163], v239 offset:352
    v_mfma_f32_16x16x32_bf16 v[96:99], v[192:195], v[168:171], v[96:99]
    v_mfma_f32_16x16x32_bf16 v[100:103], v[192:195], v[172:175], v[100:103]
    v_mfma_f32_16x16x32_bf16 v[104:107], v[196:199], v[168:171], v[104:107]
    v_mfma_f32_16x16x32_bf16 v[108:111], v[196:199], v[172:175], v[108:111]
    v_mfma_f32_16x16x32_bf16 v[112:115], v[200:203], v[168:171], v[112:115]
    v_mfma_f32_16x16x32_bf16 v[116:119], v[200:203], v[172:175], v[116:119]
    s_waitcnt lgkmcnt(0)
    v_mfma_f32_16x16x32_bf16 v[64:67], v[136:139], v[128:131], v[64:67]
    ds_read_b128 v[168:171], v237
    ds_read_b128 v[172:175], v237 offset:2048
    v_mfma_f32_16x16x32_bf16 v[68:71], v[136:139], v[132:135], v[68:71]
    ds_read_b64_tr_b16 v[176:177], v238 offset:15360
    ds_read_b64_tr_b16 v[178:179], v239 offset:15360
    v_mfma_f32_16x16x32_bf16 v[72:75], v[140:143], v[128:131], v[72:75]
    ds_read_b64_tr_b16 v[180:181], v238 offset:15368
    ds_read_b64_tr_b16 v[182:183], v239 offset:15368
    v_mfma_f32_16x16x32_bf16 v[76:79], v[140:143], v[132:135], v[76:79]
    ds_read_b64_tr_b16 v[184:185], v238 offset:15376
    ds_read_b64_tr_b16 v[186:187], v239 offset:15376
    v_mfma_f32_16x16x32_bf16 v[80:83], v[144:147], v[128:131], v[80:83]
    ds_read_b64_tr_b16 v[188:189], v238 offset:15384
    ds_read_b64_tr_b16 v[190:191], v239 offset:15384
    v_mfma_f32_16x16x32_bf16 v[84:87], v[144:147], v[132:135], v[84:87]
    ds_read_b64_tr_b16 v[192:193], v238 offset:15392
    ds_read_b64_tr_b16 v[194:195], v239 offset:15392
    v_mfma_f32_16x16x32_bf16 v[88:91], v[148:151], v[128:131], v[88:91]
    ds_read_b64_tr_b16 v[196:197], v238 offset:15704
    ds_read_b64_tr_b16 v[198:199], v239 offset:15704
    v_mfma_f32_16x16x32_bf16 v[92:95], v[148:151], v[132:135], v[92:95]
    ds_read_b64_tr_b16 v[200:201], v238 offset:15712
    ds_read_b64_tr_b16 v[202:203], v239 offset:15712
    v_mfma_f32_16x16x32_bf16 v[96:99], v[152:155], v[128:131], v[96:99]
    v_mfma_f32_16x16x32_bf16 v[100:103], v[152:155], v[132:135], v[100:103]
    v_mfma_f32_16x16x32_bf16 v[104:107], v[156:159], v[128:131], v[104:107]
    v_mfma_f32_16x16x32_bf16 v[108:111], v[156:159], v[132:135], v[108:111]
    v_mfma_f32_16x16x32_bf16 v[112:115], v[160:163], v[128:131], v[112:115]
    v_mfma_f32_16x16x32_bf16 v[116:119], v[160:163], v[132:135], v[116:119]
    s_waitcnt vmcnt(6) lgkmcnt(0)
    s_barrier
    v_mfma_f32_16x16x32_bf16 v[64:67], v[176:179], v[168:171], v[64:67]
    ds_read_b128 v[128:131], v228
    ds_read_b128 v[132:135], v228 offset:2048
    s_add_u32 m0, s73, 102400
    s_nop 0
    buffer_load_dwordx4 v4, s[28:31], s61 offen lds
    v_mfma_f32_16x16x32_bf16 v[68:71], v[176:179], v[172:175], v[68:71]
    ds_read_b64_tr_b16 v[136:137], v230 offset:0
    ds_read_b64_tr_b16 v[138:139], v231 offset:0
    s_add_u32 m0, s73, 103424
    s_nop 0
    buffer_load_dwordx4 v5, s[28:31], s61 offen lds
    v_mfma_f32_16x16x32_bf16 v[72:75], v[180:183], v[168:171], v[72:75]
    ds_read_b64_tr_b16 v[140:141], v230 offset:8
    ds_read_b64_tr_b16 v[142:143], v231 offset:8
    s_cmp_gt_i32 s75, 2
    s_cselect_b64 exec, -1, 1
    s_cselect_b32 s57, s73, 50176
    s_add_u32 m0, s57, 104448
    s_nop 0
    buffer_load_dwordx4 v6, s[28:31], s61 offen lds
    s_mov_b64 exec, -1
    v_mfma_f32_16x16x32_bf16 v[76:79], v[180:183], v[172:175], v[76:79]
    ds_read_b64_tr_b16 v[144:145], v230 offset:16
    ds_read_b64_tr_b16 v[146:147], v231 offset:16
    s_cmp_gt_i32 s75, 3
    s_cselect_b64 exec, -1, 1
    s_cselect_b32 s57, s73, 49152
    s_add_u32 m0, s57, 105472
    s_nop 0
    buffer_load_dwordx4 v7, s[28:31], s61 offen lds
    s_mov_b64 exec, -1
    s_add_u32 s61, s61, s56
    v_mfma_f32_16x16x32_bf16 v[80:83], v[184:187], v[168:171], v[80:83]
    ds_read_b64_tr_b16 v[148:149], v230 offset:24
    ds_read_b64_tr_b16 v[150:151], v231 offset:24
    s_add_u32 m0, s74, 102400
    s_nop 0
    buffer_load_dwordx4 v9, s[24:27], s60 offen lds
    v_mfma_f32_16x16x32_bf16 v[84:87], v[184:187], v[172:175], v[84:87]
    ds_read_b64_tr_b16 v[152:153], v230 offset:32
    ds_read_b64_tr_b16 v[154:155], v231 offset:32
    s_add_u32 m0, s74, 103424
    s_nop 0
    buffer_load_dwordx4 v10, s[24:27], s60 offen lds
    s_add_u32 s60, s60, 128
    v_mfma_f32_16x16x32_bf16 v[88:91], v[188:191], v[168:171], v[88:91]
    ds_read_b64_tr_b16 v[156:157], v230 offset:344
    ds_read_b64_tr_b16 v[158:159], v231 offset:344
    ds_read_b64_tr_b16 v[160:161], v230 offset:352
    v_mfma_f32_16x16x32_bf16 v[92:95], v[188:191], v[172:175], v[92:95]
    ds_read_b64_tr_b16 v[162:163], v231 offset:352
    v_mfma_f32_16x16x32_bf16 v[96:99], v[192:195], v[168:171], v[96:99]
    v_mfma_f32_16x16x32_bf16 v[100:103], v[192:195], v[172:175], v[100:103]
    v_mfma_f32_16x16x32_bf16 v[104:107], v[196:199], v[168:171], v[104:107]
    v_mfma_f32_16x16x32_bf16 v[108:111], v[196:199], v[172:175], v[108:111]
    v_mfma_f32_16x16x32_bf16 v[112:115], v[200:203], v[168:171], v[112:115]
    v_mfma_f32_16x16x32_bf16 v[116:119], v[200:203], v[172:175], v[116:119]
    s_waitcnt lgkmcnt(0)
    v_mfma_f32_16x16x32_bf16 v[64:67], v[136:139], v[128:131], v[64:67]
    ds_read_b128 v[168:171], v229
    ds_read_b128 v[172:175], v229 offset:2048
    v_mfma_f32_16x16x32_bf16 v[68:71], v[136:139], v[132:135], v[68:71]
    ds_read_b64_tr_b16 v[176:177], v230 offset:15360
    ds_read_b64_tr_b16 v[178:179], v231 offset:15360
    v_mfma_f32_16x16x32_bf16 v[72:75], v[140:143], v[128:131], v[72:75]
    ds_read_b64_tr_b16 v[180:181], v230 offset:15368
    ds_read_b64_tr_b16 v[182:183], v231 offset:15368
    v_mfma_f32_16x16x32_bf16 v[76:79], v[140:143], v[132:135], v[76:79]
    ds_read_b64_tr_b16 v[184:185], v230 offset:15376
    ds_read_b64_tr_b16 v[186:187], v231 offset:15376
    v_mfma_f32_16x16x32_bf16 v[80:83], v[144:147], v[128:131], v[80:83]
    ds_read_b64_tr_b16 v[188:189], v230 offset:15384
    ds_read_b64_tr_b16 v[190:191], v231 offset:15384
    v_mfma_f32_16x16x32_bf16 v[84:87], v[144:147], v[132:135], v[84:87]
    ds_read_b64_tr_b16 v[192:193], v230 offset:15392
    ds_read_b64_tr_b16 v[194:195], v231 offset:15392
    v_mfma_f32_16x16x32_bf16 v[88:91], v[148:151], v[128:131], v[88:91]
    ds_read_b64_tr_b16 v[196:197], v230 offset:15704
    ds_read_b64_tr_b16 v[198:199], v231 offset:15704
    v_mfma_f32_16x16x32_bf16 v[92:95], v[148:151], v[132:135], v[92:95]
    ds_read_b64_tr_b16 v[200:201], v230 offset:15712
    ds_read_b64_tr_b16 v[202:203], v231 offset:15712
    v_mfma_f32_16x16x32_bf16 v[96:99], v[152:155], v[128:131], v[96:99]
    v_mfma_f32_16x16x32_bf16 v[100:103], v[152:155], v[132:135], v[100:103]
    v_mfma_f32_16x16x32_bf16 v[104:107], v[156:159], v[128:131], v[104:107]
    v_mfma_f32_16x16x32_bf16 v[108:111], v[156:159], v[132:135], v[108:111]
    v_mfma_f32_16x16x32_bf16 v[112:115], v[160:163], v[128:131], v[112:115]
    v_mfma_f32_16x16x32_bf16 v[116:119], v[160:163], v[132:135], v[116:119]
    s_waitcnt vmcnt(6) lgkmcnt(0)
    s_barrier
    v_mfma_f32_16x16x32_bf16 v[64:67], v[176:179], v[168:171], v[64:67]
    ds_read_b128 v[128:131], v232
    ds_read_b128 v[132:135], v232 offset:2048
    s_add_u32 m0, s73, 0
    s_nop 0
    buffer_load_dwordx4 v4, s[28:31], s61 offen lds
    v_mfma_f32_16x16x32_bf16 v[68:71], v[176:179], v[172:175], v[68:71]
    ds_read_b64_tr_b16 v[136:137], v234 offset:0
    ds_read_b64_tr_b16 v[138:139], v235 offset:0
    s_add_u32 m0, s73, 1024
    s_nop 0
    buffer_load_dwordx4 v5, s[28:31], s61 offen lds
    v_mfma_f32_16x16x32_bf16 v[72:75], v[180:183], v[168:171], v[72:75]
    ds_read_b64_tr_b16 v[140:141], v234 offset:8
    ds_read_b64_tr_b16 v[142:143], v235 offset:8
    s_cmp_gt_i32 s75, 2
    s_cselect_b64 exec, -1, 1
    s_cselect_b32 s57, s73, 152576
    s_add_u32 m0, s57, 2048
    s_nop 0
    buffer_load_dwordx4 v6, s[28:31], s61 offen lds
    s_mov_b64 exec, -1
    v_mfma_f32_16x16x32_bf16 v[76:79], v[180:183], v[172:175], v[76:79]
    ds_read_b64_tr_b16 v[144:145], v234 offset:16
    ds_read_b64_tr_b16 v[146:147], v235 offset:16
    s_cmp_gt_i32 s75, 3
    s_cselect_b64 exec, -1, 1
    s_cselect_b32 s57, s73, 151552
    s_add_u32 m0, s57, 3072
    s_nop 0
    buffer_load_dwordx4 v7, s[28:31], s61 offen lds
    s_mov_b64 exec, -1
    s_add_u32 s61, s61, s56
    v_mfma_f32_16x16x32_bf16 v[80:83], v[184:187], v[168:171], v[80:83]
    ds_read_b64_tr_b16 v[148:149], v234 offset:24
    ds_read_b64_tr_b16 v[150:151], v235 offset:24
    s_add_u32 m0, s74, 0
    s_nop 0
    buffer_load_dwordx4 v9, s[24:27], s60 offen lds
    v_mfma_f32_16x16x32_bf16 v[84:87], v[184:187], v[172:175], v[84:87]
    ds_read_b64_tr_b16 v[152:153], v234 offset:32
    ds_read_b64_tr_b16 v[154:155], v235 offset:32
    s_add_u32 m0, s74, 1024
    s_nop 0
    buffer_load_dwordx4 v10, s[24:27], s60 offen lds
    s_add_u32 s60, s60, 128
    v_mfma_f32_16x16x32_bf16 v[88:91], v[188:191], v[168:171], v[88:91]
    ds_read_b64_tr_b16 v[156:157], v234 offset:344
    ds_read_b64_tr_b16 v[158:159], v235 offset:344
    ds_read_b64_tr_b16 v[160:161], v234 offset:352
    v_mfma_f32_16x16x32_bf16 v[92:95], v[188:191], v[172:175], v[92:95]
    ds_read_b64_tr_b16 v[162:163], v235 offset:352
    v_mfma_f32_16x16x32_bf16 v[96:99], v[192:195], v[168:171], v[96:99]
    v_mfma_f32_16x16x32_bf16 v[100:103], v[192:195], v[172:175], v[100:103]
    v_mfma_f32_16x16x32_bf16 v[104:107], v[196:199], v[168:171], v[104:107]
    v_mfma_f32_16x16x32_bf16 v[108:111], v[196:199], v[172:175], v[108:111]
    v_mfma_f32_16x16x32_bf16 v[112:115], v[200:203], v[168:171], v[112:115]
    v_mfma_f32_16x16x32_bf16 v[116:119], v[200:203], v[172:175], v[116:119]
    s_waitcnt lgkmcnt(0)
    v_mfma_f32_16x16x32_bf16 v[64:67], v[136:139], v[128:131], v[64:67]
    ds_read_b128 v[168:171], v233
    ds_read_b128 v[172:175], v233 offset:2048
    v_mfma_f32_16x16x32_bf16 v[68:71], v[136:139], v[132:135], v[68:71]
    ds_read_b64_tr_b16 v[176:177], v234 offset:15360
    ds_read_b64_tr_b16 v[178:179], v235 offset:15360
    v_mfma_f32_16x16x32_bf16 v[72:75], v[140:143], v[128:131], v[72:75]
    ds_read_b64_tr_b16 v[180:181], v234 offset:15368
    ds_read_b64_tr_b16 v[182:183], v235 offset:15368
    v_mfma_f32_16x16x32_bf16 v[76:79], v[140:143], v[132:135], v[76:79]
    ds_read_b64_tr_b16 v[184:185], v234 offset:15376
    ds_read_b64_tr_b16 v[186:187], v235 offset:15376
    v_mfma_f32_16x16x32_bf16 v[80:83], v[144:147], v[128:131], v[80:83]
    ds_read_b64_tr_b16 v[188:189], v234 offset:15384
    ds_read_b64_tr_b16 v[190:191], v235 offset:15384
    v_mfma_f32_16x16x32_bf16 v[84:87], v[144:147], v[132:135], v[84:87]
    ds_read_b64_tr_b16 v[192:193], v234 offset:15392
    ds_read_b64_tr_b16 v[194:195], v235 offset:15392
    v_mfma_f32_16x16x32_bf16 v[88:91], v[148:151], v[128:131], v[88:91]
    ds_read_b64_tr_b16 v[196:197], v234 offset:15704
    ds_read_b64_tr_b16 v[198:199], v235 offset:15704
    v_mfma_f32_16x16x32_bf16 v[92:95], v[148:151], v[132:135], v[92:95]
    ds_read_b64_tr_b16 v[200:201], v234 offset:15712
    ds_read_b64_tr_b16 v[202:203], v235 offset:15712
    v_mfma_f32_16x16x32_bf16 v[96:99], v[152:155], v[128:131], v[96:99]
    v_mfma_f32_16x16x32_bf16 v[100:103], v[152:155], v[132:135], v[100:103]
    v_mfma_f32_16x16x32_bf16 v[104:107], v[156:159], v[128:131], v[104:107]
    v_mfma_f32_16x16x32_bf16 v[108:111], v[156:159], v[132:135], v[108:111]
    v_mfma_f32_16x16x32_bf16 v[112:115], v[160:163], v[128:131], v[112:115]
    v_mfma_f32_16x16x32_bf16 v[116:119], v[160:163], v[132:135], v[116:119]
    s_waitcnt vmcnt(6) lgkmcnt(0)
    s_barrier
    v_mfma_f32_16x16x32_bf16 v[64:67], v[176:179], v[168:171], v[64:67]
    ds_read_b128 v[128:131], v236
    ds_read_b128 v[132:135], v236 offset:2048
    v_mfma_f32_16x16x32_bf16 v[68:71], v[176:179], v[172:175], v[68:71]
    ds_read_b64_tr_b16 v[136:137], v238 offset:0
    ds_read_b64_tr_b16 v[138:139], v239 offset:0
    v_mfma_f32_16x16x32_bf16 v[72:75], v[180:183], v[168:171], v[72:75]
    ds_read_b64_tr_b16 v[140:141], v238 offset:8
    ds_read_b64_tr_b16 v[142:143], v239 offset:8
    v_mfma_f32_16x16x32_bf16 v[76:79], v[180:183], v[172:175], v[76:79]
    ds_read_b64_tr_b16 v[144:145], v238 offset:16
    ds_read_b64_tr_b16 v[146:147], v239 offset:16
    v_mfma_f32_16x16x32_bf16 v[80:83], v[184:187], v[168:171], v[80:83]
    ds_read_b64_tr_b16 v[148:149], v238 offset:24
    ds_read_b64_tr_b16 v[150:151], v239 offset:24
    v_mfma_f32_16x16x32_bf16 v[84:87], v[184:187], v[172:175], v[84:87]
    ds_read_b64_tr_b16 v[152:153], v238 offset:32
    ds_read_b64_tr_b16 v[154:155], v239 offset:32
    v_mfma_f32_16x16x32_bf16 v[88:91], v[188:191], v[168:171], v[88:91]
    ds_read_b64_tr_b16 v[156:157], v238 offset:344
    ds_read_b64_tr_b16 v[158:159], v239 offset:344
    v_mfma_f32_16x16x32_bf16 v[92:95], v[188:191], v[172:175], v[92:95]
    ds_read_b64_tr_b16 v[160:161], v238 offset:352
    ds_read_b64_tr_b16 v[162:163], v239 offset:352
    v_mfma_f32_16x16x32_bf16 v[96:99], v[192:195], v[168:171], v[96:99]
    v_mfma_f32_16x16x32_bf16 v[100:103], v[192:195], v[172:175], v[100:103]
    v_mfma_f32_16x16x32_bf16 v[104:107], v[196:199], v[168:171], v[104:107]
    v_mov_b32 v17, 0
    buffer_load_dword v17, v17, s[44:47], 0 offen sc0 sc1
    s_lshl_b32 s57, s51, 2
    s_add_u32 s57, s57, 64
    v_mov_b32 v56, s57
    s_lshl_b32 s57, s71, 2
    s_add_u32 s57, s57, 128
    v_mov_b32 v57, s57
    buffer_load_dword v58, v56, s[44:47], 0 offen sc0 sc1
    buffer_load_dword v59, v57, s[44:47], 0 offen sc0 sc1
    v_mfma_f32_16x16x32_bf16 v[108:111], v[196:199], v[172:175], v[108:111]
    v_mfma_f32_16x16x32_bf16 v[112:115], v[200:203], v[168:171], v[112:115]
    v_mfma_f32_16x16x32_bf16 v[116:119], v[200:203], v[172:175], v[116:119]
    s_waitcnt lgkmcnt(0)
    v_mfma_f32_16x16x32_bf16 v[64:67], v[136:139], v[128:131], v[64:67]
    ds_read_b128 v[168:171], v237
    ds_read_b128 v[172:175], v237 offset:2048
    v_mfma_f32_16x16x32_bf16 v[68:71], v[136:139], v[132:135], v[68:71]
    ds_read_b64_tr_b16 v[176:177], v238 offset:15360
    ds_read_b64_tr_b16 v[178:179], v239 offset:15360
    v_mfma_f32_16x16x32_bf16 v[72:75], v[140:143], v[128:131], v[72:75]
    ds_read_b64_tr_b16 v[180:181], v238 offset:15368
    ds_read_b64_tr_b16 v[182:183], v239 offset:15368
    v_mfma_f32_16x16x32_bf16 v[76:79], v[140:143], v[132:135], v[76:79]
    ds_read_b64_tr_b16 v[184:185], v238 offset:15376
    ds_read_b64_tr_b16 v[186:187], v239 offset:15376
    v_mfma_f32_16x16x32_bf16 v[80:83], v[144:147], v[128:131], v[80:83]
    ds_read_b64_tr_b16 v[188:189], v238 offset:15384
    ds_read_b64_tr_b16 v[190:191], v239 offset:15384
    v_mfma_f32_16x16x32_bf16 v[84:87], v[144:147], v[132:135], v[84:87]
    ds_read_b64_tr_b16 v[192:193], v238 offset:15392
    ds_read_b64_tr_b16 v[194:195], v239 offset:15392
    v_mfma_f32_16x16x32_bf16 v[88:91], v[148:151], v[128:131], v[88:91]
    ds_read_b64_tr_b16 v[196:197], v238 offset:15704
    ds_read_b64_tr_b16 v[198:199], v239 offset:15704
    v_mfma_f32_16x16x32_bf16 v[92:95], v[148:151], v[132:135], v[92:95]
    ds_read_b64_tr_b16 v[200:201], v238 offset:15712
    ds_read_b64_tr_b16 v[202:203], v239 offset:15712
    v_mfma_f32_16x16x32_bf16 v[96:99], v[152:155], v[128:131], v[96:99]
    v_mfma_f32_16x16x32_bf16 v[100:103], v[152:155], v[132:135], v[100:103]
    v_mfma_f32_16x16x32_bf16 v[104:107], v[156:159], v[128:131], v[104:107]
    v_mfma_f32_16x16x32_bf16 v[108:111], v[156:159], v[132:135], v[108:111]
    v_mfma_f32_16x16x32_bf16 v[112:115], v[160:163], v[128:131], v[112:115]
    v_mfma_f32_16x16x32_bf16 v[116:119], v[160:163], v[132:135], v[116:119]
    s_waitcnt vmcnt(0) lgkmcnt(0)
    s_barrier
    v_mfma_f32_16x16x32_bf16 v[64:67], v[176:179], v[168:171], v[64:67]
    ds_read_b128 v[128:131], v228
    ds_read_b128 v[132:135], v228 offset:2048
    v_mfma_f32_16x16x32_bf16 v[68:71], v[176:179], v[172:175], v[68:71]
    ds_read_b64_tr_b16 v[136:137], v230 offset:0
    ds_read_b64_tr_b16 v[138:139], v231 offset:0
    v_mfma_f32_16x16x32_bf16 v[72:75], v[180:183], v[168:171], v[72:75]
    ds_read_b64_tr_b16 v[140:141], v230 offset:8
    ds_read_b64_tr_b16 v[142:143], v231 offset:8
    v_mfma_f32_16x16x32_bf16 v[76:79], v[180:183], v[172:175], v[76:79]
    ds_read_b64_tr_b16 v[144:145], v230 offset:16
    ds_read_b64_tr_b16 v[146:147], v231 offset:16
    v_mfma_f32_16x16x32_bf16 v[80:83], v[184:187], v[168:171], v[80:83]
    ds_read_b64_tr_b16 v[148:149], v230 offset:24
    ds_read_b64_tr_b16 v[150:151], v231 offset:24
    v_mfma_f32_16x16x32_bf16 v[84:87], v[184:187], v[172:175], v[84:87]
    ds_read_b64_tr_b16 v[152:153], v230 offset:32
    ds_read_b64_tr_b16 v[154:155], v231 offset:32
    v_mfma_f32_16x16x32_bf16 v[88:91], v[188:191], v[168:171], v[88:91]
    ds_read_b64_tr_b16 v[156:157], v230 offset:344
    ds_read_b64_tr_b16 v[158:159], v231 offset:344
    v_mfma_f32_16x16x32_bf16 v[92:95], v[188:191], v[172:175], v[92:95]
    ds_read_b64_tr_b16 v[160:161], v230 offset:352
    ds_read_b64_tr_b16 v[162:163], v231 offset:352
    v_mfma_f32_16x16x32_bf16 v[96:99], v[192:195], v[168:171], v[96:99]
    v_mfma_f32_16x16x32_bf16 v[100:103], v[192:195], v[172:175], v[100:103]
    v_mfma_f32_16x16x32_bf16 v[104:107], v[196:199], v[168:171], v[104:107]
    s_mov_b32 s60, 0
    s_waitcnt vmcnt(0)
K1_PS1:
    v_readfirstlane_b32 s57, v58
    v_readfirstlane_b32 s61, v59
    s_and_b32 s57, s57, 0xff
    s_min_u32 s57, s57, s61
    s_cmp_ge_u32 s57, 16
    s_cbranch_scc1 K1_PSD1
    s_add_u32 s60, s60, 1
    s_cmp_ge_u32 s60, 100000
    s_cbranch_scc1 K1_PSD1
    s_sleep 8
    buffer_load_dword v58, v56, s[44:47], 0 offen sc0 sc1
    buffer_load_dword v59, v57, s[44:47], 0 offen sc0 sc1
    s_waitcnt vmcnt(0)
    s_branch K1_PS1
K1_PSD1:
    s_lshl_b32 s57, s51, 2
    s_add_u32 s57, s57, s54
    s_lshl_b32 s57, s57, 8
    s_add_u32 s57, s57, 15998976
    v_lshlrev_b32 v24, 3, v2
    buffer_load_dwordx2 v[20:21], v24, s[32:35], s57 offen sc0 sc1
    buffer_load_dwordx2 v[22:23], v24, s[32:35], s57 offen offset:128 sc0 sc1
    s_cmp_lt_u32 s48, 4
    s_cbranch_scc0 K1_NCL1
    s_lshl_b32 s57, s71, 14
    s_add_u32 s57, s57, 16015360
    s_lshl_b32 s61, s48, 2
    s_add_u32 s57, s57, s61
    v_lshlrev_b32 v24, 4, v1
    buffer_load_dword v40, v24, s[32:35], s57 offen offset:0 sc0 sc1
    buffer_load_dword v41, v24, s[32:35], s57 offen offset:1024 sc0 sc1
    buffer_load_dword v42, v24, s[32:35], s57 offen offset:2048 sc0 sc1
    buffer_load_dword v43, v24, s[32:35], s57 offen offset:3072 sc0 sc1
    s_add_u32 s57, s57, 4096
    buffer_load_dword v44, v24, s[32:35], s57 offen offset:0 sc0 sc1
    buffer_load_dword v45, v24, s[32:35], s57 offen offset:1024 sc0 sc1
    buffer_load_dword v46, v24, s[32:35], s57 offen offset:2048 sc0 sc1
    buffer_load_dword v47, v24, s[32:35], s57 offen offset:3072 sc0 sc1
    s_add_u32 s57, s57, 4096
    buffer_load_dword v48, v24, s[32:35], s57 offen offset:0 sc0 sc1
    buffer_load_dword v49, v24, s[32:35], s57 offen offset:1024 sc0 sc1
    buffer_load_dword v50, v24, s[32:35], s57 offen offset:2048 sc0 sc1
    buffer_load_dword v51, v24, s[32:35], s57 offen offset:3072 sc0 sc1
    s_add_u32 s57, s57, 4096
    buffer_load_dword v52, v24, s[32:35], s57 offen offset:0 sc0 sc1
    buffer_load_dword v53, v24, s[32:35], s57 offen offset:1024 sc0 sc1
    buffer_load_dword v54, v24, s[32:35], s57 offen offset:2048 sc0 sc1
    buffer_load_dword v55, v24, s[32:35], s57 offen offset:3072 sc0 sc1
    s_add_u32 s57, s57, 4096
K1_NCL1:
    v_mfma_f32_16x16x32_bf16 v[108:111], v[196:199], v[172:175], v[108:111]
    v_mfma_f32_16x16x32_bf16 v[112:115], v[200:203], v[168:171], v[112:115]
    v_mfma_f32_16x16x32_bf16 v[116:119], v[200:203], v[172:175], v[116:119]
    s_waitcnt lgkmcnt(0)
    v_mfma_f32_16x16x32_bf16 v[64:67], v[136:139], v[128:131], v[64:67]
    ds_read_b128 v[168:171], v229
    ds_read_b128 v[172:175], v229 offset:2048
    v_mfma_f32_16x16x32_bf16 v[68:71], v[136:139], v[132:135], v[68:71]
    ds_read_b64_tr_b16 v[176:177], v230 offset:15360
    ds_read_b64_tr_b16 v[178:179], v231 offset:15360
    v_mfma_f32_16x16x32_bf16 v[72:75], v[140:143], v[128:131], v[72:75]
    ds_read_b64_tr_b16 v[180:181], v230 offset:15368
    ds_read_b64_tr_b16 v[182:183], v231 offset:15368
    v_mfma_f32_16x16x32_bf16 v[76:79], v[140:143], v[132:135], v[76:79]
    ds_read_b64_tr_b16 v[184:185], v230 offset:15376
    ds_read_b64_tr_b16 v[186:187], v231 offset:15376
    v_mfma_f32_16x16x32_bf16 v[80:83], v[144:147], v[128:131], v[80:83]
    ds_read_b64_tr_b16 v[188:189], v230 offset:15384
    ds_read_b64_tr_b16 v[190:191], v231 offset:15384
    v_mfma_f32_16x16x32_bf16 v[84:87], v[144:147], v[132:135], v[84:87]
    ds_read_b64_tr_b16 v[192:193], v230 offset:15392
    ds_read_b64_tr_b16 v[194:195], v231 offset:15392
    v_mfma_f32_16x16x32_bf16 v[88:91], v[148:151], v[128:131], v[88:91]
    ds_read_b64_tr_b16 v[196:197], v230 offset:15704
    ds_read_b64_tr_b16 v[198:199], v231 offset:15704
    v_mfma_f32_16x16x32_bf16 v[92:95], v[148:151], v[132:135], v[92:95]
    ds_read_b64_tr_b16 v[200:201], v230 offset:15712
    ds_read_b64_tr_b16 v[202:203], v231 offset:15712
    v_mfma_f32_16x16x32_bf16 v[96:99], v[152:155], v[128:131], v[96:99]
    v_mfma_f32_16x16x32_bf16 v[100:103], v[152:155], v[132:135], v[100:103]
    v_mfma_f32_16x16x32_bf16 v[104:107], v[156:159], v[128:131], v[104:107]
    v_mfma_f32_16x16x32_bf16 v[108:111], v[156:159], v[132:135], v[108:111]
    v_mfma_f32_16x16x32_bf16 v[112:115], v[160:163], v[128:131], v[112:115]
    v_mfma_f32_16x16x32_bf16 v[116:119], v[160:163], v[132:135], v[116:119]
    s_waitcnt lgkmcnt(0)
    s_barrier
    v_mfma_f32_16x16x32_bf16 v[64:67], v[176:179], v[168:171], v[64:67]
    v_mfma_f32_16x16x32_bf16 v[68:71], v[176:179], v[172:175], v[68:71]
    v_mfma_f32_16x16x32_bf16 v[72:75], v[180:183], v[168:171], v[72:75]
    v_mfma_f32_16x16x32_bf16 v[76:79], v[180:183], v[172:175], v[76:79]
    v_mfma_f32_16x16x32_bf16 v[80:83], v[184:187], v[168:171], v[80:83]
    v_mfma_f32_16x16x32_bf16 v[84:87], v[184:187], v[172:175], v[84:87]
    v_mfma_f32_16x16x32_bf16 v[88:91], v[188:191], v[168:171], v[88:91]
    v_mfma_f32_16x16x32_bf16 v[92:95], v[188:191], v[172:175], v[92:95]
    v_mfma_f32_16x16x32_bf16 v[96:99], v[192:195], v[168:171], v[96:99]
    v_mfma_f32_16x16x32_bf16 v[100:103], v[192:195], v[172:175], v[100:103]
    v_mfma_f32_16x16x32_bf16 v[104:107], v[196:199], v[168:171], v[104:107]
    v_mfma_f32_16x16x32_bf16 v[108:111], v[196:199], v[172:175], v[108:111]
    v_mfma_f32_16x16x32_bf16 v[112:115], v[200:203], v[168:171], v[112:115]
    v_mfma_f32_16x16x32_bf16 v[116:119], v[200:203], v[172:175], v[116:119]
    s_lshl_b32 s57, s52, 2
    v_mov_b32 v60, s57
    buffer_load_dword v61, v60, s[44:47], 0 offen sc0 sc1
    s_waitcnt vmcnt(1)
    s_cmp_lt_u32 s48, 4
    s_cbranch_scc0 K1_NCS1
    v_pk_add_f32 v[40:41], v[40:41], v[42:43]
    v_pk_add_f32 v[40:41], v[40:41], v[44:45]
    v_pk_add_f32 v[40:41], v[40:41], v[46:47]
    v_pk_add_f32 v[40:41], v[40:41], v[48:49]
    v_pk_add_f32 v[40:41], v[40:41], v[50:51]
    v_pk_add_f32 v[40:41], v[40:41], v[52:53]
    v_pk_add_f32 v[40:41], v[40:41], v[54:55]
    v_add_f32 v40, v40, v41
    s_lshl_b32 s57, s48, 2
    s_add_u32 s57, s57, 153600
    v_lshlrev_b32 v24, 4, v1
    v_add_u32 v24, s57, v24
    ds_write_b32 v24, v40
    v_lshlrev_b32 v25, 4, v0
    v_add_u32 v25, 73728, v25
    ds_write_b128 v25, v[252:255]
K1_NCS1:
    s_waitcnt lgkmcnt(0)
    s_barrier
    s_cmp_eq_u32 s48, 0
    s_cbranch_scc0 K1_NZ1
    v_readfirstlane_b32 s57, v17
    s_nop 0
    s_cmp_lg_u32 s57, 0
    s_cbranch_scc1 K1_ZOK1
    v_mov_b32 v24, 0
    s_mov_b32 s68, 0
K1_SZ1:
    buffer_load_dword v25, v24, s[44:47], 0 offen sc0 sc1
    s_waitcnt vmcnt(0)
    v_readfirstlane_b32 s57, v25
    s_nop 0
    s_cmp_lg_u32 s57, 0
    s_cbranch_scc1 K1_SZ1_D
    s_add_u32 s68, s68, 1
    s_cmp_ge_u32 s68, 100000
    s_cbranch_scc1 K1_SZ1_D
    s_sleep 12
    s_branch K1_SZ1
K1_SZ1_D:
K1_ZOK1:
K1_NZ1:
    v_mul_u32_u24 v26, 80, v3
    v_add_u32 v26, 153600, v26
    ds_read_b128 v[128:131], v26 offset:0
    ds_read_b128 v[132:135], v26 offset:16
    ds_read_b128 v[136:139], v26 offset:32
    ds_read_b128 v[140:143], v26 offset:48
    ds_read_b128 v[144:147], v26 offset:64
    ds_read_b128 v[148:151], v26 offset:688
    ds_read_b128 v[152:155], v26 offset:704
    v_mov_b32 v28, v20
    v_mov_b32 v32, v21
    v_mov_b32 v30, v22
    v_mov_b32 v34, v23
    s_waitcnt lgkmcnt(0)
    v_pk_fma_f32 v[64:65], v[128:129], v[28:29], v[64:65] op_sel_hi:[1,0,1] neg_lo:[0,1,0] neg_hi:[0,1,0]
    v_pk_fma_f32 v[66:67], v[130:131], v[28:29], v[66:67] op_sel_hi:[1,0,1] neg_lo:[0,1,0] neg_hi:[0,1,0]
    v_pk_fma_f32 v[68:69], v[128:129], v[30:31], v[68:69] op_sel_hi:[1,0,1] neg_lo:[0,1,0] neg_hi:[0,1,0]
    v_pk_fma_f32 v[70:71], v[130:131], v[30:31], v[70:71] op_sel_hi:[1,0,1] neg_lo:[0,1,0] neg_hi:[0,1,0]
    v_pk_fma_f32 v[72:73], v[132:133], v[28:29], v[72:73] op_sel_hi:[1,0,1] neg_lo:[0,1,0] neg_hi:[0,1,0]
    v_pk_fma_f32 v[74:75], v[134:135], v[28:29], v[74:75] op_sel_hi:[1,0,1] neg_lo:[0,1,0] neg_hi:[0,1,0]
    v_pk_fma_f32 v[76:77], v[132:133], v[30:31], v[76:77] op_sel_hi:[1,0,1] neg_lo:[0,1,0] neg_hi:[0,1,0]
    v_pk_fma_f32 v[78:79], v[134:135], v[30:31], v[78:79] op_sel_hi:[1,0,1] neg_lo:[0,1,0] neg_hi:[0,1,0]
    v_pk_fma_f32 v[80:81], v[136:137], v[28:29], v[80:81] op_sel_hi:[1,0,1] neg_lo:[0,1,0] neg_hi:[0,1,0]
    v_pk_fma_f32 v[82:83], v[138:139], v[28:29], v[82:83] op_sel_hi:[1,0,1] neg_lo:[0,1,0] neg_hi:[0,1,0]
    v_pk_fma_f32 v[84:85], v[136:137], v[30:31], v[84:85] op_sel_hi:[1,0,1] neg_lo:[0,1,0] neg_hi:[0,1,0]
    v_pk_fma_f32 v[86:87], v[138:139], v[30:31], v[86:87] op_sel_hi:[1,0,1] neg_lo:[0,1,0] neg_hi:[0,1,0]
    v_pk_fma_f32 v[88:89], v[140:141], v[28:29], v[88:89] op_sel_hi:[1,0,1] neg_lo:[0,1,0] neg_hi:[0,1,0]
    v_pk_fma_f32 v[90:91], v[142:143], v[28:29], v[90:91] op_sel_hi:[1,0,1] neg_lo:[0,1,0] neg_hi:[0,1,0]
    v_pk_fma_f32 v[92:93], v[140:141], v[30:31], v[92:93] op_sel_hi:[1,0,1] neg_lo:[0,1,0] neg_hi:[0,1,0]
    v_pk_fma_f32 v[94:95], v[142:143], v[30:31], v[94:95] op_sel_hi:[1,0,1] neg_lo:[0,1,0] neg_hi:[0,1,0]
    v_pk_fma_f32 v[96:97], v[144:145], v[28:29], v[96:97] op_sel_hi:[1,0,1] neg_lo:[0,1,0] neg_hi:[0,1,0]
    v_pk_fma_f32 v[98:99], v[146:147], v[28:29], v[98:99] op_sel_hi:[1,0,1] neg_lo:[0,1,0] neg_hi:[0,1,0]
    v_pk_fma_f32 v[100:101], v[144:145], v[30:31], v[100:101] op_sel_hi:[1,0,1] neg_lo:[0,1,0] neg_hi:[0,1,0]
    v_pk_fma_f32 v[102:103], v[146:147], v[30:31], v[102:103] op_sel_hi:[1,0,1] neg_lo:[0,1,0] neg_hi:[0,1,0]
    v_pk_fma_f32 v[104:105], v[148:149], v[28:29], v[104:105] op_sel_hi:[1,0,1] neg_lo:[0,1,0] neg_hi:[0,1,0]
    v_pk_fma_f32 v[106:107], v[150:151], v[28:29], v[106:107] op_sel_hi:[1,0,1] neg_lo:[0,1,0] neg_hi:[0,1,0]
    v_pk_fma_f32 v[108:109], v[148:149], v[30:31], v[108:109] op_sel_hi:[1,0,1] neg_lo:[0,1,0] neg_hi:[0,1,0]
    v_pk_fma_f32 v[110:111], v[150:151], v[30:31], v[110:111] op_sel_hi:[1,0,1] neg_lo:[0,1,0] neg_hi:[0,1,0]
    v_pk_fma_f32 v[112:113], v[152:153], v[28:29], v[112:113] op_sel_hi:[1,0,1] neg_lo:[0,1,0] neg_hi:[0,1,0]
    v_pk_fma_f32 v[114:115], v[154:155], v[28:29], v[114:115] op_sel_hi:[1,0,1] neg_lo:[0,1,0] neg_hi:[0,1,0]
    v_pk_fma_f32 v[116:117], v[152:153], v[30:31], v[116:117] op_sel_hi:[1,0,1] neg_lo:[0,1,0] neg_hi:[0,1,0]
    v_pk_fma_f32 v[118:119], v[154:155], v[30:31], v[118:119] op_sel_hi:[1,0,1] neg_lo:[0,1,0] neg_hi:[0,1,0]
    v_pk_mul_f32 v[64:65], v[64:65], v[32:33] op_sel_hi:[1,0]
    v_pk_mul_f32 v[66:67], v[66:67], v[32:33] op_sel_hi:[1,0]
    v_pk_mul_f32 v[68:69], v[68:69], v[34:35] op_sel_hi:[1,0]
    v_pk_mul_f32 v[70:71], v[70:71], v[34:35] op_sel_hi:[1,0]
    v_pk_mul_f32 v[72:73], v[72:73], v[32:33] op_sel_hi:[1,0]
    v_pk_mul_f32 v[74:75], v[74:75], v[32:33] op_sel_hi:[1,0]
    v_pk_mul_f32 v[76:77], v[76:77], v[34:35] op_sel_hi:[1,0]
    v_pk_mul_f32 v[78:79], v[78:79], v[34:35] op_sel_hi:[1,0]
    v_pk_mul_f32 v[80:81], v[80:81], v[32:33] op_sel_hi:[1,0]
    v_pk_mul_f32 v[82:83], v[82:83], v[32:33] op_sel_hi:[1,0]
    v_pk_mul_f32 v[84:85], v[84:85], v[34:35] op_sel_hi:[1,0]
    v_pk_mul_f32 v[86:87], v[86:87], v[34:35] op_sel_hi:[1,0]
    v_pk_mul_f32 v[88:89], v[88:89], v[32:33] op_sel_hi:[1,0]
    v_pk_mul_f32 v[90:91], v[90:91], v[32:33] op_sel_hi:[1,0]
    v_pk_mul_f32 v[92:93], v[92:93], v[34:35] op_sel_hi:[1,0]
    v_pk_mul_f32 v[94:95], v[94:95], v[34:35] op_sel_hi:[1,0]
    v_pk_mul_f32 v[96:97], v[96:97], v[32:33] op_sel_hi:[1,0]
    v_pk_mul_f32 v[98:99], v[98:99], v[32:33] op_sel_hi:[1,0]
    v_pk_mul_f32 v[100:101], v[100:101], v[34:35] op_sel_hi:[1,0]
    v_pk_mul_f32 v[102:103], v[102:103], v[34:35] op_sel_hi:[1,0]
    v_pk_mul_f32 v[104:105], v[104:105], v[32:33] op_sel_hi:[1,0]
    v_pk_mul_f32 v[106:107], v[106:107], v[32:33] op_sel_hi:[1,0]
    v_pk_mul_f32 v[108:109], v[108:109], v[34:35] op_sel_hi:[1,0]
    v_pk_mul_f32 v[110:111], v[110:111], v[34:35] op_sel_hi:[1,0]
    v_pk_mul_f32 v[112:113], v[112:113], v[32:33] op_sel_hi:[1,0]
    v_pk_mul_f32 v[114:115], v[114:115], v[32:33] op_sel_hi:[1,0]
    v_pk_mul_f32 v[116:117], v[116:117], v[34:35] op_sel_hi:[1,0]
    v_pk_mul_f32 v[118:119], v[118:119], v[34:35] op_sel_hi:[1,0]
    v_cvt_pk_bf16_f32 v160, v64, v65
    v_cvt_pk_bf16_f32 v161, v66, v67
    v_cvt_pk_bf16_f32 v162, v72, v73
    v_cvt_pk_bf16_f32 v163, v74, v75
    v_cvt_pk_bf16_f32 v164, v80, v81
    v_cvt_pk_bf16_f32 v165, v82, v83
    v_cvt_pk_bf16_f32 v166, v88, v89
    v_cvt_pk_bf16_f32 v167, v90, v91
    v_cvt_pk_bf16_f32 v168, v96, v97
    v_cvt_pk_bf16_f32 v169, v98, v99
    v_cvt_pk_bf16_f32 v184, v104, v105
    v_cvt_pk_bf16_f32 v185, v106, v107
    v_cvt_pk_bf16_f32 v186, v112, v113
    v_cvt_pk_bf16_f32 v187, v114, v115
    v_cvt_pk_bf16_f32 v172, v68, v69
    v_cvt_pk_bf16_f32 v173, v70, v71
    v_cvt_pk_bf16_f32 v174, v76, v77
    v_cvt_pk_bf16_f32 v175, v78, v79
    v_cvt_pk_bf16_f32 v176, v84, v85
    v_cvt_pk_bf16_f32 v177, v86, v87
    v_cvt_pk_bf16_f32 v178, v92, v93
    v_cvt_pk_bf16_f32 v179, v94, v95
    v_cvt_pk_bf16_f32 v180, v100, v101
    v_cvt_pk_bf16_f32 v181, v102, v103
    v_cvt_pk_bf16_f32 v190, v108, v109
    v_cvt_pk_bf16_f32 v191, v110, v111
    v_cvt_pk_bf16_f32 v192, v116, v117
    v_cvt_pk_bf16_f32 v193, v118, v119
    v_mov_b32 v170, 0
    v_mov_b32 v171, 0
    v_mov_b32 v182, 0
    v_mov_b32 v183, 0
    v_mov_b32 v206, 0
    v_mov_b32 v207, 0
    v_mov_b32 v218, 0
    v_mov_b32 v219, 0
    v_lshlrev_b32 v48, 4, v1
    s_mul_i32 s57, s54, 3072
    s_add_u32 s57, s57, 97280
    v_add_u32 v49, s57, v48
    s_lshl_b32 s58, s51, 3
    s_lshl_b32 s59, s54, 1
    s_add_u32 s58, s58, s59
    s_lshl_b32 s58, s58, 3
    s_add_u32 s58, s58, s52
    s_mul_i32 s58, s58, 3072
    s_add_u32 s58, s58, 7077888
    s_add_u32 s59, s58, 24576
    buffer_store_dwordx4 v[160:163], v48, s[32:35], s58 offen offset:0 sc1
    buffer_store_dwordx4 v[164:167], v48, s[32:35], s58 offen offset:1024 sc1
    buffer_store_dwordx4 v[168:171], v48, s[32:35], s58 offen offset:2048 sc1
    buffer_store_dwordx4 v[172:175], v48, s[32:35], s59 offen offset:0 sc1
    buffer_store_dwordx4 v[176:179], v48, s[32:35], s59 offen offset:1024 sc1
    buffer_store_dwordx4 v[180:183], v48, s[32:35], s59 offen offset:2048 sc1
    s_lshl_b32 s57, s54, 5
    v_add_u32 v24, s57, v2
    v_mul_u32_u24 v25, 224, v24
    v_mul_u32_u24 v26, 48, v3
    v_add_u32 v25, v25, v26
    v_add_u32 v25, 45056, v25
    ds_write_b64 v25, v[184:185] offset:24
    ds_write_b64 v25, v[186:187] offset:32
    ds_write_b64 v25, v[190:191] offset:3608
    ds_write_b64 v25, v[192:193] offset:3616
    v_mov_b32 v32, 0x00003f80
    v_mov_b32 v33, 0
    ds_write_b64 v25, v[32:33] offset:40
    ds_write_b64 v25, v[32:33] offset:3624
    v_lshrrev_b32 v26, 2, v1
    v_and_b32 v26, 3, v26
    v_and_b32 v27, 3, v1
    v_mul_u32_u24 v28, 800, v3
    v_mul_u32_u24 v29, 40, v26
    v_add_u32 v28, v28, v29
    v_add_u32 v28, 73728, v28
    v_mov_b32 v29, 76928
    v_cmp_eq_u32 vcc, v27, v3
    v_add_u32 v30, 0, v28
    s_nop 0
    v_cndmask_b32 v34, v29, v30, vcc
    v_add_u32 v30, 160, v28
    v_cndmask_b32 v35, v29, v30, vcc
    v_add_u32 v30, 320, v28
    v_cndmask_b32 v36, v29, v30, vcc
    v_add_u32 v30, 480, v28
    v_cndmask_b32 v37, v29, v30, vcc
    v_add_u32 v30, 640, v28
    v_cndmask_b32 v38, v29, v30, vcc
    s_waitcnt lgkmcnt(0)
    s_barrier
    ds_read_b128 v[160:163], v49 offset:0
    ds_read_b128 v[164:167], v49 offset:1024
    ds_read_b128 v[168:171], v49 offset:2048
    s_branch K1_QC
K1_T2:
    buffer_load_dwordx4 v[128:131], v14, s[24:27], 0 offen
    buffer_load_dwordx4 v[132:135], v14, s[24:27], 0 offen offset:16
    s_mov_b32 s57, 0
    buffer_load_dwordx2 v[136:137], v15, s[28:31], s57 offen
    s_add_u32 s57, s57, s63
    buffer_load_dwordx2 v[138:139], v15, s[28:31], s57 offen
    s_add_u32 s57, s57, s63
    buffer_load_dwordx2 v[140:141], v15, s[28:31], s57 offen
    s_add_u32 s57, s57, s63
    buffer_load_dwordx2 v[142:143], v15, s[28:31], s57 offen
    s_add_u32 s57, s57, s63
    buffer_load_dwordx2 v[144:145], v15, s[28:31], s57 offen
    s_cmp_gt_i32 s75, 0
    s_cselect_b64 exec, -1, 1
    s_cselect_b32 s57, s73, 154624
    s_add_u32 m0, s57, 0
    s_nop 0
    buffer_load_dwordx4 v4, s[28:31], s61 offen lds
    s_mov_b64 exec, -1
    s_cmp_gt_i32 s75, 1
    s_cselect_b64 exec, -1, 1
    s_cselect_b32 s57, s73, 153600
    s_add_u32 m0, s57, 1024
    s_nop 0
    buffer_load_dwordx4 v5, s[28:31], s61 offen lds
    s_mov_b64 exec, -1
    s_cmp_gt_i32 s75, 2
    s_cselect_b64 exec, -1, 1
    s_cselect_b32 s57, s73, 152576
    s_add_u32 m0, s57, 2048
    s_nop 0
    buffer_load_dwordx4 v6, s[28:31], s61 offen lds
    s_mov_b64 exec, -1
    s_cmp_gt_i32 s75, 3
    s_cselect_b64 exec, -1, 1
    s_cselect_b32 s57, s73, 151552
    s_add_u32 m0, s57, 3072
    s_nop 0
    buffer_load_dwordx4 v7, s[28:31], s61 offen lds
    s_mov_b64 exec, -1
    s_cmp_gt_i32 s75, 4
    s_cselect_b64 exec, -1, 1
    s_cselect_b32 s57, s73, 150528
    s_add_u32 m0, s57, 4096
    s_nop 0
    buffer_load_dwordx4 v8, s[28:31], s61 offen lds
    s_mov_b64 exec, -1
    s_add_u32 s61, s61, s56
    s_add_u32 m0, s74, 0
    s_nop 0
    buffer_load_dwordx4 v9, s[24:27], s60 offen lds
    s_add_u32 m0, s74, 1024
    s_nop 0
    buffer_load_dwordx4 v10, s[24:27], s60 offen lds
    s_add_u32 s60, s60, 128
    s_barrier
    s_cmp_gt_i32 s75, 0
    s_cselect_b64 exec, -1, 1
    s_cselect_b32 s57, s73, 103424
    s_add_u32 m0, s57, 51200
    s_nop 0
    buffer_load_dwordx4 v4, s[28:31], s61 offen lds
    s_mov_b64 exec, -1
    s_cmp_gt_i32 s75, 1
    s_cselect_b64 exec, -1, 1
    s_cselect_b32 s57, s73, 102400
    s_add_u32 m0, s57, 52224
    s_nop 0
    buffer_load_dwordx4 v5, s[28:31], s61 offen lds
    s_mov_b64 exec, -1
    s_cmp_gt_i32 s75, 2
    s_cselect_b64 exec, -1, 1
    s_cselect_b32 s57, s73, 101376
    s_add_u32 m0, s57, 53248
    s_nop 0
    buffer_load_dwordx4 v6, s[28:31], s61 offen lds
    s_mov_b64 exec, -1
    s_cmp_gt_i32 s75, 3
    s_cselect_b64 exec, -1, 1
    s_cselect_b32 s57, s73, 100352
    s_add_u32 m0, s57, 54272
    s_nop 0
    buffer_load_dwordx4 v7, s[28:31], s61 offen lds
    s_mov_b64 exec, -1
    s_cmp_gt_i32 s75, 4
    s_cselect_b64 exec, -1, 1
    s_cselect_b32 s57, s73, 99328
    s_add_u32 m0, s57, 55296
    s_nop 0
    buffer_load_dwordx4 v8, s[28:31], s61 offen lds
    s_mov_b64 exec, -1
    s_add_u32 s61, s61, s56
    s_add_u32 m0, s74, 51200
    s_nop 0
    buffer_load_dwordx4 v9, s[24:27], s60 offen lds
    s_add_u32 m0, s74, 52224
    s_nop 0
    buffer_load_dwordx4 v10, s[24:27], s60 offen lds
    s_add_u32 s60, s60, 128
    s_waitcnt vmcnt(14)
    v_lshlrev_b32 v148, 16, v136
    v_and_b32 v149, 0xffff0000, v136
    v_lshlrev_b32 v150, 16, v137
    v_and_b32 v151, 0xffff0000, v137
    v_lshlrev_b32 v152, 16, v138
    v_and_b32 v153, 0xffff0000, v138
    v_lshlrev_b32 v154, 16, v139
    v_and_b32 v155, 0xffff0000, v139
    v_lshlrev_b32 v156, 16, v140
    v_and_b32 v157, 0xffff0000, v140
    v_lshlrev_b32 v158, 16, v141
    v_and_b32 v159, 0xffff0000, v141
    v_lshlrev_b32 v160, 16, v142
    v_and_b32 v161, 0xffff0000, v142
    v_lshlrev_b32 v162, 16, v143
    v_and_b32 v163, 0xffff0000, v143
    v_lshlrev_b32 v164, 16, v144
    v_and_b32 v165, 0xffff0000, v144
    v_lshlrev_b32 v166, 16, v145
    v_and_b32 v167, 0xffff0000, v145
    v_pk_add_f32 v[148:149], v[148:149], v[152:153]
    v_pk_add_f32 v[150:151], v[150:151], v[154:155]
    v_pk_add_f32 v[148:149], v[148:149], v[156:157]
    v_pk_add_f32 v[150:151], v[150:151], v[158:159]
    v_pk_add_f32 v[148:149], v[148:149], v[160:161]
    v_pk_add_f32 v[150:151], v[150:151], v[162:163]
    v_pk_add_f32 v[148:149], v[148:149], v[164:165]
    v_pk_add_f32 v[150:151], v[150:151], v[166:167]
    v_lshlrev_b32 v24, 4, v0
    v_add_u32 v24, 155648, v24
    ds_write_b128 v24, v[148:151]
    v_lshlrev_b32 v168, 16, v128
    v_and_b32 v169, 0xffff0000, v128
    v_lshlrev_b32 v170, 16, v129
    v_and_b32 v171, 0xffff0000, v129
    v_lshlrev_b32 v172, 16, v130
    v_and_b32 v173, 0xffff0000, v130
    v_lshlrev_b32 v174, 16, v131
    v_and_b32 v175, 0xffff0000, v131
    v_lshlrev_b32 v176, 16, v132
    v_and_b32 v177, 0xffff0000, v132
    v_lshlrev_b32 v178, 16, v133
    v_and_b32 v179, 0xffff0000, v133
    v_lshlrev_b32 v180, 16, v134
    v_and_b32 v181, 0xffff0000, v134
    v_lshlrev_b32 v182, 16, v135
    v_and_b32 v183, 0xffff0000, v135
    v_pk_add_f32 v[184:185], v[168:169], v[170:171]
    v_pk_add_f32 v[184:185], v[184:185], v[172:173]
    v_pk_add_f32 v[184:185], v[184:185], v[174:175]
    v_pk_add_f32 v[184:185], v[184:185], v[176:177]
    v_pk_add_f32 v[184:185], v[184:185], v[178:179]
    v_pk_add_f32 v[184:185], v[184:185], v[180:181]
    v_pk_add_f32 v[184:185], v[184:185], v[182:183]
    v_add_f32 v184, v184, v185
    s_nop 1
    v_add_f32_dpp v184, v184, v184 row_shr:1 row_mask:0xf bank_mask:0xf bound_ctrl:0
    s_nop 1
    v_add_f32_dpp v184, v184, v184 row_shr:2 row_mask:0xf bank_mask:0xf bound_ctrl:0
    s_nop 1
    v_add_f32_dpp v184, v184, v184 row_shr:4 row_mask:0xf bank_mask:0xf bound_ctrl:0
    s_nop 1
    v_add_f32_dpp v184, v184, v184 row_shr:8 row_mask:0xf bank_mask:0xf bound_ctrl:0
    s_nop 1
    v_add_f32_dpp v184, v184, v184 row_bcast:15 row_mask:0xa bank_mask:0xf
    s_nop 1
    v_add_f32_dpp v184, v184, v184 row_bcast:31 row_mask:0xc bank_mask:0xf
    s_nop 0
    v_readlane_b32 s57, v184, 63
    v_mov_b32 v186, 0x3acccccd
    s_nop 0
    v_mul_f32 v186, s57, v186
    v_mov_b32 v184, 0
    v_mov_b32 v185, 0
    s_mov_b32 exec_hi, 0xff
    v_pk_add_f32 v[168:169], v[168:169], v[186:187] op_sel_hi:[1,0] neg_lo:[0,1] neg_hi:[0,1]
    v_pk_add_f32 v[170:171], v[170:171], v[186:187] op_sel_hi:[1,0] neg_lo:[0,1] neg_hi:[0,1]
    v_pk_add_f32 v[172:173], v[172:173], v[186:187] op_sel_hi:[1,0] neg_lo:[0,1] neg_hi:[0,1]
    v_pk_add_f32 v[174:175], v[174:175], v[186:187] op_sel_hi:[1,0] neg_lo:[0,1] neg_hi:[0,1]
    v_pk_add_f32 v[176:177], v[176:177], v[186:187] op_sel_hi:[1,0] neg_lo:[0,1] neg_hi:[0,1]
    v_pk_add_f32 v[178:179], v[178:179], v[186:187] op_sel_hi:[1,0] neg_lo:[0,1] neg_hi:[0,1]
    v_pk_add_f32 v[180:181], v[180:181], v[186:187] op_sel_hi:[1,0] neg_lo:[0,1] neg_hi:[0,1]
    v_pk_add_f32 v[182:183], v[182:183], v[186:187] op_sel_hi:[1,0] neg_lo:[0,1] neg_hi:[0,1]
    v_pk_fma_f32 v[184:185], v[168:169], v[168:169], v[184:185]
    v_pk_fma_f32 v[184:185], v[170:171], v[170:171], v[184:185]
    v_pk_fma_f32 v[184:185], v[172:173], v[172:173], v[184:185]
    v_pk_fma_f32 v[184:185], v[174:175], v[174:175], v[184:185]
    v_pk_fma_f32 v[184:185], v[176:177], v[176:177], v[184:185]
    v_pk_fma_f32 v[184:185], v[178:179], v[178:179], v[184:185]
    v_pk_fma_f32 v[184:185], v[180:181], v[180:181], v[184:185]
    v_pk_fma_f32 v[184:185], v[182:183], v[182:183], v[184:185]
    s_mov_b64 exec, -1
    v_add_f32 v184, v184, v185
    s_nop 1
    v_add_f32_dpp v184, v184, v184 row_shr:1 row_mask:0xf bank_mask:0xf bound_ctrl:0
    s_nop 1
    v_add_f32_dpp v184, v184, v184 row_shr:2 row_mask:0xf bank_mask:0xf bound_ctrl:0
    s_nop 1
    v_add_f32_dpp v184, v184, v184 row_shr:4 row_mask:0xf bank_mask:0xf bound_ctrl:0
    s_nop 1
    v_add_f32_dpp v184, v184, v184 row_shr:8 row_mask:0xf bank_mask:0xf bound_ctrl:0
    s_nop 1
    v_add_f32_dpp v184, v184, v184 row_bcast:15 row_mask:0xa bank_mask:0xf
    s_nop 1
    v_add_f32_dpp v184, v184, v184 row_bcast:31 row_mask:0xc bank_mask:0xf
    s_nop 0
    v_readlane_b32 s57, v184, 63
    v_mov_b32 v187, 0x3acccccd
    s_nop 0
    v_mul_f32 v187, s57, v187
    v_cvt_pk_bf16_f32 v186, v186, v186
    v_lshlrev_b32 v186, 16, v186
    v_cvt_pk_bf16_f32 v187, v187, v187
    v_lshlrev_b32 v187, 16, v187
    v_add_f32 v187, 0x3727c5ac, v187
    v_cvt_pk_bf16_f32 v187, v187, v187
    v_lshlrev_b32 v187, 16, v187
    v_sqrt_f32 v187, v187
    s_nop 0
    v_cvt_pk_bf16_f32 v187, v187, v187
    v_lshlrev_b32 v187, 16, v187
    v_rcp_f32 v187, v187
    s_lshl_b32 s57, s49, 3
    s_add_u32 s57, s57, 15998976
    v_mov_b32 v24, 0
    s_mov_b64 exec, 1
    buffer_store_dwordx2 v[186:187], v24, s[32:35], s57 offen sc0 sc1
    s_mov_b64 exec, -1
    s_waitcnt vmcnt(8) lgkmcnt(0)
    s_barrier
    s_cmp_eq_u32 s48, 7
    s_cbranch_scc0 K1_NCP2
    v_lshlrev_b32 v24, 4, v1
    v_add_u32 v25, 155648, v24
    ds_read_b128 v[168:171], v25 offset:0
    ds_read_b128 v[172:175], v25 offset:1024
    ds_read_b128 v[176:179], v25 offset:2048
    ds_read_b128 v[180:183], v25 offset:3072
    ds_read_b128 v[184:187], v25 offset:4096
    ds_read_b128 v[188:191], v25 offset:5120
    ds_read_b128 v[192:195], v25 offset:6144
    ds_read_b128 v[196:199], v25 offset:7168
    s_waitcnt lgkmcnt(0)
    v_pk_add_f32 v[168:169], v[168:169], v[172:173]
    v_pk_add_f32 v[170:171], v[170:171], v[174:175]
    v_pk_add_f32 v[168:169], v[168:169], v[176:177]
    v_pk_add_f32 v[170:171], v[170:171], v[178:179]
    v_pk_add_f32 v[168:169], v[168:169], v[180:181]
    v_pk_add_f32 v[170:171], v[170:171], v[182:183]
    v_pk_add_f32 v[168:169], v[168:169], v[184:185]
    v_pk_add_f32 v[170:171], v[170:171], v[186:187]
    v_pk_add_f32 v[168:169], v[168:169], v[188:189]
    v_pk_add_f32 v[170:171], v[170:171], v[190:191]
    v_pk_add_f32 v[168:169], v[168:169], v[192:193]
    v_pk_add_f32 v[170:171], v[170:171], v[194:195]
    v_pk_add_f32 v[168:169], v[168:169], v[196:197]
    v_pk_add_f32 v[170:171], v[170:171], v[198:199]
    s_lshl_b32 s57, s71, 4
    s_add_u32 s57, s57, s51
    s_lshl_b32 s57, s57, 10
    s_add_u32 s57, s57, 16015360
    buffer_store_dwordx4 v[168:171], v24, s[32:35], s57 offen sc0 sc1
    s_nop 1
K1_NCP2:
    ds_read_b128 v[128:131], v228
    ds_read_b128 v[132:135], v228 offset:2048
    ds_read_b64_tr_b16 v[136:137], v230 offset:0
    ds_read_b64_tr_b16 v[138:139], v231 offset:0
    ds_read_b64_tr_b16 v[140:141], v230 offset:32
    ds_read_b64_tr_b16 v[142:143], v231 offset:32
    ds_read_b64_tr_b16 v[144:145], v230 offset:64
    ds_read_b64_tr_b16 v[146:147], v231 offset:64
    ds_read_b64_tr_b16 v[148:149], v230 offset:96
    ds_read_b64_tr_b16 v[150:151], v231 offset:96
    ds_read_b64_tr_b16 v[152:153], v230 offset:128
    ds_read_b64_tr_b16 v[154:155], v231 offset:128
    ds_read_b64_tr_b16 v[156:157], v230 offset:160
    ds_read_b64_tr_b16 v[158:159], v231 offset:160
    ds_read_b64_tr_b16 v[160:161], v230 offset:192
    ds_read_b64_tr_b16 v[162:163], v231 offset:192
    ds_read_b64_tr_b16 v[164:165], v230 offset:224
    ds_read_b64_tr_b16 v[166:167], v231 offset:224
    s_waitcnt lgkmcnt(0)
    v_mfma_f32_16x16x32_bf16 v[64:67], v[136:139], v[128:131], 0
    ds_read_b128 v[168:171], v229
    ds_read_b128 v[172:175], v229 offset:2048
    s_cmp_gt_i32 s75, 0
    s_cselect_b64 exec, -1, 1
    s_cselect_b32 s57, s73, 52224
    s_add_u32 m0, s57, 102400
    s_nop 0
    buffer_load_dwordx4 v4, s[28:31], s61 offen lds
    s_mov_b64 exec, -1
    v_mfma_f32_16x16x32_bf16 v[68:71], v[136:139], v[132:135], 0
    ds_read_b64_tr_b16 v[176:177], v230 offset:17408
    ds_read_b64_tr_b16 v[178:179], v231 offset:17408
    s_cmp_gt_i32 s75, 1
    s_cselect_b64 exec, -1, 1
    s_cselect_b32 s57, s73, 51200
    s_add_u32 m0, s57, 103424
    s_nop 0
    buffer_load_dwordx4 v5, s[28:31], s61 offen lds
    s_mov_b64 exec, -1
    v_mfma_f32_16x16x32_bf16 v[72:75], v[140:143], v[128:131], 0
    ds_read_b64_tr_b16 v[180:181], v230 offset:17440
    ds_read_b64_tr_b16 v[182:183], v231 offset:17440
    s_cmp_gt_i32 s75, 2
    s_cselect_b64 exec, -1, 1
    s_cselect_b32 s57, s73, 50176
    s_add_u32 m0, s57, 104448
    s_nop 0
    buffer_load_dwordx4 v6, s[28:31], s61 offen lds
    s_mov_b64 exec, -1
    v_mfma_f32_16x16x32_bf16 v[76:79], v[140:143], v[132:135], 0
    ds_read_b64_tr_b16 v[184:185], v230 offset:17472
    ds_read_b64_tr_b16 v[186:187], v231 offset:17472
    s_cmp_gt_i32 s75, 3
    s_cselect_b64 exec, -1, 1
    s_cselect_b32 s57, s73, 49152
    s_add_u32 m0, s57, 105472
    s_nop 0
    buffer_load_dwordx4 v7, s[28:31], s61 offen lds
    s_mov_b64 exec, -1
    v_mfma_f32_16x16x32_bf16 v[80:83], v[144:147], v[128:131], 0
    ds_read_b64_tr_b16 v[188:189], v230 offset:17504
    ds_read_b64_tr_b16 v[190:191], v231 offset:17504
    s_cmp_gt_i32 s75, 4
    s_cselect_b64 exec, -1, 1
    s_cselect_b32 s57, s73, 48128
    s_add_u32 m0, s57, 106496
    s_nop 0
    buffer_load_dwordx4 v8, s[28:31], s61 offen lds
    s_mov_b64 exec, -1
    s_add_u32 s61, s61, s56
    v_mfma_f32_16x16x32_bf16 v[84:87], v[144:147], v[132:135], 0
    ds_read_b64_tr_b16 v[192:193], v230 offset:17536
    ds_read_b64_tr_b16 v[194:195], v231 offset:17536
    s_add_u32 m0, s74, 102400
    s_nop 0
    buffer_load_dwordx4 v9, s[24:27], s60 offen lds
    v_mfma_f32_16x16x32_bf16 v[88:91], v[148:151], v[128:131], 0
    ds_read_b64_tr_b16 v[196:197], v230 offset:17568
    ds_read_b64_tr_b16 v[198:199], v231 offset:17568
    s_add_u32 m0, s74, 103424
    s_nop 0
    buffer_load_dwordx4 v10, s[24:27], s60 offen lds
    s_add_u32 s60, s60, 128
    v_mfma_f32_16x16x32_bf16 v[92:95], v[148:151], v[132:135], 0
    ds_read_b64_tr_b16 v[200:201], v230 offset:17600
    ds_read_b64_tr_b16 v[202:203], v231 offset:17600
    ds_read_b64_tr_b16 v[204:205], v230 offset:17632
    v_mfma_f32_16x16x32_bf16 v[96:99], v[152:155], v[128:131], 0
    ds_read_b64_tr_b16 v[206:207], v231 offset:17632
    v_mfma_f32_16x16x32_bf16 v[100:103], v[152:155], v[132:135], 0
    v_mfma_f32_16x16x32_bf16 v[104:107], v[156:159], v[128:131], 0
    v_mfma_f32_16x16x32_bf16 v[108:111], v[156:159], v[132:135], 0
    v_mfma_f32_16x16x32_bf16 v[112:115], v[160:163], v[128:131], 0
    v_mfma_f32_16x16x32_bf16 v[116:119], v[160:163], v[132:135], 0
    v_mfma_f32_16x16x32_bf16 v[120:123], v[164:167], v[128:131], 0
    v_mfma_f32_16x16x32_bf16 v[124:127], v[164:167], v[132:135], 0
    s_waitcnt vmcnt(8) lgkmcnt(0)
    s_barrier
    v_mfma_f32_16x16x32_bf16 v[64:67], v[176:179], v[168:171], v[64:67]
    ds_read_b128 v[128:131], v232
    ds_read_b128 v[132:135], v232 offset:2048
    s_cmp_gt_i32 s75, 0
    s_cselect_b64 exec, -1, 1
    s_cselect_b32 s57, s73, 154624
    s_add_u32 m0, s57, 0
    s_nop 0
    buffer_load_dwordx4 v4, s[28:31], s61 offen lds
    s_mov_b64 exec, -1
    v_mfma_f32_16x16x32_bf16 v[68:71], v[176:179], v[172:175], v[68:71]
    ds_read_b64_tr_b16 v[136:137], v234 offset:0
    ds_read_b64_tr_b16 v[138:139], v235 offset:0
    s_cmp_gt_i32 s75, 1
    s_cselect_b64 exec, -1, 1
    s_cselect_b32 s57, s73, 153600
    s_add_u32 m0, s57, 1024
    s_nop 0
    buffer_load_dwordx4 v5, s[28:31], s61 offen lds
    s_mov_b64 exec, -1
    v_mfma_f32_16x16x32_bf16 v[72:75], v[180:183], v[168:171], v[72:75]
    ds_read_b64_tr_b16 v[140:141], v234 offset:32
    ds_read_b64_tr_b16 v[142:143], v235 offset:32
    s_cmp_gt_i32 s75, 2
    s_cselect_b64 exec, -1, 1
    s_cselect_b32 s57, s73, 152576
    s_add_u32 m0, s57, 2048
    s_nop 0
    buffer_load_dwordx4 v6, s[28:31], s61 offen lds
    s_mov_b64 exec, -1
    v_mfma_f32_16x16x32_bf16 v[76:79], v[180:183], v[172:175], v[76:79]
    ds_read_b64_tr_b16 v[144:145], v234 offset:64
    ds_read_b64_tr_b16 v[146:147], v235 offset:64
    s_cmp_gt_i32 s75, 3
    s_cselect_b64 exec, -1, 1
    s_cselect_b32 s57, s73, 151552
    s_add_u32 m0, s57, 3072
    s_nop 0
    buffer_load_dwordx4 v7, s[28:31], s61 offen lds
    s_mov_b64 exec, -1
    v_mfma_f32_16x16x32_bf16 v[80:83], v[184:187], v[168:171], v[80:83]
    ds_read_b64_tr_b16 v[148:149], v234 offset:96
    ds_read_b64_tr_b16 v[150:151], v235 offset:96
    s_cmp_gt_i32 s75, 4
    s_cselect_b64 exec, -1, 1
    s_cselect_b32 s57, s73, 150528
    s_add_u32 m0, s57, 4096
    s_nop 0
    buffer_load_dwordx4 v8, s[28:31], s61 offen lds
    s_mov_b64 exec, -1
    s_add_u32 s61, s61, s56
    v_mfma_f32_16x16x32_bf16 v[84:87], v[184:187], v[172:175], v[84:87]
    ds_read_b64_tr_b16 v[152:153], v234 offset:128
    ds_read_b64_tr_b16 v[154:155], v235 offset:128
    s_add_u32 m0, s74, 0
    s_nop 0
    buffer_load_dwordx4 v9, s[24:27], s60 offen lds
    v_mfma_f32_16x16x32_bf16 v[88:91], v[188:191], v[168:171], v[88:91]
    ds_read_b64_tr_b16 v[156:157], v234 offset:160
    ds_read_b64_tr_b16 v[158:159], v235 offset:160
    s_add_u32 m0, s74, 1024
    s_nop 0
    buffer_load_dwordx4 v10, s[24:27], s60 offen lds
    s_add_u32 s60, s60, 128
    v_mfma_f32_16x16x32_bf16 v[92:95], v[188:191], v[172:175], v[92:95]
    ds_read_b64_tr_b16 v[160:161], v234 offset:192
    ds_read_b64_tr_b16 v[162:163], v235 offset:192
    ds_read_b64_tr_b16 v[164:165], v234 offset:224
    v_mfma_f32_16x16x32_bf16 v[96:99], v[192:195], v[168:171], v[96:99]
    ds_read_b64_tr_b16 v[166:167], v235 offset:224
    v_mfma_f32_16x16x32_bf16 v[100:103], v[192:195], v[172:175], v[100:103]
    v_mfma_f32_16x16x32_bf16 v[104:107], v[196:199], v[168:171], v[104:107]
    v_mfma_f32_16x16x32_bf16 v[108:111], v[196:199], v[172:175], v[108:111]
    v_mfma_f32_16x16x32_bf16 v[112:115], v[200:203], v[168:171], v[112:115]
    v_mfma_f32_16x16x32_bf16 v[116:119], v[200:203], v[172:175], v[116:119]
    v_mfma_f32_16x16x32_bf16 v[120:123], v[204:207], v[168:171], v[120:123]
    v_mfma_f32_16x16x32_bf16 v[124:127], v[204:207], v[172:175], v[124:127]
    s_waitcnt lgkmcnt(0)
    v_mfma_f32_16x16x32_bf16 v[64:67], v[136:139], v[128:131], v[64:67]
    ds_read_b128 v[168:171], v233
    ds_read_b128 v[172:175], v233 offset:2048
    v_mfma_f32_16x16x32_bf16 v[68:71], v[136:139], v[132:135], v[68:71]
    ds_read_b64_tr_b16 v[176:177], v234 offset:17408
    ds_read_b64_tr_b16 v[178:179], v235 offset:17408
    v_mfma_f32_16x16x32_bf16 v[72:75], v[140:143], v[128:131], v[72:75]
    ds_read_b64_tr_b16 v[180:181], v234 offset:17440
    ds_read_b64_tr_b16 v[182:183], v235 offset:17440
    v_mfma_f32_16x16x32_bf16 v[76:79], v[140:143], v[132:135], v[76:79]
    ds_read_b64_tr_b16 v[184:185], v234 offset:17472
    ds_read_b64_tr_b16 v[186:187], v235 offset:17472
    v_mfma_f32_16x16x32_bf16 v[80:83], v[144:147], v[128:131], v[80:83]
    ds_read_b64_tr_b16 v[188:189], v234 offset:17504
    ds_read_b64_tr_b16 v[190:191], v235 offset:17504
    v_mfma_f32_16x16x32_bf16 v[84:87], v[144:147], v[132:135], v[84:87]
    ds_read_b64_tr_b16 v[192:193], v234 offset:17536
    ds_read_b64_tr_b16 v[194:195], v235 offset:17536
    v_mfma_f32_16x16x32_bf16 v[88:91], v[148:151], v[128:131], v[88:91]
    ds_read_b64_tr_b16 v[196:197], v234 offset:17568
    ds_read_b64_tr_b16 v[198:199], v235 offset:17568
    v_mfma_f32_16x16x32_bf16 v[92:95], v[148:151], v[132:135], v[92:95]
    ds_read_b64_tr_b16 v[200:201], v234 offset:17600
    ds_read_b64_tr_b16 v[202:203], v235 offset:17600
    v_mfma_f32_16x16x32_bf16 v[96:99], v[152:155], v[128:131], v[96:99]
    ds_read_b64_tr_b16 v[204:205], v234 offset:17632
    ds_read_b64_tr_b16 v[206:207], v235 offset:17632
    v_mfma_f32_16x16x32_bf16 v[100:103], v[152:155], v[132:135], v[100:103]
    v_mfma_f32_16x16x32_bf16 v[104:107], v[156:159], v[128:131], v[104:107]
    v_mfma_f32_16x16x32_bf16 v[108:111], v[156:159], v[132:135], v[108:111]
    v_mfma_f32_16x16x32_bf16 v[112:115], v[160:163], v[128:131], v[112:115]
    v_mfma_f32_16x16x32_bf16 v[116:119], v[160:163], v[132:135], v[116:119]
    v_mfma_f32_16x16x32_bf16 v[120:123], v[164:167], v[128:131], v[120:123]
    v_mfma_f32_16x16x32_bf16 v[124:127], v[164:167], v[132:135], v[124:127]
    s_waitcnt vmcnt(7) lgkmcnt(0)
    s_barrier
    v_mfma_f32_16x16x32_bf16 v[64:67], v[176:179], v[168:171], v[64:67]
    ds_read_b128 v[128:131], v236
    ds_read_b128 v[132:135], v236 offset:2048
    s_cmp_gt_i32 s75, 0
    s_cselect_b64 exec, -1, 1
    s_cselect_b32 s57, s73, 103424
    s_add_u32 m0, s57, 51200
    s_nop 0
    buffer_load_dwordx4 v4, s[28:31], s61 offen lds
    s_mov_b64 exec, -1
    v_mfma_f32_16x16x32_bf16 v[68:71], v[176:179], v[172:175], v[68:71]
    ds_read_b64_tr_b16 v[136:137], v238 offset:0
    ds_read_b64_tr_b16 v[138:139], v239 offset:0
    s_cmp_gt_i32 s75, 1
    s_cselect_b64 exec, -1, 1
    s_cselect_b32 s57, s73, 102400
    s_add_u32 m0, s57, 52224
    s_nop 0
    buffer_load_dwordx4 v5, s[28:31], s61 offen lds
    s_mov_b64 exec, -1
    v_mfma_f32_16x16x32_bf16 v[72:75], v[180:183], v[168:171], v[72:75]
    ds_read_b64_tr_b16 v[140:141], v238 offset:32
    ds_read_b64_tr_b16 v[142:143], v239 offset:32
    s_cmp_gt_i32 s75, 2
    s_cselect_b64 exec, -1, 1
    s_cselect_b32 s57, s73, 101376
    s_add_u32 m0, s57, 53248
    s_nop 0
    buffer_load_dwordx4 v6, s[28:31], s61 offen lds
    s_mov_b64 exec, -1
    v_mfma_f32_16x16x32_bf16 v[76:79], v[180:183], v[172:175], v[76:79]
    ds_read_b64_tr_b16 v[144:145], v238 offset:64
    ds_read_b64_tr_b16 v[146:147], v239 offset:64
    s_cmp_gt_i32 s75, 3
    s_cselect_b64 exec, -1, 1
    s_cselect_b32 s57, s73, 100352
    s_add_u32 m0, s57, 54272
    s_nop 0
    buffer_load_dwordx4 v7, s[28:31], s61 offen lds
    s_mov_b64 exec, -1
    v_mfma_f32_16x16x32_bf16 v[80:83], v[184:187], v[168:171], v[80:83]
    ds_read_b64_tr_b16 v[148:149], v238 offset:96
    ds_read_b64_tr_b16 v[150:151], v239 offset:96
    s_cmp_gt_i32 s75, 4
    s_cselect_b64 exec, -1, 1
    s_cselect_b32 s57, s73, 99328
    s_add_u32 m0, s57, 55296
    s_nop 0
    buffer_load_dwordx4 v8, s[28:31], s61 offen lds
    s_mov_b64 exec, -1
    s_add_u32 s61, s61, s56
    v_mfma_f32_16x16x32_bf16 v[84:87], v[184:187], v[172:175], v[84:87]
    ds_read_b64_tr_b16 v[152:153], v238 offset:128
    ds_read_b64_tr_b16 v[154:155], v239 offset:128
    s_add_u32 m0, s74, 51200
    s_nop 0
    buffer_load_dwordx4 v9, s[24:27], s60 offen lds
    v_mfma_f32_16x16x32_bf16 v[88:91], v[188:191], v[168:171], v[88:91]
    ds_read_b64_tr_b16 v[156:157], v238 offset:160
    ds_read_b64_tr_b16 v[158:159], v239 offset:160
    s_add_u32 m0, s74, 52224
    s_nop 0
    buffer_load_dwordx4 v10, s[24:27], s60 offen lds
    s_add_u32 s60, s60, 128
    v_mfma_f32_16x16x32_bf16 v[92:95], v[188:191], v[172:175], v[92:95]
    ds_read_b64_tr_b16 v[160:161], v238 offset:192
    ds_read_b64_tr_b16 v[162:163], v239 offset:192
    ds_read_b64_tr_b16 v[164:165], v238 offset:224
    v_mfma_f32_16x16x32_bf16 v[96:99], v[192:195], v[168:171], v[96:99]
    ds_read_b64_tr_b16 v[166:167], v239 offset:224
    v_mfma_f32_16x16x32_bf16 v[100:103], v[192:195], v[172:175], v[100:103]
    v_mfma_f32_16x16x32_bf16 v[104:107], v[196:199], v[168:171], v[104:107]
    v_mfma_f32_16x16x32_bf16 v[108:111], v[196:199], v[172:175], v[108:111]
    v_mfma_f32_16x16x32_bf16 v[112:115], v[200:203], v[168:171], v[112:115]
    v_mfma_f32_16x16x32_bf16 v[116:119], v[200:203], v[172:175], v[116:119]
    v_mfma_f32_16x16x32_bf16 v[120:123], v[204:207], v[168:171], v[120:123]
    v_mfma_f32_16x16x32_bf16 v[124:127], v[204:207], v[172:175], v[124:127]
    s_waitcnt lgkmcnt(0)
    v_mfma_f32_16x16x32_bf16 v[64:67], v[136:139], v[128:131], v[64:67]
    ds_read_b128 v[168:171], v237
    ds_read_b128 v[172:175], v237 offset:2048
    v_mfma_f32_16x16x32_bf16 v[68:71], v[136:139], v[132:135], v[68:71]
    ds_read_b64_tr_b16 v[176:177], v238 offset:17408
    ds_read_b64_tr_b16 v[178:179], v239 offset:17408
    v_mfma_f32_16x16x32_bf16 v[72:75], v[140:143], v[128:131], v[72:75]
    ds_read_b64_tr_b16 v[180:181], v238 offset:17440
    ds_read_b64_tr_b16 v[182:183], v239 offset:17440
    v_mfma_f32_16x16x32_bf16 v[76:79], v[140:143], v[132:135], v[76:79]
    ds_read_b64_tr_b16 v[184:185], v238 offset:17472
    ds_read_b64_tr_b16 v[186:187], v239 offset:17472
    v_mfma_f32_16x16x32_bf16 v[80:83], v[144:147], v[128:131], v[80:83]
    ds_read_b64_tr_b16 v[188:189], v238 offset:17504
    ds_read_b64_tr_b16 v[190:191], v239 offset:17504
    v_mfma_f32_16x16x32_bf16 v[84:87], v[144:147], v[132:135], v[84:87]
    ds_read_b64_tr_b16 v[192:193], v238 offset:17536
    ds_read_b64_tr_b16 v[194:195], v239 offset:17536
    v_mfma_f32_16x16x32_bf16 v[88:91], v[148:151], v[128:131], v[88:91]
    ds_read_b64_tr_b16 v[196:197], v238 offset:17568
    ds_read_b64_tr_b16 v[198:199], v239 offset:17568
    v_mfma_f32_16x16x32_bf16 v[92:95], v[148:151], v[132:135], v[92:95]
    ds_read_b64_tr_b16 v[200:201], v238 offset:17600
    ds_read_b64_tr_b16 v[202:203], v239 offset:17600
    v_mfma_f32_16x16x32_bf16 v[96:99], v[152:155], v[128:131], v[96:99]
    ds_read_b64_tr_b16 v[204:205], v238 offset:17632
    ds_read_b64_tr_b16 v[206:207], v239 offset:17632
    v_mfma_f32_16x16x32_bf16 v[100:103], v[152:155], v[132:135], v[100:103]
    v_mfma_f32_16x16x32_bf16 v[104:107], v[156:159], v[128:131], v[104:107]
    v_mfma_f32_16x16x32_bf16 v[108:111], v[156:159], v[132:135], v[108:111]
    v_mfma_f32_16x16x32_bf16 v[112:115], v[160:163], v[128:131], v[112:115]
    v_mfma_f32_16x16x32_bf16 v[116:119], v[160:163], v[132:135], v[116:119]
    v_mfma_f32_16x16x32_bf16 v[120:123], v[164:167], v[128:131], v[120:123]
    v_mfma_f32_16x16x32_bf16 v[124:127], v[164:167], v[132:135], v[124:127]
    s_waitcnt vmcnt(7) lgkmcnt(0)
    s_barrier
    v_mfma_f32_16x16x32_bf16 v[64:67], v[176:179], v[168:171], v[64:67]
    ds_read_b128 v[128:131], v228
    ds_read_b128 v[132:135], v228 offset:2048
    s_cmp_gt_i32 s75, 0
    s_cselect_b64 exec, -1, 1
    s_cselect_b32 s57, s73, 52224
    s_add_u32 m0, s57, 102400
    s_nop 0
    buffer_load_dwordx4 v4, s[28:31], s61 offen lds
    s_mov_b64 exec, -1
    v_mfma_f32_16x16x32_bf16 v[68:71], v[176:179], v[172:175], v[68:71]
    ds_read_b64_tr_b16 v[136:137], v230 offset:0
    ds_read_b64_tr_b16 v[138:139], v231 offset:0
    s_cmp_gt_i32 s75, 1
    s_cselect_b64 exec, -1, 1
    s_cselect_b32 s57, s73, 51200
    s_add_u32 m0, s57, 103424
    s_nop 0
    buffer_load_dwordx4 v5, s[28:31], s61 offen lds
    s_mov_b64 exec, -1
    v_mfma_f32_16x16x32_bf16 v[72:75], v[180:183], v[168:171], v[72:75]
    ds_read_b64_tr_b16 v[140:141], v230 offset:32
    ds_read_b64_tr_b16 v[142:143], v231 offset:32
    s_cmp_gt_i32 s75, 2
    s_cselect_b64 exec, -1, 1
    s_cselect_b32 s57, s73, 50176
    s_add_u32 m0, s57, 104448
    s_nop 0
    buffer_load_dwordx4 v6, s[28:31], s61 offen lds
    s_mov_b64 exec, -1
    v_mfma_f32_16x16x32_bf16 v[76:79], v[180:183], v[172:175], v[76:79]
    ds_read_b64_tr_b16 v[144:145], v230 offset:64
    ds_read_b64_tr_b16 v[146:147], v231 offset:64
    s_cmp_gt_i32 s75, 3
    s_cselect_b64 exec, -1, 1
    s_cselect_b32 s57, s73, 49152
    s_add_u32 m0, s57, 105472
    s_nop 0
    buffer_load_dwordx4 v7, s[28:31], s61 offen lds
    s_mov_b64 exec, -1
    v_mfma_f32_16x16x32_bf16 v[80:83], v[184:187], v[168:171], v[80:83]
    ds_read_b64_tr_b16 v[148:149], v230 offset:96
    ds_read_b64_tr_b16 v[150:151], v231 offset:96
    s_cmp_gt_i32 s75, 4
    s_cselect_b64 exec, -1, 1
    s_cselect_b32 s57, s73, 48128
    s_add_u32 m0, s57, 106496
    s_nop 0
    buffer_load_dwordx4 v8, s[28:31], s61 offen lds
    s_mov_b64 exec, -1
    s_add_u32 s61, s61, s56
    v_mfma_f32_16x16x32_bf16 v[84:87], v[184:187], v[172:175], v[84:87]
    ds_read_b64_tr_b16 v[152:153], v230 offset:128
    ds_read_b64_tr_b16 v[154:155], v231 offset:128
    s_add_u32 m0, s74, 102400
    s_nop 0
    buffer_load_dwordx4 v9, s[24:27], s60 offen lds
    v_mfma_f32_16x16x32_bf16 v[88:91], v[188:191], v[168:171], v[88:91]
    ds_read_b64_tr_b16 v[156:157], v230 offset:160
    ds_read_b64_tr_b16 v[158:159], v231 offset:160
    s_add_u32 m0, s74, 103424
    s_nop 0
    buffer_load_dwordx4 v10, s[24:27], s60 offen lds
    s_add_u32 s60, s60, 128
    v_mfma_f32_16x16x32_bf16 v[92:95], v[188:191], v[172:175], v[92:95]
    ds_read_b64_tr_b16 v[160:161], v230 offset:192
    ds_read_b64_tr_b16 v[162:163], v231 offset:192
    ds_read_b64_tr_b16 v[164:165], v230 offset:224
    v_mfma_f32_16x16x32_bf16 v[96:99], v[192:195], v[168:171], v[96:99]
    ds_read_b64_tr_b16 v[166:167], v231 offset:224
    v_mfma_f32_16x16x32_bf16 v[100:103], v[192:195], v[172:175], v[100:103]
    v_mfma_f32_16x16x32_bf16 v[104:107], v[196:199], v[168:171], v[104:107]
    v_mfma_f32_16x16x32_bf16 v[108:111], v[196:199], v[172:175], v[108:111]
    v_mfma_f32_16x16x32_bf16 v[112:115], v[200:203], v[168:171], v[112:115]
    s_cmp_eq_u32 s48, 0
    s_cbranch_scc0 K1_NSG2
    s_lshl_b32 s57, s51, 2
    s_add_u32 s57, s57, 64
    v_mov_b32 v24, s57
    s_lshl_b32 s57, s71, 2
    s_add_u32 s57, s57, 128
    v_mov_b32 v26, s57
    v_mov_b32 v25, 1
    s_mov_b64 exec, 1
    buffer_atomic_add v25, v24, s[44:47], 0 offen
    buffer_atomic_add v25, v26, s[44:47], 0 offen
    s_mov_b64 exec, -1
K1_NSG2:
    v_mfma_f32_16x16x32_bf16 v[116:119], v[200:203], v[172:175], v[116:119]
    v_mfma_f32_16x16x32_bf16 v[120:123], v[204:207], v[168:171], v[120:123]
    v_mfma_f32_16x16x32_bf16 v[124:127], v[204:207], v[172:175], v[124:127]
    s_waitcnt lgkmcnt(0)
    v_mfma_f32_16x16x32_bf16 v[64:67], v[136:139], v[128:131], v[64:67]
    ds_read_b128 v[168:171], v229
    ds_read_b128 v[172:175], v229 offset:2048
    v_mfma_f32_16x16x32_bf16 v[68:71], v[136:139], v[132:135], v[68:71]
    ds_read_b64_tr_b16 v[176:177], v230 offset:17408
    ds_read_b64_tr_b16 v[178:179], v231 offset:17408
    v_mfma_f32_16x16x32_bf16 v[72:75], v[140:143], v[128:131], v[72:75]
    ds_read_b64_tr_b16 v[180:181], v230 offset:17440
    ds_read_b64_tr_b16 v[182:183], v231 offset:17440
    v_mfma_f32_16x16x32_bf16 v[76:79], v[140:143], v[132:135], v[76:79]
    ds_read_b64_tr_b16 v[184:185], v230 offset:17472
    ds_read_b64_tr_b16 v[186:187], v231 offset:17472
    v_mfma_f32_16x16x32_bf16 v[80:83], v[144:147], v[128:131], v[80:83]
    ds_read_b64_tr_b16 v[188:189], v230 offset:17504
    ds_read_b64_tr_b16 v[190:191], v231 offset:17504
    v_mfma_f32_16x16x32_bf16 v[84:87], v[144:147], v[132:135], v[84:87]
    ds_read_b64_tr_b16 v[192:193], v230 offset:17536
    ds_read_b64_tr_b16 v[194:195], v231 offset:17536
    v_mfma_f32_16x16x32_bf16 v[88:91], v[148:151], v[128:131], v[88:91]
    ds_read_b64_tr_b16 v[196:197], v230 offset:17568
    ds_read_b64_tr_b16 v[198:199], v231 offset:17568
    v_mfma_f32_16x16x32_bf16 v[92:95], v[148:151], v[132:135], v[92:95]
    ds_read_b64_tr_b16 v[200:201], v230 offset:17600
    ds_read_b64_tr_b16 v[202:203], v231 offset:17600
    v_mfma_f32_16x16x32_bf16 v[96:99], v[152:155], v[128:131], v[96:99]
    ds_read_b64_tr_b16 v[204:205], v230 offset:17632
    ds_read_b64_tr_b16 v[206:207], v231 offset:17632
    v_mfma_f32_16x16x32_bf16 v[100:103], v[152:155], v[132:135], v[100:103]
    v_mfma_f32_16x16x32_bf16 v[104:107], v[156:159], v[128:131], v[104:107]
    v_mfma_f32_16x16x32_bf16 v[108:111], v[156:159], v[132:135], v[108:111]
    v_mfma_f32_16x16x32_bf16 v[112:115], v[160:163], v[128:131], v[112:115]
    v_mfma_f32_16x16x32_bf16 v[116:119], v[160:163], v[132:135], v[116:119]
    v_mfma_f32_16x16x32_bf16 v[120:123], v[164:167], v[128:131], v[120:123]
    v_mfma_f32_16x16x32_bf16 v[124:127], v[164:167], v[132:135], v[124:127]
    s_waitcnt vmcnt(7) lgkmcnt(0)
    s_barrier
    v_mfma_f32_16x16x32_bf16 v[64:67], v[176:179], v[168:171], v[64:67]
    ds_read_b128 v[128:131], v232
    ds_read_b128 v[132:135], v232 offset:2048
    s_cmp_gt_i32 s75, 0
    s_cselect_b64 exec, -1, 1
    s_cselect_b32 s57, s73, 154624
    s_add_u32 m0, s57, 0
    s_nop 0
    buffer_load_dwordx4 v4, s[28:31], s61 offen lds
    s_mov_b64 exec, -1
    v_mfma_f32_16x16x32_bf16 v[68:71], v[176:179], v[172:175], v[68:71]
    ds_read_b64_tr_b16 v[136:137], v234 offset:0
    ds_read_b64_tr_b16 v[138:139], v235 offset:0
    s_cmp_gt_i32 s75, 1
    s_cselect_b64 exec, -1, 1
    s_cselect_b32 s57, s73, 153600
    s_add_u32 m0, s57, 1024
    s_nop 0
    buffer_load_dwordx4 v5, s[28:31], s61 offen lds
    s_mov_b64 exec, -1
    v_mfma_f32_16x16x32_bf16 v[72:75], v[180:183], v[168:171], v[72:75]
    ds_read_b64_tr_b16 v[140:141], v234 offset:32
    ds_read_b64_tr_b16 v[142:143], v235 offset:32
    s_cmp_gt_i32 s75, 2
    s_cselect_b64 exec, -1, 1
    s_cselect_b32 s57, s73, 152576
    s_add_u32 m0, s57, 2048
    s_nop 0
    buffer_load_dwordx4 v6, s[28:31], s61 offen lds
    s_mov_b64 exec, -1
    v_mfma_f32_16x16x32_bf16 v[76:79], v[180:183], v[172:175], v[76:79]
    ds_read_b64_tr_b16 v[144:145], v234 offset:64
    ds_read_b64_tr_b16 v[146:147], v235 offset:64
    s_cmp_gt_i32 s75, 3
    s_cselect_b64 exec, -1, 1
    s_cselect_b32 s57, s73, 151552
    s_add_u32 m0, s57, 3072
    s_nop 0
    buffer_load_dwordx4 v7, s[28:31], s61 offen lds
    s_mov_b64 exec, -1
    v_mfma_f32_16x16x32_bf16 v[80:83], v[184:187], v[168:171], v[80:83]
    ds_read_b64_tr_b16 v[148:149], v234 offset:96
    ds_read_b64_tr_b16 v[150:151], v235 offset:96
    s_cmp_gt_i32 s75, 4
    s_cselect_b64 exec, -1, 1
    s_cselect_b32 s57, s73, 150528
    s_add_u32 m0, s57, 4096
    s_nop 0
    buffer_load_dwordx4 v8, s[28:31], s61 offen lds
    s_mov_b64 exec, -1
    s_add_u32 s61, s61, s56
    v_mfma_f32_16x16x32_bf16 v[84:87], v[184:187], v[172:175], v[84:87]
    ds_read_b64_tr_b16 v[152:153], v234 offset:128
    ds_read_b64_tr_b16 v[154:155], v235 offset:128
    s_add_u32 m0, s74, 0
    s_nop 0
    buffer_load_dwordx4 v9, s[24:27], s60 offen lds
    v_mfma_f32_16x16x32_bf16 v[88:91], v[188:191], v[168:171], v[88:91]
    ds_read_b64_tr_b16 v[156:157], v234 offset:160
    ds_read_b64_tr_b16 v[158:159], v235 offset:160
    s_add_u32 m0, s74, 1024
    s_nop 0
    buffer_load_dwordx4 v10, s[24:27], s60 offen lds
    s_add_u32 s60, s60, 128
    v_mfma_f32_16x16x32_bf16 v[92:95], v[188:191], v[172:175], v[92:95]
    ds_read_b64_tr_b16 v[160:161], v234 offset:192
    ds_read_b64_tr_b16 v[162:163], v235 offset:192
    ds_read_b64_tr_b16 v[164:165], v234 offset:224
    v_mfma_f32_16x16x32_bf16 v[96:99], v[192:195], v[168:171], v[96:99]
    ds_read_b64_tr_b16 v[166:167], v235 offset:224
    v_mfma_f32_16x16x32_bf16 v[100:103], v[192:195], v[172:175], v[100:103]
    v_mfma_f32_16x16x32_bf16 v[104:107], v[196:199], v[168:171], v[104:107]
    v_mfma_f32_16x16x32_bf16 v[108:111], v[196:199], v[172:175], v[108:111]
    v_mfma_f32_16x16x32_bf16 v[112:115], v[200:203], v[168:171], v[112:115]
    v_mfma_f32_16x16x32_bf16 v[116:119], v[200:203], v[172:175], v[116:119]
    v_mfma_f32_16x16x32_bf16 v[120:123], v[204:207], v[168:171], v[120:123]
    v_mfma_f32_16x16x32_bf16 v[124:127], v[204:207], v[172:175], v[124:127]
    s_waitcnt lgkmcnt(0)
    v_mfma_f32_16x16x32_bf16 v[64:67], v[136:139], v[128:131], v[64:67]
    ds_read_b128 v[168:171], v233
    ds_read_b128 v[172:175], v233 offset:2048
    v_mfma_f32_16x16x32_bf16 v[68:71], v[136:139], v[132:135], v[68:71]
    ds_read_b64_tr_b16 v[176:177], v234 offset:17408
    ds_read_b64_tr_b16 v[178:179], v235 offset:17408
    v_mfma_f32_16x16x32_bf16 v[72:75], v[140:143], v[128:131], v[72:75]
    ds_read_b64_tr_b16 v[180:181], v234 offset:17440
    ds_read_b64_tr_b16 v[182:183], v235 offset:17440
    v_mfma_f32_16x16x32_bf16 v[76:79], v[140:143], v[132:135], v[76:79]
    ds_read_b64_tr_b16 v[184:185], v234 offset:17472
    ds_read_b64_tr_b16 v[186:187], v235 offset:17472
    v_mfma_f32_16x16x32_bf16 v[80:83], v[144:147], v[128:131], v[80:83]
    ds_read_b64_tr_b16 v[188:189], v234 offset:17504
    ds_read_b64_tr_b16 v[190:191], v235 offset:17504
    v_mfma_f32_16x16x32_bf16 v[84:87], v[144:147], v[132:135], v[84:87]
    ds_read_b64_tr_b16 v[192:193], v234 offset:17536
    ds_read_b64_tr_b16 v[194:195], v235 offset:17536
    v_mfma_f32_16x16x32_bf16 v[88:91], v[148:151], v[128:131], v[88:91]
    ds_read_b64_tr_b16 v[196:197], v234 offset:17568
    ds_read_b64_tr_b16 v[198:199], v235 offset:17568
    v_mfma_f32_16x16x32_bf16 v[92:95], v[148:151], v[132:135], v[92:95]
    ds_read_b64_tr_b16 v[200:201], v234 offset:17600
    ds_read_b64_tr_b16 v[202:203], v235 offset:17600
    v_mfma_f32_16x16x32_bf16 v[96:99], v[152:155], v[128:131], v[96:99]
    ds_read_b64_tr_b16 v[204:205], v234 offset:17632
    ds_read_b64_tr_b16 v[206:207], v235 offset:17632
    v_mfma_f32_16x16x32_bf16 v[100:103], v[152:155], v[132:135], v[100:103]
    v_mfma_f32_16x16x32_bf16 v[104:107], v[156:159], v[128:131], v[104:107]
    v_mfma_f32_16x16x32_bf16 v[108:111], v[156:159], v[132:135], v[108:111]
    v_mfma_f32_16x16x32_bf16 v[112:115], v[160:163], v[128:131], v[112:115]
    v_mfma_f32_16x16x32_bf16 v[116:119], v[160:163], v[132:135], v[116:119]
    v_mfma_f32_16x16x32_bf16 v[120:123], v[164:167], v[128:131], v[120:123]
    v_mfma_f32_16x16x32_bf16 v[124:127], v[164:167], v[132:135], v[124:127]
    s_waitcnt vmcnt(7) lgkmcnt(0)
    s_barrier
    v_mfma_f32_16x16x32_bf16 v[64:67], v[176:179], v[168:171], v[64:67]
    ds_read_b128 v[128:131], v236
    ds_read_b128 v[132:135], v236 offset:2048
    s_cmp_gt_i32 s75, 0
    s_cselect_b64 exec, -1, 1
    s_cselect_b32 s57, s73, 103424
    s_add_u32 m0, s57, 51200
    s_nop 0
    buffer_load_dwordx4 v4, s[28:31], s61 offen lds
    s_mov_b64 exec, -1
    v_mfma_f32_16x16x32_bf16 v[68:71], v[176:179], v[172:175], v[68:71]
    ds_read_b64_tr_b16 v[136:137], v238 offset:0
    ds_read_b64_tr_b16 v[138:139], v239 offset:0
    s_cmp_gt_i32 s75, 1
    s_cselect_b64 exec, -1, 1
    s_cselect_b32 s57, s73, 102400
    s_add_u32 m0, s57, 52224
    s_nop 0
    buffer_load_dwordx4 v5, s[28:31], s61 offen lds
    s_mov_b64 exec, -1
    v_mfma_f32_16x16x32_bf16 v[72:75], v[180:183], v[168:171], v[72:75]
    ds_read_b64_tr_b16 v[140:141], v238 offset:32
    ds_read_b64_tr_b16 v[142:143], v239 offset:32
    s_cmp_gt_i32 s75, 2
    s_cselect_b64 exec, -1, 1
    s_cselect_b32 s57, s73, 101376
    s_add_u32 m0, s57, 53248
    s_nop 0
    buffer_load_dwordx4 v6, s[28:31], s61 offen lds
    s_mov_b64 exec, -1
    v_mfma_f32_16x16x32_bf16 v[76:79], v[180:183], v[172:175], v[76:79]
    ds_read_b64_tr_b16 v[144:145], v238 offset:64
    ds_read_b64_tr_b16 v[146:147], v239 offset:64
    s_cmp_gt_i32 s75, 3
    s_cselect_b64 exec, -1, 1
    s_cselect_b32 s57, s73, 100352
    s_add_u32 m0, s57, 54272
    s_nop 0
    buffer_load_dwordx4 v7, s[28:31], s61 offen lds
    s_mov_b64 exec, -1
    v_mfma_f32_16x16x32_bf16 v[80:83], v[184:187], v[168:171], v[80:83]
    ds_read_b64_tr_b16 v[148:149], v238 offset:96
    ds_read_b64_tr_b16 v[150:151], v239 offset:96
    s_cmp_gt_i32 s75, 4
    s_cselect_b64 exec, -1, 1
    s_cselect_b32 s57, s73, 99328
    s_add_u32 m0, s57, 55296
    s_nop 0
    buffer_load_dwordx4 v8, s[28:31], s61 offen lds
    s_mov_b64 exec, -1
    s_add_u32 s61, s61, s56
    v_mfma_f32_16x16x32_bf16 v[84:87], v[184:187], v[172:175], v[84:87]
    ds_read_b64_tr_b16 v[152:153], v238 offset:128
    ds_read_b64_tr_b16 v[154:155], v239 offset:128
    s_add_u32 m0, s74, 51200
    s_nop 0
    buffer_load_dwordx4 v9, s[24:27], s60 offen lds
    v_mfma_f32_16x16x32_bf16 v[88:91], v[188:191], v[168:171], v[88:91]
    ds_read_b64_tr_b16 v[156:157], v238 offset:160
    ds_read_b64_tr_b16 v[158:159], v239 offset:160
    s_add_u32 m0, s74, 52224
    s_nop 0
    buffer_load_dwordx4 v10, s[24:27], s60 offen lds
    s_add_u32 s60, s60, 128
    v_mfma_f32_16x16x32_bf16 v[92:95], v[188:191], v[172:175], v[92:95]
    ds_read_b64_tr_b16 v[160:161], v238 offset:192
    ds_read_b64_tr_b16 v[162:163], v239 offset:192
    ds_read_b64_tr_b16 v[164:165], v238 offset:224
    v_mfma_f32_16x16x32_bf16 v[96:99], v[192:195], v[168:171], v[96:99]
    ds_read_b64_tr_b16 v[166:167], v239 offset:224
    v_mfma_f32_16x16x32_bf16 v[100:103], v[192:195], v[172:175], v[100:103]
    v_mfma_f32_16x16x32_bf16 v[104:107], v[196:199], v[168:171], v[104:107]
    v_mfma_f32_16x16x32_bf16 v[108:111], v[196:199], v[172:175], v[108:111]
    v_mfma_f32_16x16x32_bf16 v[112:115], v[200:203], v[168:171], v[112:115]
    v_mfma_f32_16x16x32_bf16 v[116:119], v[200:203], v[172:175], v[116:119]
    v_mfma_f32_16x16x32_bf16 v[120:123], v[204:207], v[168:171], v[120:123]
    v_mfma_f32_16x16x32_bf16 v[124:127], v[204:207], v[172:175], v[124:127]
    s_waitcnt lgkmcnt(0)
    v_mfma_f32_16x16x32_bf16 v[64:67], v[136:139], v[128:131], v[64:67]
    ds_read_b128 v[168:171], v237
    ds_read_b128 v[172:175], v237 offset:2048
    v_mfma_f32_16x16x32_bf16 v[68:71], v[136:139], v[132:135], v[68:71]
    ds_read_b64_tr_b16 v[176:177], v238 offset:17408
    ds_read_b64_tr_b16 v[178:179], v239 offset:17408
    v_mfma_f32_16x16x32_bf16 v[72:75], v[140:143], v[128:131], v[72:75]
    ds_read_b64_tr_b16 v[180:181], v238 offset:17440
    ds_read_b64_tr_b16 v[182:183], v239 offset:17440
    v_mfma_f32_16x16x32_bf16 v[76:79], v[140:143], v[132:135], v[76:79]
    ds_read_b64_tr_b16 v[184:185], v238 offset:17472
    ds_read_b64_tr_b16 v[186:187], v239 offset:17472
    v_mfma_f32_16x16x32_bf16 v[80:83], v[144:147], v[128:131], v[80:83]
    ds_read_b64_tr_b16 v[188:189], v238 offset:17504
    ds_read_b64_tr_b16 v[190:191], v239 offset:17504
    v_mfma_f32_16x16x32_bf16 v[84:87], v[144:147], v[132:135], v[84:87]
    ds_read_b64_tr_b16 v[192:193], v238 offset:17536
    ds_read_b64_tr_b16 v[194:195], v239 offset:17536
    v_mfma_f32_16x16x32_bf16 v[88:91], v[148:151], v[128:131], v[88:91]
    ds_read_b64_tr_b16 v[196:197], v238 offset:17568
    ds_read_b64_tr_b16 v[198:199], v239 offset:17568
    v_mfma_f32_16x16x32_bf16 v[92:95], v[148:151], v[132:135], v[92:95]
    ds_read_b64_tr_b16 v[200:201], v238 offset:17600
    ds_read_b64_tr_b16 v[202:203], v239 offset:17600
    v_mfma_f32_16x16x32_bf16 v[96:99], v[152:155], v[128:131], v[96:99]
    ds_read_b64_tr_b16 v[204:205], v238 offset:17632
    ds_read_b64_tr_b16 v[206:207], v239 offset:17632
    v_mfma_f32_16x16x32_bf16 v[100:103], v[152:155], v[132:135], v[100:103]
    v_mfma_f32_16x16x32_bf16 v[104:107], v[156:159], v[128:131], v[104:107]
    v_mfma_f32_16x16x32_bf16 v[108:111], v[156:159], v[132:135], v[108:111]
    v_mfma_f32_16x16x32_bf16 v[112:115], v[160:163], v[128:131], v[112:115]
    v_mfma_f32_16x16x32_bf16 v[116:119], v[160:163], v[132:135], v[116:119]
    v_mfma_f32_16x16x32_bf16 v[120:123], v[164:167], v[128:131], v[120:123]
    v_mfma_f32_16x16x32_bf16 v[124:127], v[164:167], v[132:135], v[124:127]
    s_waitcnt vmcnt(7) lgkmcnt(0)
    s_barrier
    v_mfma_f32_16x16x32_bf16 v[64:67], v[176:179], v[168:171], v[64:67]
    ds_read_b128 v[128:131], v228
    ds_read_b128 v[132:135], v228 offset:2048
    s_cmp_gt_i32 s75, 0
    s_cselect_b64 exec, -1, 1
    s_cselect_b32 s57, s73, 52224
    s_add_u32 m0, s57, 102400
    s_nop 0
    buffer_load_dwordx4 v4, s[28:31], s61 offen lds
    s_mov_b64 exec, -1
    v_mfma_f32_16x16x32_bf16 v[68:71], v[176:179], v[172:175], v[68:71]
    ds_read_b64_tr_b16 v[136:137], v230 offset:0
    ds_read_b64_tr_b16 v[138:139], v231 offset:0
    s_cmp_gt_i32 s75, 1
    s_cselect_b64 exec, -1, 1
    s_cselect_b32 s57, s73, 51200
    s_add_u32 m0, s57, 103424
    s_nop 0
    buffer_load_dwordx4 v5, s[28:31], s61 offen lds
    s_mov_b64 exec, -1
    v_mfma_f32_16x16x32_bf16 v[72:75], v[180:183], v[168:171], v[72:75]
    ds_read_b64_tr_b16 v[140:141], v230 offset:32
    ds_read_b64_tr_b16 v[142:143], v231 offset:32
    s_cmp_gt_i32 s75, 2
    s_cselect_b64 exec, -1, 1
    s_cselect_b32 s57, s73, 50176
    s_add_u32 m0, s57, 104448
    s_nop 0
    buffer_load_dwordx4 v6, s[28:31], s61 offen lds
    s_mov_b64 exec, -1
    v_mfma_f32_16x16x32_bf16 v[76:79], v[180:183], v[172:175], v[76:79]
    ds_read_b64_tr_b16 v[144:145], v230 offset:64
    ds_read_b64_tr_b16 v[146:147], v231 offset:64
    s_cmp_gt_i32 s75, 3
    s_cselect_b64 exec, -1, 1
    s_cselect_b32 s57, s73, 49152
    s_add_u32 m0, s57, 105472
    s_nop 0
    buffer_load_dwordx4 v7, s[28:31], s61 offen lds
    s_mov_b64 exec, -1
    v_mfma_f32_16x16x32_bf16 v[80:83], v[184:187], v[168:171], v[80:83]
    ds_read_b64_tr_b16 v[148:149], v230 offset:96
    ds_read_b64_tr_b16 v[150:151], v231 offset:96
    s_cmp_gt_i32 s75, 4
    s_cselect_b64 exec, -1, 1
    s_cselect_b32 s57, s73, 48128
    s_add_u32 m0, s57, 106496
    s_nop 0
    buffer_load_dwordx4 v8, s[28:31], s61 offen lds
    s_mov_b64 exec, -1
    s_add_u32 s61, s61, s56
    v_mfma_f32_16x16x32_bf16 v[84:87], v[184:187], v[172:175], v[84:87]
    ds_read_b64_tr_b16 v[152:153], v230 offset:128
    ds_read_b64_tr_b16 v[154:155], v231 offset:128
    s_add_u32 m0, s74, 102400
    s_nop 0
    buffer_load_dwordx4 v9, s[24:27], s60 offen lds
    v_mfma_f32_16x16x32_bf16 v[88:91], v[188:191], v[168:171], v[88:91]
    ds_read_b64_tr_b16 v[156:157], v230 offset:160
    ds_read_b64_tr_b16 v[158:159], v231 offset:160
    s_add_u32 m0, s74, 103424
    s_nop 0
    buffer_load_dwordx4 v10, s[24:27], s60 offen lds
    s_add_u32 s60, s60, 128
    v_mfma_f32_16x16x32_bf16 v[92:95], v[188:191], v[172:175], v[92:95]
    ds_read_b64_tr_b16 v[160:161], v230 offset:192
    ds_read_b64_tr_b16 v[162:163], v231 offset:192
    ds_read_b64_tr_b16 v[164:165], v230 offset:224
    v_mfma_f32_16x16x32_bf16 v[96:99], v[192:195], v[168:171], v[96:99]
    ds_read_b64_tr_b16 v[166:167], v231 offset:224
    v_mfma_f32_16x16x32_bf16 v[100:103], v[192:195], v[172:175], v[100:103]
    v_mfma_f32_16x16x32_bf16 v[104:107], v[196:199], v[168:171], v[104:107]
    v_mfma_f32_16x16x32_bf16 v[108:111], v[196:199], v[172:175], v[108:111]
    v_mfma_f32_16x16x32_bf16 v[112:115], v[200:203], v[168:171], v[112:115]
    v_mfma_f32_16x16x32_bf16 v[116:119], v[200:203], v[172:175], v[116:119]
    v_mfma_f32_16x16x32_bf16 v[120:123], v[204:207], v[168:171], v[120:123]
    v_mfma_f32_16x16x32_bf16 v[124:127], v[204:207], v[172:175], v[124:127]
    s_waitcnt lgkmcnt(0)
    v_mfma_f32_16x16x32_bf16 v[64:67], v[136:139], v[128:131], v[64:67]
    ds_read_b128 v[168:171], v229
    ds_read_b128 v[172:175], v229 offset:2048
    v_mfma_f32_16x16x32_bf16 v[68:71], v[136:139], v[132:135], v[68:71]
    ds_read_b64_tr_b16 v[176:177], v230 offset:17408
    ds_read_b64_tr_b16 v[178:179], v231 offset:17408
    v_mfma_f32_16x16x32_bf16 v[72:75], v[140:143], v[128:131], v[72:75]
    ds_read_b64_tr_b16 v[180:181], v230 offset:17440
    ds_read_b64_tr_b16 v[182:183], v231 offset:17440
    v_mfma_f32_16x16x32_bf16 v[76:79], v[140:143], v[132:135], v[76:79]
    ds_read_b64_tr_b16 v[184:185], v230 offset:17472
    ds_read_b64_tr_b16 v[186:187], v231 offset:17472
    v_mfma_f32_16x16x32_bf16 v[80:83], v[144:147], v[128:131], v[80:83]
    ds_read_b64_tr_b16 v[188:189], v230 offset:17504
    ds_read_b64_tr_b16 v[190:191], v231 offset:17504
    v_mfma_f32_16x16x32_bf16 v[84:87], v[144:147], v[132:135], v[84:87]
    ds_read_b64_tr_b16 v[192:193], v230 offset:17536
    ds_read_b64_tr_b16 v[194:195], v231 offset:17536
    v_mfma_f32_16x16x32_bf16 v[88:91], v[148:151], v[128:131], v[88:91]
    ds_read_b64_tr_b16 v[196:197], v230 offset:17568
    ds_read_b64_tr_b16 v[198:199], v231 offset:17568
    v_mfma_f32_16x16x32_bf16 v[92:95], v[148:151], v[132:135], v[92:95]
    ds_read_b64_tr_b16 v[200:201], v230 offset:17600
    ds_read_b64_tr_b16 v[202:203], v231 offset:17600
    v_mfma_f32_16x16x32_bf16 v[96:99], v[152:155], v[128:131], v[96:99]
    ds_read_b64_tr_b16 v[204:205], v230 offset:17632
    ds_read_b64_tr_b16 v[206:207], v231 offset:17632
    v_mfma_f32_16x16x32_bf16 v[100:103], v[152:155], v[132:135], v[100:103]
    v_mfma_f32_16x16x32_bf16 v[104:107], v[156:159], v[128:131], v[104:107]
    v_mfma_f32_16x16x32_bf16 v[108:111], v[156:159], v[132:135], v[108:111]
    v_mfma_f32_16x16x32_bf16 v[112:115], v[160:163], v[128:131], v[112:115]
    v_mfma_f32_16x16x32_bf16 v[116:119], v[160:163], v[132:135], v[116:119]
    v_mfma_f32_16x16x32_bf16 v[120:123], v[164:167], v[128:131], v[120:123]
    v_mfma_f32_16x16x32_bf16 v[124:127], v[164:167], v[132:135], v[124:127]
    s_waitcnt vmcnt(7) lgkmcnt(0)
    s_barrier
    v_mfma_f32_16x16x32_bf16 v[64:67], v[176:179], v[168:171], v[64:67]
    ds_read_b128 v[128:131], v232
    ds_read_b128 v[132:135], v232 offset:2048
    s_cmp_gt_i32 s75, 0
    s_cselect_b64 exec, -1, 1
    s_cselect_b32 s57, s73, 154624
    s_add_u32 m0, s57, 0
    s_nop 0
    buffer_load_dwordx4 v4, s[28:31], s61 offen lds
    s_mov_b64 exec, -1
    v_mfma_f32_16x16x32_bf16 v[68:71], v[176:179], v[172:175], v[68:71]
    ds_read_b64_tr_b16 v[136:137], v234 offset:0
    ds_read_b64_tr_b16 v[138:139], v235 offset:0
    s_cmp_gt_i32 s75, 1
    s_cselect_b64 exec, -1, 1
    s_cselect_b32 s57, s73, 153600
    s_add_u32 m0, s57, 1024
    s_nop 0
    buffer_load_dwordx4 v5, s[28:31], s61 offen lds
    s_mov_b64 exec, -1
    v_mfma_f32_16x16x32_bf16 v[72:75], v[180:183], v[168:171], v[72:75]
    ds_read_b64_tr_b16 v[140:141], v234 offset:32
    ds_read_b64_tr_b16 v[142:143], v235 offset:32
    s_cmp_gt_i32 s75, 2
    s_cselect_b64 exec, -1, 1
    s_cselect_b32 s57, s73, 152576
    s_add_u32 m0, s57, 2048
    s_nop 0
    buffer_load_dwordx4 v6, s[28:31], s61 offen lds
    s_mov_b64 exec, -1
    v_mfma_f32_16x16x32_bf16 v[76:79], v[180:183], v[172:175], v[76:79]
    ds_read_b64_tr_b16 v[144:145], v234 offset:64
    ds_read_b64_tr_b16 v[146:147], v235 offset:64
    s_cmp_gt_i32 s75, 3
    s_cselect_b64 exec, -1, 1
    s_cselect_b32 s57, s73, 151552
    s_add_u32 m0, s57, 3072
    s_nop 0
    buffer_load_dwordx4 v7, s[28:31], s61 offen lds
    s_mov_b64 exec, -1
    v_mfma_f32_16x16x32_bf16 v[80:83], v[184:187], v[168:171], v[80:83]
    ds_read_b64_tr_b16 v[148:149], v234 offset:96
    ds_read_b64_tr_b16 v[150:151], v235 offset:96
    s_cmp_gt_i32 s75, 4
    s_cselect_b64 exec, -1, 1
    s_cselect_b32 s57, s73, 150528
    s_add_u32 m0, s57, 4096
    s_nop 0
    buffer_load_dwordx4 v8, s[28:31], s61 offen lds
    s_mov_b64 exec, -1
    s_add_u32 s61, s61, s56
    v_mfma_f32_16x16x32_bf16 v[84:87], v[184:187], v[172:175], v[84:87]
    ds_read_b64_tr_b16 v[152:153], v234 offset:128
    ds_read_b64_tr_b16 v[154:155], v235 offset:128
    s_add_u32 m0, s74, 0
    s_nop 0
    buffer_load_dwordx4 v9, s[24:27], s60 offen lds
    v_mfma_f32_16x16x32_bf16 v[88:91], v[188:191], v[168:171], v[88:91]
    ds_read_b64_tr_b16 v[156:157], v234 offset:160
    ds_read_b64_tr_b16 v[158:159], v235 offset:160
    s_add_u32 m0, s74, 1024
    s_nop 0
    buffer_load_dwordx4 v10, s[24:27], s60 offen lds
    s_add_u32 s60, s60, 128
    v_mfma_f32_16x16x32_bf16 v[92:95], v[188:191], v[172:175], v[92:95]
    ds_read_b64_tr_b16 v[160:161], v234 offset:192
    ds_read_b64_tr_b16 v[162:163], v235 offset:192
    ds_read_b64_tr_b16 v[164:165], v234 offset:224
    v_mfma_f32_16x16x32_bf16 v[96:99], v[192:195], v[168:171], v[96:99]
    ds_read_b64_tr_b16 v[166:167], v235 offset:224
    v_mfma_f32_16x16x32_bf16 v[100:103], v[192:195], v[172:175], v[100:103]
    v_mfma_f32_16x16x32_bf16 v[104:107], v[196:199], v[168:171], v[104:107]
    v_mfma_f32_16x16x32_bf16 v[108:111], v[196:199], v[172:175], v[108:111]
    v_mfma_f32_16x16x32_bf16 v[112:115], v[200:203], v[168:171], v[112:115]
    v_mfma_f32_16x16x32_bf16 v[116:119], v[200:203], v[172:175], v[116:119]
    v_mfma_f32_16x16x32_bf16 v[120:123], v[204:207], v[168:171], v[120:123]
    v_mfma_f32_16x16x32_bf16 v[124:127], v[204:207], v[172:175], v[124:127]
    s_waitcnt lgkmcnt(0)
    v_mfma_f32_16x16x32_bf16 v[64:67], v[136:139], v[128:131], v[64:67]
    ds_read_b128 v[168:171], v233
    ds_read_b128 v[172:175], v233 offset:2048
    v_mfma_f32_16x16x32_bf16 v[68:71], v[136:139], v[132:135], v[68:71]
    ds_read_b64_tr_b16 v[176:177], v234 offset:17408
    ds_read_b64_tr_b16 v[178:179], v235 offset:17408
    v_mfma_f32_16x16x32_bf16 v[72:75], v[140:143], v[128:131], v[72:75]
    ds_read_b64_tr_b16 v[180:181], v234 offset:17440
    ds_read_b64_tr_b16 v[182:183], v235 offset:17440
    v_mfma_f32_16x16x32_bf16 v[76:79], v[140:143], v[132:135], v[76:79]
    ds_read_b64_tr_b16 v[184:185], v234 offset:17472
    ds_read_b64_tr_b16 v[186:187], v235 offset:17472
    v_mfma_f32_16x16x32_bf16 v[80:83], v[144:147], v[128:131], v[80:83]
    ds_read_b64_tr_b16 v[188:189], v234 offset:17504
    ds_read_b64_tr_b16 v[190:191], v235 offset:17504
    v_mfma_f32_16x16x32_bf16 v[84:87], v[144:147], v[132:135], v[84:87]
    ds_read_b64_tr_b16 v[192:193], v234 offset:17536
    ds_read_b64_tr_b16 v[194:195], v235 offset:17536
    v_mfma_f32_16x16x32_bf16 v[88:91], v[148:151], v[128:131], v[88:91]
    ds_read_b64_tr_b16 v[196:197], v234 offset:17568
    ds_read_b64_tr_b16 v[198:199], v235 offset:17568
    v_mfma_f32_16x16x32_bf16 v[92:95], v[148:151], v[132:135], v[92:95]
    ds_read_b64_tr_b16 v[200:201], v234 offset:17600
    ds_read_b64_tr_b16 v[202:203], v235 offset:17600
    v_mfma_f32_16x16x32_bf16 v[96:99], v[152:155], v[128:131], v[96:99]
    ds_read_b64_tr_b16 v[204:205], v234 offset:17632
    ds_read_b64_tr_b16 v[206:207], v235 offset:17632
    v_mfma_f32_16x16x32_bf16 v[100:103], v[152:155], v[132:135], v[100:103]
    v_mfma_f32_16x16x32_bf16 v[104:107], v[156:159], v[128:131], v[104:107]
    v_mfma_f32_16x16x32_bf16 v[108:111], v[156:159], v[132:135], v[108:111]
    v_mfma_f32_16x16x32_bf16 v[112:115], v[160:163], v[128:131], v[112:115]
    v_mfma_f32_16x16x32_bf16 v[116:119], v[160:163], v[132:135], v[116:119]
    v_mfma_f32_16x16x32_bf16 v[120:123], v[164:167], v[128:131], v[120:123]
    v_mfma_f32_16x16x32_bf16 v[124:127], v[164:167], v[132:135], v[124:127]
    s_waitcnt vmcnt(7) lgkmcnt(0)
    s_barrier
    v_mfma_f32_16x16x32_bf16 v[64:67], v[176:179], v[168:171], v[64:67]
    ds_read_b128 v[128:131], v236
    ds_read_b128 v[132:135], v236 offset:2048
    v_mfma_f32_16x16x32_bf16 v[68:71], v[176:179], v[172:175], v[68:71]
    ds_read_b64_tr_b16 v[136:137], v238 offset:0
    ds_read_b64_tr_b16 v[138:139], v239 offset:0
    v_mfma_f32_16x16x32_bf16 v[72:75], v[180:183], v[168:171], v[72:75]
    ds_read_b64_tr_b16 v[140:141], v238 offset:32
    ds_read_b64_tr_b16 v[142:143], v239 offset:32
    v_mfma_f32_16x16x32_bf16 v[76:79], v[180:183], v[172:175], v[76:79]
    ds_read_b64_tr_b16 v[144:145], v238 offset:64
    ds_read_b64_tr_b16 v[146:147], v239 offset:64
    v_mfma_f32_16x16x32_bf16 v[80:83], v[184:187], v[168:171], v[80:83]
    ds_read_b64_tr_b16 v[148:149], v238 offset:96
    ds_read_b64_tr_b16 v[150:151], v239 offset:96
    v_mfma_f32_16x16x32_bf16 v[84:87], v[184:187], v[172:175], v[84:87]
    ds_read_b64_tr_b16 v[152:153], v238 offset:128
    ds_read_b64_tr_b16 v[154:155], v239 offset:128
    v_mfma_f32_16x16x32_bf16 v[88:91], v[188:191], v[168:171], v[88:91]
    ds_read_b64_tr_b16 v[156:157], v238 offset:160
    ds_read_b64_tr_b16 v[158:159], v239 offset:160
    v_mfma_f32_16x16x32_bf16 v[92:95], v[188:191], v[172:175], v[92:95]
    ds_read_b64_tr_b16 v[160:161], v238 offset:192
    ds_read_b64_tr_b16 v[162:163], v239 offset:192
    v_mfma_f32_16x16x32_bf16 v[96:99], v[192:195], v[168:171], v[96:99]
    ds_read_b64_tr_b16 v[164:165], v238 offset:224
    ds_read_b64_tr_b16 v[166:167], v239 offset:224
    v_mfma_f32_16x16x32_bf16 v[100:103], v[192:195], v[172:175], v[100:103]
    v_mfma_f32_16x16x32_bf16 v[104:107], v[196:199], v[168:171], v[104:107]
    v_mfma_f32_16x16x32_bf16 v[108:111], v[196:199], v[172:175], v[108:111]
    v_mfma_f32_16x16x32_bf16 v[112:115], v[200:203], v[168:171], v[112:115]
    v_mov_b32 v17, 0
    buffer_load_dword v17, v17, s[44:47], 0 offen sc0 sc1
    s_lshl_b32 s57, s51, 2
    s_add_u32 s57, s57, 64
    v_mov_b32 v56, s57
    s_lshl_b32 s57, s71, 2
    s_add_u32 s57, s57, 128
    v_mov_b32 v57, s57
    buffer_load_dword v58, v56, s[44:47], 0 offen sc0 sc1
    buffer_load_dword v59, v57, s[44:47], 0 offen sc0 sc1
    v_mfma_f32_16x16x32_bf16 v[116:119], v[200:203], v[172:175], v[116:119]
    v_mfma_f32_16x16x32_bf16 v[120:123], v[204:207], v[168:171], v[120:123]
    v_mfma_f32_16x16x32_bf16 v[124:127], v[204:207], v[172:175], v[124:127]
    s_waitcnt lgkmcnt(0)
    v_mfma_f32_16x16x32_bf16 v[64:67], v[136:139], v[128:131], v[64:67]
    ds_read_b128 v[168:171], v237
    ds_read_b128 v[172:175], v237 offset:2048
    v_mfma_f32_16x16x32_bf16 v[68:71], v[136:139], v[132:135], v[68:71]
    ds_read_b64_tr_b16 v[176:177], v238 offset:17408
    ds_read_b64_tr_b16 v[178:179], v239 offset:17408
    v_mfma_f32_16x16x32_bf16 v[72:75], v[140:143], v[128:131], v[72:75]
    ds_read_b64_tr_b16 v[180:181], v238 offset:17440
    ds_read_b64_tr_b16 v[182:183], v239 offset:17440
    v_mfma_f32_16x16x32_bf16 v[76:79], v[140:143], v[132:135], v[76:79]
    ds_read_b64_tr_b16 v[184:185], v238 offset:17472
    ds_read_b64_tr_b16 v[186:187], v239 offset:17472
    v_mfma_f32_16x16x32_bf16 v[80:83], v[144:147], v[128:131], v[80:83]
    ds_read_b64_tr_b16 v[188:189], v238 offset:17504
    ds_read_b64_tr_b16 v[190:191], v239 offset:17504
    v_mfma_f32_16x16x32_bf16 v[84:87], v[144:147], v[132:135], v[84:87]
    ds_read_b64_tr_b16 v[192:193], v238 offset:17536
    ds_read_b64_tr_b16 v[194:195], v239 offset:17536
    v_mfma_f32_16x16x32_bf16 v[88:91], v[148:151], v[128:131], v[88:91]
    ds_read_b64_tr_b16 v[196:197], v238 offset:17568
    ds_read_b64_tr_b16 v[198:199], v239 offset:17568
    v_mfma_f32_16x16x32_bf16 v[92:95], v[148:151], v[132:135], v[92:95]
    ds_read_b64_tr_b16 v[200:201], v238 offset:17600
    ds_read_b64_tr_b16 v[202:203], v239 offset:17600
    v_mfma_f32_16x16x32_bf16 v[96:99], v[152:155], v[128:131], v[96:99]
    ds_read_b64_tr_b16 v[204:205], v238 offset:17632
    ds_read_b64_tr_b16 v[206:207], v239 offset:17632
    v_mfma_f32_16x16x32_bf16 v[100:103], v[152:155], v[132:135], v[100:103]
    v_mfma_f32_16x16x32_bf16 v[104:107], v[156:159], v[128:131], v[104:107]
    v_mfma_f32_16x16x32_bf16 v[108:111], v[156:159], v[132:135], v[108:111]
    v_mfma_f32_16x16x32_bf16 v[112:115], v[160:163], v[128:131], v[112:115]
    v_mfma_f32_16x16x32_bf16 v[116:119], v[160:163], v[132:135], v[116:119]
    v_mfma_f32_16x16x32_bf16 v[120:123], v[164:167], v[128:131], v[120:123]
    v_mfma_f32_16x16x32_bf16 v[124:127], v[164:167], v[132:135], v[124:127]
    s_waitcnt vmcnt(0) lgkmcnt(0)
    s_barrier
    v_mfma_f32_16x16x32_bf16 v[64:67], v[176:179], v[168:171], v[64:67]
    ds_read_b128 v[128:131], v228
    ds_read_b128 v[132:135], v228 offset:2048
    v_mfma_f32_16x16x32_bf16 v[68:71], v[176:179], v[172:175], v[68:71]
    ds_read_b64_tr_b16 v[136:137], v230 offset:0
    ds_read_b64_tr_b16 v[138:139], v231 offset:0
    v_mfma_f32_16x16x32_bf16 v[72:75], v[180:183], v[168:171], v[72:75]
    ds_read_b64_tr_b16 v[140:141], v230 offset:32
    ds_read_b64_tr_b16 v[142:143], v231 offset:32
    v_mfma_f32_16x16x32_bf16 v[76:79], v[180:183], v[172:175], v[76:79]
    ds_read_b64_tr_b16 v[144:145], v230 offset:64
    ds_read_b64_tr_b16 v[146:147], v231 offset:64
    v_mfma_f32_16x16x32_bf16 v[80:83], v[184:187], v[168:171], v[80:83]
    ds_read_b64_tr_b16 v[148:149], v230 offset:96
    ds_read_b64_tr_b16 v[150:151], v231 offset:96
    v_mfma_f32_16x16x32_bf16 v[84:87], v[184:187], v[172:175], v[84:87]
    ds_read_b64_tr_b16 v[152:153], v230 offset:128
    ds_read_b64_tr_b16 v[154:155], v231 offset:128
    v_mfma_f32_16x16x32_bf16 v[88:91], v[188:191], v[168:171], v[88:91]
    ds_read_b64_tr_b16 v[156:157], v230 offset:160
    ds_read_b64_tr_b16 v[158:159], v231 offset:160
    v_mfma_f32_16x16x32_bf16 v[92:95], v[188:191], v[172:175], v[92:95]
    ds_read_b64_tr_b16 v[160:161], v230 offset:192
    ds_read_b64_tr_b16 v[162:163], v231 offset:192
    v_mfma_f32_16x16x32_bf16 v[96:99], v[192:195], v[168:171], v[96:99]
    ds_read_b64_tr_b16 v[164:165], v230 offset:224
    ds_read_b64_tr_b16 v[166:167], v231 offset:224
    v_mfma_f32_16x16x32_bf16 v[100:103], v[192:195], v[172:175], v[100:103]
    v_mfma_f32_16x16x32_bf16 v[104:107], v[196:199], v[168:171], v[104:107]
    v_mfma_f32_16x16x32_bf16 v[108:111], v[196:199], v[172:175], v[108:111]
    v_mfma_f32_16x16x32_bf16 v[112:115], v[200:203], v[168:171], v[112:115]
    s_mov_b32 s60, 0
    s_waitcnt vmcnt(0)
K1_PS2:
    v_readfirstlane_b32 s57, v58
    v_readfirstlane_b32 s61, v59
    s_and_b32 s57, s57, 0xff
    s_min_u32 s57, s57, s61
    s_cmp_ge_u32 s57, 16
    s_cbranch_scc1 K1_PSD2
    s_add_u32 s60, s60, 1
    s_cmp_ge_u32 s60, 100000
    s_cbranch_scc1 K1_PSD2
    s_sleep 8
    buffer_load_dword v58, v56, s[44:47], 0 offen sc0 sc1
    buffer_load_dword v59, v57, s[44:47], 0 offen sc0 sc1
    s_waitcnt vmcnt(0)
    s_branch K1_PS2
K1_PSD2:
    s_lshl_b32 s57, s51, 2
    s_add_u32 s57, s57, s54
    s_lshl_b32 s57, s57, 8
    s_add_u32 s57, s57, 15998976
    v_lshlrev_b32 v24, 3, v2
    buffer_load_dwordx2 v[20:21], v24, s[32:35], s57 offen sc0 sc1
    buffer_load_dwordx2 v[22:23], v24, s[32:35], s57 offen offset:128 sc0 sc1
    s_cmp_lt_u32 s48, 4
    s_cbranch_scc0 K1_NCL2
    s_lshl_b32 s57, s71, 14
    s_add_u32 s57, s57, 16015360
    s_lshl_b32 s61, s48, 2
    s_add_u32 s57, s57, s61
    v_lshlrev_b32 v24, 4, v1
    buffer_load_dword v40, v24, s[32:35], s57 offen offset:0 sc0 sc1
    buffer_load_dword v41, v24, s[32:35], s57 offen offset:1024 sc0 sc1
    buffer_load_dword v42, v24, s[32:35], s57 offen offset:2048 sc0 sc1
    buffer_load_dword v43, v24, s[32:35], s57 offen offset:3072 sc0 sc1
    s_add_u32 s57, s57, 4096
    buffer_load_dword v44, v24, s[32:35], s57 offen offset:0 sc0 sc1
    buffer_load_dword v45, v24, s[32:35], s57 offen offset:1024 sc0 sc1
    buffer_load_dword v46, v24, s[32:35], s57 offen offset:2048 sc0 sc1
    buffer_load_dword v47, v24, s[32:35], s57 offen offset:3072 sc0 sc1
    s_add_u32 s57, s57, 4096
    buffer_load_dword v48, v24, s[32:35], s57 offen offset:0 sc0 sc1
    buffer_load_dword v49, v24, s[32:35], s57 offen offset:1024 sc0 sc1
    buffer_load_dword v50, v24, s[32:35], s57 offen offset:2048 sc0 sc1
    buffer_load_dword v51, v24, s[32:35], s57 offen offset:3072 sc0 sc1
    s_add_u32 s57, s57, 4096
    buffer_load_dword v52, v24, s[32:35], s57 offen offset:0 sc0 sc1
    buffer_load_dword v53, v24, s[32:35], s57 offen offset:1024 sc0 sc1
    buffer_load_dword v54, v24, s[32:35], s57 offen offset:2048 sc0 sc1
    buffer_load_dword v55, v24, s[32:35], s57 offen offset:3072 sc0 sc1
    s_add_u32 s57, s57, 4096
K1_NCL2:
    v_mfma_f32_16x16x32_bf16 v[116:119], v[200:203], v[172:175], v[116:119]
    v_mfma_f32_16x16x32_bf16 v[120:123], v[204:207], v[168:171], v[120:123]
    v_mfma_f32_16x16x32_bf16 v[124:127], v[204:207], v[172:175], v[124:127]
    s_waitcnt lgkmcnt(0)
    v_mfma_f32_16x16x32_bf16 v[64:67], v[136:139], v[128:131], v[64:67]
    ds_read_b128 v[168:171], v229
    ds_read_b128 v[172:175], v229 offset:2048
    v_mfma_f32_16x16x32_bf16 v[68:71], v[136:139], v[132:135], v[68:71]
    ds_read_b64_tr_b16 v[176:177], v230 offset:17408
    ds_read_b64_tr_b16 v[178:179], v231 offset:17408
    v_mfma_f32_16x16x32_bf16 v[72:75], v[140:143], v[128:131], v[72:75]
    ds_read_b64_tr_b16 v[180:181], v230 offset:17440
    ds_read_b64_tr_b16 v[182:183], v231 offset:17440
    v_mfma_f32_16x16x32_bf16 v[76:79], v[140:143], v[132:135], v[76:79]
    ds_read_b64_tr_b16 v[184:185], v230 offset:17472
    ds_read_b64_tr_b16 v[186:187], v231 offset:17472
    v_mfma_f32_16x16x32_bf16 v[80:83], v[144:147], v[128:131], v[80:83]
    ds_read_b64_tr_b16 v[188:189], v230 offset:17504
    ds_read_b64_tr_b16 v[190:191], v231 offset:17504
    v_mfma_f32_16x16x32_bf16 v[84:87], v[144:147], v[132:135], v[84:87]
    ds_read_b64_tr_b16 v[192:193], v230 offset:17536
    ds_read_b64_tr_b16 v[194:195], v231 offset:17536
    v_mfma_f32_16x16x32_bf16 v[88:91], v[148:151], v[128:131], v[88:91]
    ds_read_b64_tr_b16 v[196:197], v230 offset:17568
    ds_read_b64_tr_b16 v[198:199], v231 offset:17568
    v_mfma_f32_16x16x32_bf16 v[92:95], v[148:151], v[132:135], v[92:95]
    ds_read_b64_tr_b16 v[200:201], v230 offset:17600
    ds_read_b64_tr_b16 v[202:203], v231 offset:17600
    v_mfma_f32_16x16x32_bf16 v[96:99], v[152:155], v[128:131], v[96:99]
    ds_read_b64_tr_b16 v[204:205], v230 offset:17632
    ds_read_b64_tr_b16 v[206:207], v231 offset:17632
    v_mfma_f32_16x16x32_bf16 v[100:103], v[152:155], v[132:135], v[100:103]
    v_mfma_f32_16x16x32_bf16 v[104:107], v[156:159], v[128:131], v[104:107]
    v_mfma_f32_16x16x32_bf16 v[108:111], v[156:159], v[132:135], v[108:111]
    v_mfma_f32_16x16x32_bf16 v[112:115], v[160:163], v[128:131], v[112:115]
    v_mfma_f32_16x16x32_bf16 v[116:119], v[160:163], v[132:135], v[116:119]
    v_mfma_f32_16x16x32_bf16 v[120:123], v[164:167], v[128:131], v[120:123]
    v_mfma_f32_16x16x32_bf16 v[124:127], v[164:167], v[132:135], v[124:127]
    s_waitcnt lgkmcnt(0)
    s_barrier
    v_mfma_f32_16x16x32_bf16 v[64:67], v[176:179], v[168:171], v[64:67]
    v_mfma_f32_16x16x32_bf16 v[68:71], v[176:179], v[172:175], v[68:71]
    v_mfma_f32_16x16x32_bf16 v[72:75], v[180:183], v[168:171], v[72:75]
    v_mfma_f32_16x16x32_bf16 v[76:79], v[180:183], v[172:175], v[76:79]
    v_mfma_f32_16x16x32_bf16 v[80:83], v[184:187], v[168:171], v[80:83]
    v_mfma_f32_16x16x32_bf16 v[84:87], v[184:187], v[172:175], v[84:87]
    v_mfma_f32_16x16x32_bf16 v[88:91], v[188:191], v[168:171], v[88:91]
    v_mfma_f32_16x16x32_bf16 v[92:95], v[188:191], v[172:175], v[92:95]
    v_mfma_f32_16x16x32_bf16 v[96:99], v[192:195], v[168:171], v[96:99]
    v_mfma_f32_16x16x32_bf16 v[100:103], v[192:195], v[172:175], v[100:103]
    v_mfma_f32_16x16x32_bf16 v[104:107], v[196:199], v[168:171], v[104:107]
    v_mfma_f32_16x16x32_bf16 v[108:111], v[196:199], v[172:175], v[108:111]
    v_mfma_f32_16x16x32_bf16 v[112:115], v[200:203], v[168:171], v[112:115]
    v_mfma_f32_16x16x32_bf16 v[116:119], v[200:203], v[172:175], v[116:119]
    v_mfma_f32_16x16x32_bf16 v[120:123], v[204:207], v[168:171], v[120:123]
    v_mfma_f32_16x16x32_bf16 v[124:127], v[204:207], v[172:175], v[124:127]
    s_waitcnt vmcnt(0)
    s_cmp_lt_u32 s48, 4
    s_cbranch_scc0 K1_NCS2
    v_pk_add_f32 v[40:41], v[40:41], v[42:43]
    v_pk_add_f32 v[40:41], v[40:41], v[44:45]
    v_pk_add_f32 v[40:41], v[40:41], v[46:47]
    v_pk_add_f32 v[40:41], v[40:41], v[48:49]
    v_pk_add_f32 v[40:41], v[40:41], v[50:51]
    v_pk_add_f32 v[40:41], v[40:41], v[52:53]
    v_pk_add_f32 v[40:41], v[40:41], v[54:55]
    v_add_f32 v40, v40, v41
    s_lshl_b32 s57, s48, 2
    s_add_u32 s57, s57, 153600
    v_lshlrev_b32 v24, 4, v1
    v_add_u32 v24, s57, v24
    ds_write_b32 v24, v40
K1_NCS2:
    s_waitcnt lgkmcnt(0)
    s_barrier
    s_cmp_eq_u32 s48, 0
    s_cbranch_scc0 K1_NZ2
    v_readfirstlane_b32 s57, v17
    s_nop 0
    s_cmp_lg_u32 s57, 0
    s_cbranch_scc1 K1_ZOK2
    v_mov_b32 v24, 0
    s_mov_b32 s68, 0
K1_SZ2:
    buffer_load_dword v25, v24, s[44:47], 0 offen sc0 sc1
    s_waitcnt vmcnt(0)
    v_readfirstlane_b32 s57, v25
    s_nop 0
    s_cmp_lg_u32 s57, 0
    s_cbranch_scc1 K1_SZ2_D
    s_add_u32 s68, s68, 1
    s_cmp_ge_u32 s68, 100000
    s_cbranch_scc1 K1_SZ2_D
    s_sleep 12
    s_branch K1_SZ2
K1_SZ2_D:
K1_ZOK2:
K1_NZ2:
    v_lshlrev_b32 v26, 4, v3
    s_mul_i32 s57, s55, 512
    s_add_u32 s57, s57, 153600
    v_add_u32 v26, s57, v26
    ds_read_b128 v[128:131], v26 offset:0
    ds_read_b128 v[132:135], v26 offset:64
    ds_read_b128 v[136:139], v26 offset:128
    ds_read_b128 v[140:143], v26 offset:192
    ds_read_b128 v[144:147], v26 offset:256
    ds_read_b128 v[148:151], v26 offset:320
    ds_read_b128 v[152:155], v26 offset:384
    ds_read_b128 v[156:159], v26 offset:448
    v_mov_b32 v28, v20
    v_mov_b32 v32, v21
    v_mov_b32 v30, v22
    v_mov_b32 v34, v23
    s_waitcnt lgkmcnt(0)
    v_pk_fma_f32 v[64:65], v[128:129], v[28:29], v[64:65] op_sel_hi:[1,0,1] neg_lo:[0,1,0] neg_hi:[0,1,0]
    v_pk_fma_f32 v[66:67], v[130:131], v[28:29], v[66:67] op_sel_hi:[1,0,1] neg_lo:[0,1,0] neg_hi:[0,1,0]
    v_pk_fma_f32 v[68:69], v[128:129], v[30:31], v[68:69] op_sel_hi:[1,0,1] neg_lo:[0,1,0] neg_hi:[0,1,0]
    v_pk_fma_f32 v[70:71], v[130:131], v[30:31], v[70:71] op_sel_hi:[1,0,1] neg_lo:[0,1,0] neg_hi:[0,1,0]
    v_pk_fma_f32 v[72:73], v[132:133], v[28:29], v[72:73] op_sel_hi:[1,0,1] neg_lo:[0,1,0] neg_hi:[0,1,0]
    v_pk_fma_f32 v[74:75], v[134:135], v[28:29], v[74:75] op_sel_hi:[1,0,1] neg_lo:[0,1,0] neg_hi:[0,1,0]
    v_pk_fma_f32 v[76:77], v[132:133], v[30:31], v[76:77] op_sel_hi:[1,0,1] neg_lo:[0,1,0] neg_hi:[0,1,0]
    v_pk_fma_f32 v[78:79], v[134:135], v[30:31], v[78:79] op_sel_hi:[1,0,1] neg_lo:[0,1,0] neg_hi:[0,1,0]
    v_pk_fma_f32 v[80:81], v[136:137], v[28:29], v[80:81] op_sel_hi:[1,0,1] neg_lo:[0,1,0] neg_hi:[0,1,0]
    v_pk_fma_f32 v[82:83], v[138:139], v[28:29], v[82:83] op_sel_hi:[1,0,1] neg_lo:[0,1,0] neg_hi:[0,1,0]
    v_pk_fma_f32 v[84:85], v[136:137], v[30:31], v[84:85] op_sel_hi:[1,0,1] neg_lo:[0,1,0] neg_hi:[0,1,0]
    v_pk_fma_f32 v[86:87], v[138:139], v[30:31], v[86:87] op_sel_hi:[1,0,1] neg_lo:[0,1,0] neg_hi:[0,1,0]
    v_pk_fma_f32 v[88:89], v[140:141], v[28:29], v[88:89] op_sel_hi:[1,0,1] neg_lo:[0,1,0] neg_hi:[0,1,0]
    v_pk_fma_f32 v[90:91], v[142:143], v[28:29], v[90:91] op_sel_hi:[1,0,1] neg_lo:[0,1,0] neg_hi:[0,1,0]
    v_pk_fma_f32 v[92:93], v[140:141], v[30:31], v[92:93] op_sel_hi:[1,0,1] neg_lo:[0,1,0] neg_hi:[0,1,0]
    v_pk_fma_f32 v[94:95], v[142:143], v[30:31], v[94:95] op_sel_hi:[1,0,1] neg_lo:[0,1,0] neg_hi:[0,1,0]
    v_pk_fma_f32 v[96:97], v[144:145], v[28:29], v[96:97] op_sel_hi:[1,0,1] neg_lo:[0,1,0] neg_hi:[0,1,0]
    v_pk_fma_f32 v[98:99], v[146:147], v[28:29], v[98:99] op_sel_hi:[1,0,1] neg_lo:[0,1,0] neg_hi:[0,1,0]
    v_pk_fma_f32 v[100:101], v[144:145], v[30:31], v[100:101] op_sel_hi:[1,0,1] neg_lo:[0,1,0] neg_hi:[0,1,0]
    v_pk_fma_f32 v[102:103], v[146:147], v[30:31], v[102:103] op_sel_hi:[1,0,1] neg_lo:[0,1,0] neg_hi:[0,1,0]
    v_pk_fma_f32 v[104:105], v[148:149], v[28:29], v[104:105] op_sel_hi:[1,0,1] neg_lo:[0,1,0] neg_hi:[0,1,0]
    v_pk_fma_f32 v[106:107], v[150:151], v[28:29], v[106:107] op_sel_hi:[1,0,1] neg_lo:[0,1,0] neg_hi:[0,1,0]
    v_pk_fma_f32 v[108:109], v[148:149], v[30:31], v[108:109] op_sel_hi:[1,0,1] neg_lo:[0,1,0] neg_hi:[0,1,0]
    v_pk_fma_f32 v[110:111], v[150:151], v[30:31], v[110:111] op_sel_hi:[1,0,1] neg_lo:[0,1,0] neg_hi:[0,1,0]
    v_pk_fma_f32 v[112:113], v[152:153], v[28:29], v[112:113] op_sel_hi:[1,0,1] neg_lo:[0,1,0] neg_hi:[0,1,0]
    v_pk_fma_f32 v[114:115], v[154:155], v[28:29], v[114:115] op_sel_hi:[1,0,1] neg_lo:[0,1,0] neg_hi:[0,1,0]
    v_pk_fma_f32 v[116:117], v[152:153], v[30:31], v[116:117] op_sel_hi:[1,0,1] neg_lo:[0,1,0] neg_hi:[0,1,0]
    v_pk_fma_f32 v[118:119], v[154:155], v[30:31], v[118:119] op_sel_hi:[1,0,1] neg_lo:[0,1,0] neg_hi:[0,1,0]
    v_pk_fma_f32 v[120:121], v[156:157], v[28:29], v[120:121] op_sel_hi:[1,0,1] neg_lo:[0,1,0] neg_hi:[0,1,0]
    v_pk_fma_f32 v[122:123], v[158:159], v[28:29], v[122:123] op_sel_hi:[1,0,1] neg_lo:[0,1,0] neg_hi:[0,1,0]
    v_pk_fma_f32 v[124:125], v[156:157], v[30:31], v[124:125] op_sel_hi:[1,0,1] neg_lo:[0,1,0] neg_hi:[0,1,0]
    v_pk_fma_f32 v[126:127], v[158:159], v[30:31], v[126:127] op_sel_hi:[1,0,1] neg_lo:[0,1,0] neg_hi:[0,1,0]
    v_pk_mul_f32 v[64:65], v[64:65], v[32:33] op_sel_hi:[1,0]
    v_pk_mul_f32 v[66:67], v[66:67], v[32:33] op_sel_hi:[1,0]
    v_pk_mul_f32 v[68:69], v[68:69], v[34:35] op_sel_hi:[1,0]
    v_pk_mul_f32 v[70:71], v[70:71], v[34:35] op_sel_hi:[1,0]
    v_pk_mul_f32 v[72:73], v[72:73], v[32:33] op_sel_hi:[1,0]
    v_pk_mul_f32 v[74:75], v[74:75], v[32:33] op_sel_hi:[1,0]
    v_pk_mul_f32 v[76:77], v[76:77], v[34:35] op_sel_hi:[1,0]
    v_pk_mul_f32 v[78:79], v[78:79], v[34:35] op_sel_hi:[1,0]
    v_pk_mul_f32 v[80:81], v[80:81], v[32:33] op_sel_hi:[1,0]
    v_pk_mul_f32 v[82:83], v[82:83], v[32:33] op_sel_hi:[1,0]
    v_pk_mul_f32 v[84:85], v[84:85], v[34:35] op_sel_hi:[1,0]
    v_pk_mul_f32 v[86:87], v[86:87], v[34:35] op_sel_hi:[1,0]
    v_pk_mul_f32 v[88:89], v[88:89], v[32:33] op_sel_hi:[1,0]
    v_pk_mul_f32 v[90:91], v[90:91], v[32:33] op_sel_hi:[1,0]
    v_pk_mul_f32 v[92:93], v[92:93], v[34:35] op_sel_hi:[1,0]
    v_pk_mul_f32 v[94:95], v[94:95], v[34:35] op_sel_hi:[1,0]
    v_pk_mul_f32 v[96:97], v[96:97], v[32:33] op_sel_hi:[1,0]
    v_pk_mul_f32 v[98:99], v[98:99], v[32:33] op_sel_hi:[1,0]
    v_pk_mul_f32 v[100:101], v[100:101], v[34:35] op_sel_hi:[1,0]
    v_pk_mul_f32 v[102:103], v[102:103], v[34:35] op_sel_hi:[1,0]
    v_pk_mul_f32 v[104:105], v[104:105], v[32:33] op_sel_hi:[1,0]
    v_pk_mul_f32 v[106:107], v[106:107], v[32:33] op_sel_hi:[1,0]
    v_pk_mul_f32 v[108:109], v[108:109], v[34:35] op_sel_hi:[1,0]
    v_pk_mul_f32 v[110:111], v[110:111], v[34:35] op_sel_hi:[1,0]
    v_pk_mul_f32 v[112:113], v[112:113], v[32:33] op_sel_hi:[1,0]
    v_pk_mul_f32 v[114:115], v[114:115], v[32:33] op_sel_hi:[1,0]
    v_pk_mul_f32 v[116:117], v[116:117], v[34:35] op_sel_hi:[1,0]
    v_pk_mul_f32 v[118:119], v[118:119], v[34:35] op_sel_hi:[1,0]
    v_pk_mul_f32 v[120:121], v[120:121], v[32:33] op_sel_hi:[1,0]
    v_pk_mul_f32 v[122:123], v[122:123], v[32:33] op_sel_hi:[1,0]
    v_pk_mul_f32 v[124:125], v[124:125], v[34:35] op_sel_hi:[1,0]
    v_pk_mul_f32 v[126:127], v[126:127], v[34:35] op_sel_hi:[1,0]
    s_mov_b32 s56, 1069066811
    s_mov_b32 s57, 1069066811
    s_lshl_b32 s60, s51, 3
    s_lshl_b32 s61, s54, 1
    s_add_u32 s60, s60, s61
    s_mul_i32 s60, s60, 54
    s_mul_i32 s61, s52, 3
    s_add_u32 s61, s61, 3
    s_lshl_b32 s62, s52, 2
    s_cmp_lt_u32 s52, 3
    s_cselect_b32 s61, s62, s61
    s_lshl_b32 s61, s61, 1
    s_add_u32 s60, s60, s61
    s_mul_i32 s61, s55, 4
    s_add_u32 s60, s60, s61
    s_lshl_b32 s60, s60, 10
    s_add_u32 s61, s60, 55296
    v_lshlrev_b32 v44, 4, v1
    v_pk_mul_f32 v[128:129], v[64:65], s[56:57] op_sel_hi:[1,0]
    v_pk_mul_f32 v[130:131], v[66:67], s[56:57] op_sel_hi:[1,0]
    v_pk_mul_f32 v[132:133], v[72:73], s[56:57] op_sel_hi:[1,0]
    v_pk_mul_f32 v[134:135], v[74:75], s[56:57] op_sel_hi:[1,0]
    v_exp_f32 v128, -v128
    v_exp_f32 v129, -v129
    v_exp_f32 v130, -v130
    v_exp_f32 v131, -v131
    v_exp_f32 v132, -v132
    v_exp_f32 v133, -v133
    v_exp_f32 v134, -v134
    v_exp_f32 v135, -v135
    v_pk_add_f32 v[128:129], v[128:129], 1.0 op_sel_hi:[1,0]
    v_pk_add_f32 v[130:131], v[130:131], 1.0 op_sel_hi:[1,0]
    v_pk_add_f32 v[132:133], v[132:133], 1.0 op_sel_hi:[1,0]
    v_pk_add_f32 v[134:135], v[134:135], 1.0 op_sel_hi:[1,0]
    v_rcp_f32 v128, v128
    v_rcp_f32 v129, v129
    v_rcp_f32 v130, v130
    v_rcp_f32 v131, v131
    v_rcp_f32 v132, v132
    v_rcp_f32 v133, v133
    v_rcp_f32 v134, v134
    v_rcp_f32 v135, v135
    v_pk_mul_f32 v[64:65], v[64:65], v[128:129]
    v_pk_mul_f32 v[66:67], v[66:67], v[130:131]
    v_pk_mul_f32 v[72:73], v[72:73], v[132:133]
    v_pk_mul_f32 v[74:75], v[74:75], v[134:135]
    v_cvt_pk_bf16_f32 v160, v64, v65
    v_cvt_pk_bf16_f32 v161, v66, v67
    v_cvt_pk_bf16_f32 v162, v72, v73
    v_cvt_pk_bf16_f32 v163, v74, v75
    buffer_store_dwordx4 v[160:163], v44, s[32:35], s60 offen offset:0 sc1
    v_pk_mul_f32 v[136:137], v[68:69], s[56:57] op_sel_hi:[1,0]
    v_pk_mul_f32 v[138:139], v[70:71], s[56:57] op_sel_hi:[1,0]
    v_pk_mul_f32 v[140:141], v[76:77], s[56:57] op_sel_hi:[1,0]
    v_pk_mul_f32 v[142:143], v[78:79], s[56:57] op_sel_hi:[1,0]
    v_exp_f32 v136, -v136
    v_exp_f32 v137, -v137
    v_exp_f32 v138, -v138
    v_exp_f32 v139, -v139
    v_exp_f32 v140, -v140
    v_exp_f32 v141, -v141
    v_exp_f32 v142, -v142
    v_exp_f32 v143, -v143
    v_pk_add_f32 v[136:137], v[136:137], 1.0 op_sel_hi:[1,0]
    v_pk_add_f32 v[138:139], v[138:139], 1.0 op_sel_hi:[1,0]
    v_pk_add_f32 v[140:141], v[140:141], 1.0 op_sel_hi:[1,0]
    v_pk_add_f32 v[142:143], v[142:143], 1.0 op_sel_hi:[1,0]
    v_rcp_f32 v136, v136
    v_rcp_f32 v137, v137
    v_rcp_f32 v138, v138
    v_rcp_f32 v139, v139
    v_rcp_f32 v140, v140
    v_rcp_f32 v141, v141
    v_rcp_f32 v142, v142
    v_rcp_f32 v143, v143
    v_pk_mul_f32 v[68:69], v[68:69], v[136:137]
    v_pk_mul_f32 v[70:71], v[70:71], v[138:139]
    v_pk_mul_f32 v[76:77], v[76:77], v[140:141]
    v_pk_mul_f32 v[78:79], v[78:79], v[142:143]
    v_cvt_pk_bf16_f32 v164, v68, v69
    v_cvt_pk_bf16_f32 v165, v70, v71
    v_cvt_pk_bf16_f32 v166, v76, v77
    v_cvt_pk_bf16_f32 v167, v78, v79
    buffer_store_dwordx4 v[164:167], v44, s[32:35], s61 offen offset:0 sc1
    v_pk_mul_f32 v[128:129], v[80:81], s[56:57] op_sel_hi:[1,0]
    v_pk_mul_f32 v[130:131], v[82:83], s[56:57] op_sel_hi:[1,0]
    v_pk_mul_f32 v[132:133], v[88:89], s[56:57] op_sel_hi:[1,0]
    v_pk_mul_f32 v[134:135], v[90:91], s[56:57] op_sel_hi:[1,0]
    v_exp_f32 v128, -v128
    v_exp_f32 v129, -v129
    v_exp_f32 v130, -v130
    v_exp_f32 v131, -v131
    v_exp_f32 v132, -v132
    v_exp_f32 v133, -v133
    v_exp_f32 v134, -v134
    v_exp_f32 v135, -v135
    v_pk_add_f32 v[128:129], v[128:129], 1.0 op_sel_hi:[1,0]
    v_pk_add_f32 v[130:131], v[130:131], 1.0 op_sel_hi:[1,0]
    v_pk_add_f32 v[132:133], v[132:133], 1.0 op_sel_hi:[1,0]
    v_pk_add_f32 v[134:135], v[134:135], 1.0 op_sel_hi:[1,0]
    v_rcp_f32 v128, v128
    v_rcp_f32 v129, v129
    v_rcp_f32 v130, v130
    v_rcp_f32 v131, v131
    v_rcp_f32 v132, v132
    v_rcp_f32 v133, v133
    v_rcp_f32 v134, v134
    v_rcp_f32 v135, v135
    v_pk_mul_f32 v[80:81], v[80:81], v[128:129]
    v_pk_mul_f32 v[82:83], v[82:83], v[130:131]
    v_pk_mul_f32 v[88:89], v[88:89], v[132:133]
    v_pk_mul_f32 v[90:91], v[90:91], v[134:135]
    v_cvt_pk_bf16_f32 v168, v80, v81
    v_cvt_pk_bf16_f32 v169, v82, v83
    v_cvt_pk_bf16_f32 v170, v88, v89
    v_cvt_pk_bf16_f32 v171, v90, v91
    buffer_store_dwordx4 v[168:171], v44, s[32:35], s60 offen offset:1024 sc1
    v_pk_mul_f32 v[136:137], v[84:85], s[56:57] op_sel_hi:[1,0]
    v_pk_mul_f32 v[138:139], v[86:87], s[56:57] op_sel_hi:[1,0]
    v_pk_mul_f32 v[140:141], v[92:93], s[56:57] op_sel_hi:[1,0]
    v_pk_mul_f32 v[142:143], v[94:95], s[56:57] op_sel_hi:[1,0]
    v_exp_f32 v136, -v136
    v_exp_f32 v137, -v137
    v_exp_f32 v138, -v138
    v_exp_f32 v139, -v139
    v_exp_f32 v140, -v140
    v_exp_f32 v141, -v141
    v_exp_f32 v142, -v142
    v_exp_f32 v143, -v143
    v_pk_add_f32 v[136:137], v[136:137], 1.0 op_sel_hi:[1,0]
    v_pk_add_f32 v[138:139], v[138:139], 1.0 op_sel_hi:[1,0]
    v_pk_add_f32 v[140:141], v[140:141], 1.0 op_sel_hi:[1,0]
    v_pk_add_f32 v[142:143], v[142:143], 1.0 op_sel_hi:[1,0]
    v_rcp_f32 v136, v136
    v_rcp_f32 v137, v137
    v_rcp_f32 v138, v138
    v_rcp_f32 v139, v139
    v_rcp_f32 v140, v140
    v_rcp_f32 v141, v141
    v_rcp_f32 v142, v142
    v_rcp_f32 v143, v143
    v_pk_mul_f32 v[84:85], v[84:85], v[136:137]
    v_pk_mul_f32 v[86:87], v[86:87], v[138:139]
    v_pk_mul_f32 v[92:93], v[92:93], v[140:141]
    v_pk_mul_f32 v[94:95], v[94:95], v[142:143]
    v_cvt_pk_bf16_f32 v172, v84, v85
    v_cvt_pk_bf16_f32 v173, v86, v87
    v_cvt_pk_bf16_f32 v174, v92, v93
    v_cvt_pk_bf16_f32 v175, v94, v95
    buffer_store_dwordx4 v[172:175], v44, s[32:35], s61 offen offset:1024 sc1
    v_pk_mul_f32 v[128:129], v[96:97], s[56:57] op_sel_hi:[1,0]
    v_pk_mul_f32 v[130:131], v[98:99], s[56:57] op_sel_hi:[1,0]
    v_pk_mul_f32 v[132:133], v[104:105], s[56:57] op_sel_hi:[1,0]
    v_pk_mul_f32 v[134:135], v[106:107], s[56:57] op_sel_hi:[1,0]
    v_exp_f32 v128, -v128
    v_exp_f32 v129, -v129
    v_exp_f32 v130, -v130
    v_exp_f32 v131, -v131
    v_exp_f32 v132, -v132
    v_exp_f32 v133, -v133
    v_exp_f32 v134, -v134
    v_exp_f32 v135, -v135
    v_pk_add_f32 v[128:129], v[128:129], 1.0 op_sel_hi:[1,0]
    v_pk_add_f32 v[130:131], v[130:131], 1.0 op_sel_hi:[1,0]
    v_pk_add_f32 v[132:133], v[132:133], 1.0 op_sel_hi:[1,0]
    v_pk_add_f32 v[134:135], v[134:135], 1.0 op_sel_hi:[1,0]
    v_rcp_f32 v128, v128
    v_rcp_f32 v129, v129
    v_rcp_f32 v130, v130
    v_rcp_f32 v131, v131
    v_rcp_f32 v132, v132
    v_rcp_f32 v133, v133
    v_rcp_f32 v134, v134
    v_rcp_f32 v135, v135
    v_pk_mul_f32 v[96:97], v[96:97], v[128:129]
    v_pk_mul_f32 v[98:99], v[98:99], v[130:131]
    v_pk_mul_f32 v[104:105], v[104:105], v[132:133]
    v_pk_mul_f32 v[106:107], v[106:107], v[134:135]
    v_cvt_pk_bf16_f32 v176, v96, v97
    v_cvt_pk_bf16_f32 v177, v98, v99
    v_cvt_pk_bf16_f32 v178, v104, v105
    v_cvt_pk_bf16_f32 v179, v106, v107
    buffer_store_dwordx4 v[176:179], v44, s[32:35], s60 offen offset:2048 sc1
    v_pk_mul_f32 v[136:137], v[100:101], s[56:57] op_sel_hi:[1,0]
    v_pk_mul_f32 v[138:139], v[102:103], s[56:57] op_sel_hi:[1,0]
    v_pk_mul_f32 v[140:141], v[108:109], s[56:57] op_sel_hi:[1,0]
    v_pk_mul_f32 v[142:143], v[110:111], s[56:57] op_sel_hi:[1,0]
    v_exp_f32 v136, -v136
    v_exp_f32 v137, -v137
    v_exp_f32 v138, -v138
    v_exp_f32 v139, -v139
    v_exp_f32 v140, -v140
    v_exp_f32 v141, -v141
    v_exp_f32 v142, -v142
    v_exp_f32 v143, -v143
    v_pk_add_f32 v[136:137], v[136:137], 1.0 op_sel_hi:[1,0]
    v_pk_add_f32 v[138:139], v[138:139], 1.0 op_sel_hi:[1,0]
    v_pk_add_f32 v[140:141], v[140:141], 1.0 op_sel_hi:[1,0]
    v_pk_add_f32 v[142:143], v[142:143], 1.0 op_sel_hi:[1,0]
    v_rcp_f32 v136, v136
    v_rcp_f32 v137, v137
    v_rcp_f32 v138, v138
    v_rcp_f32 v139, v139
    v_rcp_f32 v140, v140
    v_rcp_f32 v141, v141
    v_rcp_f32 v142, v142
    v_rcp_f32 v143, v143
    v_pk_mul_f32 v[100:101], v[100:101], v[136:137]
    v_pk_mul_f32 v[102:103], v[102:103], v[138:139]
    v_pk_mul_f32 v[108:109], v[108:109], v[140:141]
    v_pk_mul_f32 v[110:111], v[110:111], v[142:143]
    v_cvt_pk_bf16_f32 v180, v100, v101
    v_cvt_pk_bf16_f32 v181, v102, v103
    v_cvt_pk_bf16_f32 v182, v108, v109
    v_cvt_pk_bf16_f32 v183, v110, v111
    buffer_store_dwordx4 v[180:183], v44, s[32:35], s61 offen offset:2048 sc1
    v_pk_mul_f32 v[128:129], v[112:113], s[56:57] op_sel_hi:[1,0]
    v_pk_mul_f32 v[130:131], v[114:115], s[56:57] op_sel_hi:[1,0]
    v_pk_mul_f32 v[132:133], v[120:121], s[56:57] op_sel_hi:[1,0]
    v_pk_mul_f32 v[134:135], v[122:123], s[56:57] op_sel_hi:[1,0]
    v_exp_f32 v128, -v128
    v_exp_f32 v129, -v129
    v_exp_f32 v130, -v130
    v_exp_f32 v131, -v131
    v_exp_f32 v132, -v132
    v_exp_f32 v133, -v133
    v_exp_f32 v134, -v134
    v_exp_f32 v135, -v135
    v_pk_add_f32 v[128:129], v[128:129], 1.0 op_sel_hi:[1,0]
    v_pk_add_f32 v[130:131], v[130:131], 1.0 op_sel_hi:[1,0]
    v_pk_add_f32 v[132:133], v[132:133], 1.0 op_sel_hi:[1,0]
    v_pk_add_f32 v[134:135], v[134:135], 1.0 op_sel_hi:[1,0]
    v_rcp_f32 v128, v128
    v_rcp_f32 v129, v129
    v_rcp_f32 v130, v130
    v_rcp_f32 v131, v131
    v_rcp_f32 v132, v132
    v_rcp_f32 v133, v133
    v_rcp_f32 v134, v134
    v_rcp_f32 v135, v135
    v_pk_mul_f32 v[112:113], v[112:113], v[128:129]
    v_pk_mul_f32 v[114:115], v[114:115], v[130:131]
    v_pk_mul_f32 v[120:121], v[120:121], v[132:133]
    v_pk_mul_f32 v[122:123], v[122:123], v[134:135]
    v_cvt_pk_bf16_f32 v184, v112, v113
    v_cvt_pk_bf16_f32 v185, v114, v115
    v_cvt_pk_bf16_f32 v186, v120, v121
    v_cvt_pk_bf16_f32 v187, v122, v123
    buffer_store_dwordx4 v[184:187], v44, s[32:35], s60 offen offset:3072 sc1
    v_pk_mul_f32 v[136:137], v[116:117], s[56:57] op_sel_hi:[1,0]
    v_pk_mul_f32 v[138:139], v[118:119], s[56:57] op_sel_hi:[1,0]
    v_pk_mul_f32 v[140:141], v[124:125], s[56:57] op_sel_hi:[1,0]
    v_pk_mul_f32 v[142:143], v[126:127], s[56:57] op_sel_hi:[1,0]
    v_exp_f32 v136, -v136
    v_exp_f32 v137, -v137
    v_exp_f32 v138, -v138
    v_exp_f32 v139, -v139
    v_exp_f32 v140, -v140
    v_exp_f32 v141, -v141
    v_exp_f32 v142, -v142
    v_exp_f32 v143, -v143
    v_pk_add_f32 v[136:137], v[136:137], 1.0 op_sel_hi:[1,0]
    v_pk_add_f32 v[138:139], v[138:139], 1.0 op_sel_hi:[1,0]
    v_pk_add_f32 v[140:141], v[140:141], 1.0 op_sel_hi:[1,0]
    v_pk_add_f32 v[142:143], v[142:143], 1.0 op_sel_hi:[1,0]
    v_rcp_f32 v136, v136
    v_rcp_f32 v137, v137
    v_rcp_f32 v138, v138
    v_rcp_f32 v139, v139
    v_rcp_f32 v140, v140
    v_rcp_f32 v141, v141
    v_rcp_f32 v142, v142
    v_rcp_f32 v143, v143
    v_pk_mul_f32 v[116:117], v[116:117], v[136:137]
    v_pk_mul_f32 v[118:119], v[118:119], v[138:139]
    v_pk_mul_f32 v[124:125], v[124:125], v[140:141]
    v_pk_mul_f32 v[126:127], v[126:127], v[142:143]
    v_cvt_pk_bf16_f32 v188, v116, v117
    v_cvt_pk_bf16_f32 v189, v118, v119
    v_cvt_pk_bf16_f32 v190, v124, v125
    v_cvt_pk_bf16_f32 v191, v126, v127
    buffer_store_dwordx4 v[188:191], v44, s[32:35], s61 offen offset:3072 sc1
    s_branch K1_P2
K1_T3:
    buffer_load_dwordx4 v[128:131], v14, s[24:27], 0 offen
    buffer_load_dwordx4 v[132:135], v14, s[24:27], 0 offen offset:16
    s_mov_b32 s57, 0
    buffer_load_dwordx2 v[136:137], v15, s[28:31], s57 offen
    s_add_u32 s57, s57, s63
    buffer_load_dwordx2 v[138:139], v15, s[28:31], s57 offen
    s_add_u32 s57, s57, s63
    buffer_load_dwordx2 v[140:141], v15, s[28:31], s57 offen
    s_add_u32 s57, s57, s63
    buffer_load_dwordx2 v[142:143], v15, s[28:31], s57 offen
    s_add_u32 s57, s57, s63
    buffer_load_dwordx2 v[144:145], v15, s[28:31], s57 offen
    s_cmp_gt_i32 s75, 0
    s_cselect_b64 exec, -1, 1
    s_cselect_b32 s57, s73, 154624
    s_add_u32 m0, s57, 0
    s_nop 0
    buffer_load_dwordx4 v4, s[28:31], s61 offen lds
    s_mov_b64 exec, -1
    s_cmp_gt_i32 s75, 1
    s_cselect_b64 exec, -1, 1
    s_cselect_b32 s57, s73, 153600
    s_add_u32 m0, s57, 1024
    s_nop 0
    buffer_load_dwordx4 v5, s[28:31], s61 offen lds
    s_mov_b64 exec, -1
    s_cmp_gt_i32 s75, 2
    s_cselect_b64 exec, -1, 1
    s_cselect_b32 s57, s73, 152576
    s_add_u32 m0, s57, 2048
    s_nop 0
    buffer_load_dwordx4 v6, s[28:31], s61 offen lds
    s_mov_b64 exec, -1
    s_cmp_gt_i32 s75, 3
    s_cselect_b64 exec, -1, 1
    s_cselect_b32 s57, s73, 151552
    s_add_u32 m0, s57, 3072
    s_nop 0
    buffer_load_dwordx4 v7, s[28:31], s61 offen lds
    s_mov_b64 exec, -1
    s_add_u32 s61, s61, s56
    s_add_u32 m0, s74, 0
    s_nop 0
    buffer_load_dwordx4 v9, s[24:27], s60 offen lds
    s_add_u32 m0, s74, 1024
    s_nop 0
    buffer_load_dwordx4 v10, s[24:27], s60 offen lds
    s_add_u32 s60, s60, 128
    s_barrier
    s_cmp_gt_i32 s75, 0
    s_cselect_b64 exec, -1, 1
    s_cselect_b32 s57, s73, 103424
    s_add_u32 m0, s57, 51200
    s_nop 0
    buffer_load_dwordx4 v4, s[28:31], s61 offen lds
    s_mov_b64 exec, -1
    s_cmp_gt_i32 s75, 1
    s_cselect_b64 exec, -1, 1
    s_cselect_b32 s57, s73, 102400
    s_add_u32 m0, s57, 52224
    s_nop 0
    buffer_load_dwordx4 v5, s[28:31], s61 offen lds
    s_mov_b64 exec, -1
    s_cmp_gt_i32 s75, 2
    s_cselect_b64 exec, -1, 1
    s_cselect_b32 s57, s73, 101376
    s_add_u32 m0, s57, 53248
    s_nop 0
    buffer_load_dwordx4 v6, s[28:31], s61 offen lds
    s_mov_b64 exec, -1
    s_cmp_gt_i32 s75, 3
    s_cselect_b64 exec, -1, 1
    s_cselect_b32 s57, s73, 100352
    s_add_u32 m0, s57, 54272
    s_nop 0
    buffer_load_dwordx4 v7, s[28:31], s61 offen lds
    s_mov_b64 exec, -1
    s_add_u32 s61, s61, s56
    s_add_u32 m0, s74, 51200
    s_nop 0
    buffer_load_dwordx4 v9, s[24:27], s60 offen lds
    s_add_u32 m0, s74, 52224
    s_nop 0
    buffer_load_dwordx4 v10, s[24:27], s60 offen lds
    s_add_u32 s60, s60, 128
    s_waitcnt vmcnt(12)
    v_lshlrev_b32 v148, 16, v136
    v_and_b32 v149, 0xffff0000, v136
    v_lshlrev_b32 v150, 16, v137
    v_and_b32 v151, 0xffff0000, v137
    v_lshlrev_b32 v152, 16, v138
    v_and_b32 v153, 0xffff0000, v138
    v_lshlrev_b32 v154, 16, v139
    v_and_b32 v155, 0xffff0000, v139
    v_lshlrev_b32 v156, 16, v140
    v_and_b32 v157, 0xffff0000, v140
    v_lshlrev_b32 v158, 16, v141
    v_and_b32 v159, 0xffff0000, v141
    v_lshlrev_b32 v160, 16, v142
    v_and_b32 v161, 0xffff0000, v142
    v_lshlrev_b32 v162, 16, v143
    v_and_b32 v163, 0xffff0000, v143
    v_lshlrev_b32 v164, 16, v144
    v_and_b32 v165, 0xffff0000, v144
    v_lshlrev_b32 v166, 16, v145
    v_and_b32 v167, 0xffff0000, v145
    v_pk_add_f32 v[148:149], v[148:149], v[152:153]
    v_pk_add_f32 v[150:151], v[150:151], v[154:155]
    v_pk_add_f32 v[148:149], v[148:149], v[156:157]
    v_pk_add_f32 v[150:151], v[150:151], v[158:159]
    v_pk_add_f32 v[148:149], v[148:149], v[160:161]
    v_pk_add_f32 v[150:151], v[150:151], v[162:163]
    v_pk_add_f32 v[148:149], v[148:149], v[164:165]
    v_pk_add_f32 v[150:151], v[150:151], v[166:167]
    v_lshlrev_b32 v24, 4, v0
    v_add_u32 v24, 155648, v24
    ds_write_b128 v24, v[148:151]
    v_lshlrev_b32 v168, 16, v128
    v_and_b32 v169, 0xffff0000, v128
    v_lshlrev_b32 v170, 16, v129
    v_and_b32 v171, 0xffff0000, v129
    v_lshlrev_b32 v172, 16, v130
    v_and_b32 v173, 0xffff0000, v130
    v_lshlrev_b32 v174, 16, v131
    v_and_b32 v175, 0xffff0000, v131
    v_lshlrev_b32 v176, 16, v132
    v_and_b32 v177, 0xffff0000, v132
    v_lshlrev_b32 v178, 16, v133
    v_and_b32 v179, 0xffff0000, v133
    v_lshlrev_b32 v180, 16, v134
    v_and_b32 v181, 0xffff0000, v134
    v_lshlrev_b32 v182, 16, v135
    v_and_b32 v183, 0xffff0000, v135
    v_pk_add_f32 v[184:185], v[168:169], v[170:171]
    v_pk_add_f32 v[184:185], v[184:185], v[172:173]
    v_pk_add_f32 v[184:185], v[184:185], v[174:175]
    v_pk_add_f32 v[184:185], v[184:185], v[176:177]
    v_pk_add_f32 v[184:185], v[184:185], v[178:179]
    v_pk_add_f32 v[184:185], v[184:185], v[180:181]
    v_pk_add_f32 v[184:185], v[184:185], v[182:183]
    v_add_f32 v184, v184, v185
    s_nop 1
    v_add_f32_dpp v184, v184, v184 row_shr:1 row_mask:0xf bank_mask:0xf bound_ctrl:0
    s_nop 1
    v_add_f32_dpp v184, v184, v184 row_shr:2 row_mask:0xf bank_mask:0xf bound_ctrl:0
    s_nop 1
    v_add_f32_dpp v184, v184, v184 row_shr:4 row_mask:0xf bank_mask:0xf bound_ctrl:0
    s_nop 1
    v_add_f32_dpp v184, v184, v184 row_shr:8 row_mask:0xf bank_mask:0xf bound_ctrl:0
    s_nop 1
    v_add_f32_dpp v184, v184, v184 row_bcast:15 row_mask:0xa bank_mask:0xf
    s_nop 1
    v_add_f32_dpp v184, v184, v184 row_bcast:31 row_mask:0xc bank_mask:0xf
    s_nop 0
    v_readlane_b32 s57, v184, 63
    v_mov_b32 v186, 0x3acccccd
    s_nop 0
    v_mul_f32 v186, s57, v186
    v_mov_b32 v184, 0
    v_mov_b32 v185, 0
    s_mov_b32 exec_hi, 0xff
    v_pk_add_f32 v[168:169], v[168:169], v[186:187] op_sel_hi:[1,0] neg_lo:[0,1] neg_hi:[0,1]
    v_pk_add_f32 v[170:171], v[170:171], v[186:187] op_sel_hi:[1,0] neg_lo:[0,1] neg_hi:[0,1]
    v_pk_add_f32 v[172:173], v[172:173], v[186:187] op_sel_hi:[1,0] neg_lo:[0,1] neg_hi:[0,1]
    v_pk_add_f32 v[174:175], v[174:175], v[186:187] op_sel_hi:[1,0] neg_lo:[0,1] neg_hi:[0,1]
    v_pk_add_f32 v[176:177], v[176:177], v[186:187] op_sel_hi:[1,0] neg_lo:[0,1] neg_hi:[0,1]
    v_pk_add_f32 v[178:179], v[178:179], v[186:187] op_sel_hi:[1,0] neg_lo:[0,1] neg_hi:[0,1]
    v_pk_add_f32 v[180:181], v[180:181], v[186:187] op_sel_hi:[1,0] neg_lo:[0,1] neg_hi:[0,1]
    v_pk_add_f32 v[182:183], v[182:183], v[186:187] op_sel_hi:[1,0] neg_lo:[0,1] neg_hi:[0,1]
    v_pk_fma_f32 v[184:185], v[168:169], v[168:169], v[184:185]
    v_pk_fma_f32 v[184:185], v[170:171], v[170:171], v[184:185]
    v_pk_fma_f32 v[184:185], v[172:173], v[172:173], v[184:185]
    v_pk_fma_f32 v[184:185], v[174:175], v[174:175], v[184:185]
    v_pk_fma_f32 v[184:185], v[176:177], v[176:177], v[184:185]
    v_pk_fma_f32 v[184:185], v[178:179], v[178:179], v[184:185]
    v_pk_fma_f32 v[184:185], v[180:181], v[180:181], v[184:185]
    v_pk_fma_f32 v[184:185], v[182:183], v[182:183], v[184:185]
    s_mov_b64 exec, -1
    v_add_f32 v184, v184, v185
    s_nop 1
    v_add_f32_dpp v184, v184, v184 row_shr:1 row_mask:0xf bank_mask:0xf bound_ctrl:0
    s_nop 1
    v_add_f32_dpp v184, v184, v184 row_shr:2 row_mask:0xf bank_mask:0xf bound_ctrl:0
    s_nop 1
    v_add_f32_dpp v184, v184, v184 row_shr:4 row_mask:0xf bank_mask:0xf bound_ctrl:0
    s_nop 1
    v_add_f32_dpp v184, v184, v184 row_shr:8 row_mask:0xf bank_mask:0xf bound_ctrl:0
    s_nop 1
    v_add_f32_dpp v184, v184, v184 row_bcast:15 row_mask:0xa bank_mask:0xf
    s_nop 1
    v_add_f32_dpp v184, v184, v184 row_bcast:31 row_mask:0xc bank_mask:0xf
    s_nop 0
    v_readlane_b32 s57, v184, 63
    v_mov_b32 v187, 0x3acccccd
    s_nop 0
    v_mul_f32 v187, s57, v187
    v_cvt_pk_bf16_f32 v186, v186, v186
    v_lshlrev_b32 v186, 16, v186
    v_cvt_pk_bf16_f32 v187, v187, v187
    v_lshlrev_b32 v187, 16, v187
    v_add_f32 v187, 0x3727c5ac, v187
    v_cvt_pk_bf16_f32 v187, v187, v187
    v_lshlrev_b32 v187, 16, v187
    v_sqrt_f32 v187, v187
    s_nop 0
    v_cvt_pk_bf16_f32 v187, v187, v187
    v_lshlrev_b32 v187, 16, v187
    v_rcp_f32 v187, v187
    s_lshl_b32 s57, s49, 3
    s_add_u32 s57, s57, 15998976
    v_mov_b32 v24, 0
    s_mov_b64 exec, 1
    buffer_store_dwordx2 v[186:187], v24, s[32:35], s57 offen sc0 sc1
    s_mov_b64 exec, -1
    s_mul_i32 s69, s51, 5
    s_add_u32 s69, s69, s52
    s_sub_u32 s69, s69, 3
    s_lshl_b32 s57, s48, 2
    v_add_u32 v24, s57, v3
    v_lshrrev_b32 v25, 3, v24
    v_and_b32 v26, 7, v24
    v_lshrrev_b32 v27, 2, v26
    v_lshlrev_b32 v27, 4, v27
    v_lshl_add_u32 v27, v25, 2, v27
    v_and_b32 v28, 3, v26
    v_add_u32 v32, v27, v28
    v_mul_u32_u24 v31, 20, v25
    s_mov_b32 s98, 0
    s_add_u32 s64, s69, 0
    s_mul_i32 s65, s64, 205
    s_lshr_b32 s70, s65, 10
    s_mul_i32 s65, s70, 5
    s_sub_u32 s65, s64, s65
    s_lshl_b32 s72, s65, 8
    s_cmp_ge_u32 s64, 370
    s_cselect_b32 s72, 1073741824, s72
    s_lshl_b32 s76, s70, 5
    v_add_u32 v27, s76, v32
    s_sub_u32 s76, s70, 54
    s_max_i32 s76, s76, 0
    s_mul_i32 s77, s76, 205
    s_lshr_b32 s77, s77, 10
    s_mul_i32 s65, s77, 5
    s_sub_u32 s65, s76, s65
    s_lshl_b32 s65, s65, 3
    v_add_u32 v28, s65, v26
    v_cmp_lt_u32 vcc, 19, v28
    s_nop 1
    v_cndmask_b32 v30, 0, 60, vcc
    v_add3_u32 v29, v28, v30, v31
    s_mul_i32 s77, s77, 160
    v_add_u32 v29, s77, v29
    s_cmp_ge_u32 s70, 54
    s_cselect_b32 s65, 1, 0
    s_cselect_b64 vcc, -1, 0
    s_or_b32 s98, s98, s65
    v_cndmask_b32 v27, v27, v29, vcc
    v_mul_u32_u24 v27, 1280, v27
    v_lshl_add_u32 v27, v2, 4, v27
    v_add_u32 v217, s72, v27
    s_add_u32 s64, s69, 80
    s_mul_i32 s65, s64, 205
    s_lshr_b32 s70, s65, 10
    s_mul_i32 s65, s70, 5
    s_sub_u32 s65, s64, s65
    s_lshl_b32 s72, s65, 8
    s_cmp_ge_u32 s64, 370
    s_cselect_b32 s72, 1073741824, s72
    s_lshl_b32 s76, s70, 5
    v_add_u32 v27, s76, v32
    s_sub_u32 s76, s70, 54
    s_max_i32 s76, s76, 0
    s_mul_i32 s77, s76, 205
    s_lshr_b32 s77, s77, 10
    s_mul_i32 s65, s77, 5
    s_sub_u32 s65, s76, s65
    s_lshl_b32 s65, s65, 3
    v_add_u32 v28, s65, v26
    v_cmp_lt_u32 vcc, 19, v28
    s_nop 1
    v_cndmask_b32 v30, 0, 60, vcc
    v_add3_u32 v29, v28, v30, v31
    s_mul_i32 s77, s77, 160
    v_add_u32 v29, s77, v29
    s_cmp_ge_u32 s70, 54
    s_cselect_b32 s65, 2, 0
    s_cselect_b64 vcc, -1, 0
    s_or_b32 s98, s98, s65
    v_cndmask_b32 v27, v27, v29, vcc
    v_mul_u32_u24 v27, 1280, v27
    v_lshl_add_u32 v27, v2, 4, v27
    v_add_u32 v218, s72, v27
    s_add_u32 s64, s69, 160
    s_mul_i32 s65, s64, 205
    s_lshr_b32 s70, s65, 10
    s_mul_i32 s65, s70, 5
    s_sub_u32 s65, s64, s65
    s_lshl_b32 s72, s65, 8
    s_cmp_ge_u32 s64, 370
    s_cselect_b32 s72, 1073741824, s72
    s_lshl_b32 s76, s70, 5
    v_add_u32 v27, s76, v32
    s_sub_u32 s76, s70, 54
    s_max_i32 s76, s76, 0
    s_mul_i32 s77, s76, 205
    s_lshr_b32 s77, s77, 10
    s_mul_i32 s65, s77, 5
    s_sub_u32 s65, s76, s65
    s_lshl_b32 s65, s65, 3
    v_add_u32 v28, s65, v26
    v_cmp_lt_u32 vcc, 19, v28
    s_nop 1
    v_cndmask_b32 v30, 0, 60, vcc
    v_add3_u32 v29, v28, v30, v31
    s_mul_i32 s77, s77, 160
    v_add_u32 v29, s77, v29
    s_cmp_ge_u32 s70, 54
    s_cselect_b32 s65, 4, 0
    s_cselect_b64 vcc, -1, 0
    s_or_b32 s98, s98, s65
    v_cndmask_b32 v27, v27, v29, vcc
    v_mul_u32_u24 v27, 1280, v27
    v_lshl_add_u32 v27, v2, 4, v27
    v_add_u32 v219, s72, v27
    s_add_u32 s64, s69, 240
    s_mul_i32 s65, s64, 205
    s_lshr_b32 s70, s65, 10
    s_mul_i32 s65, s70, 5
    s_sub_u32 s65, s64, s65
    s_lshl_b32 s72, s65, 8
    s_cmp_ge_u32 s64, 370
    s_cselect_b32 s72, 1073741824, s72
    s_lshl_b32 s76, s70, 5
    v_add_u32 v27, s76, v32
    s_sub_u32 s76, s70, 54
    s_max_i32 s76, s76, 0
    s_mul_i32 s77, s76, 205
    s_lshr_b32 s77, s77, 10
    s_mul_i32 s65, s77, 5
    s_sub_u32 s65, s76, s65
    s_lshl_b32 s65, s65, 3
    v_add_u32 v28, s65, v26
    v_cmp_lt_u32 vcc, 19, v28
    s_nop 1
    v_cndmask_b32 v30, 0, 60, vcc
    v_add3_u32 v29, v28, v30, v31
    s_mul_i32 s77, s77, 160
    v_add_u32 v29, s77, v29
    s_cmp_ge_u32 s70, 54
    s_cselect_b32 s65, 8, 0
    s_cselect_b64 vcc, -1, 0
    s_or_b32 s98, s98, s65
    v_cndmask_b32 v27, v27, v29, vcc
    v_mul_u32_u24 v27, 1280, v27
    v_lshl_add_u32 v27, v2, 4, v27
    v_add_u32 v220, s72, v27
    s_add_u32 s64, s69, 320
    s_mul_i32 s65, s64, 205
    s_lshr_b32 s70, s65, 10
    s_mul_i32 s65, s70, 5
    s_sub_u32 s65, s64, s65
    s_lshl_b32 s72, s65, 8
    s_cmp_ge_u32 s64, 370
    s_cselect_b32 s72, 1073741824, s72
    s_lshl_b32 s76, s70, 5
    v_add_u32 v27, s76, v32
    s_sub_u32 s76, s70, 54
    s_max_i32 s76, s76, 0
    s_mul_i32 s77, s76, 205
    s_lshr_b32 s77, s77, 10
    s_mul_i32 s65, s77, 5
    s_sub_u32 s65, s76, s65
    s_lshl_b32 s65, s65, 3
    v_add_u32 v28, s65, v26
    v_cmp_lt_u32 vcc, 19, v28
    s_nop 1
    v_cndmask_b32 v30, 0, 60, vcc
    v_add3_u32 v29, v28, v30, v31
    s_mul_i32 s77, s77, 160
    v_add_u32 v29, s77, v29
    s_cmp_ge_u32 s70, 54
    s_cselect_b32 s65, 16, 0
    s_cselect_b64 vcc, -1, 0
    s_or_b32 s98, s98, s65
    v_cndmask_b32 v27, v27, v29, vcc
    v_mul_u32_u24 v27, 1280, v27
    v_lshl_add_u32 v27, v2, 4, v27
    v_add_u32 v221, s72, v27
    v_lshrrev_b32 v26, 2, v1
    v_and_b32 v26, 3, v26
    v_and_b32 v27, 3, v1
    v_lshl_add_u32 v28, v3, 3, v26
    v_lshlrev_b32 v28, 8, v28
    v_lshl_add_u32 v28, v27, 3, v28
    s_lshl_b32 s57, s48, 5
    v_add_u32 v211, s57, v28
    v_lshlrev_b32 v216, 4, v1
    s_waitcnt vmcnt(7) lgkmcnt(0)
    s_barrier
    s_cmp_eq_u32 s48, 7
    s_cbranch_scc0 K1_NCP3
    v_lshlrev_b32 v24, 4, v1
    v_add_u32 v25, 155648, v24
    ds_read_b128 v[168:171], v25 offset:0
    ds_read_b128 v[172:175], v25 offset:1024
    ds_read_b128 v[176:179], v25 offset:2048
    ds_read_b128 v[180:183], v25 offset:3072
    ds_read_b128 v[184:187], v25 offset:4096
    ds_read_b128 v[188:191], v25 offset:5120
    ds_read_b128 v[192:195], v25 offset:6144
    ds_read_b128 v[196:199], v25 offset:7168
    s_waitcnt lgkmcnt(0)
    v_pk_add_f32 v[168:169], v[168:169], v[172:173]
    v_pk_add_f32 v[170:171], v[170:171], v[174:175]
    v_pk_add_f32 v[168:169], v[168:169], v[176:177]
    v_pk_add_f32 v[170:171], v[170:171], v[178:179]
    v_pk_add_f32 v[168:169], v[168:169], v[180:181]
    v_pk_add_f32 v[170:171], v[170:171], v[182:183]
    v_pk_add_f32 v[168:169], v[168:169], v[184:185]
    v_pk_add_f32 v[170:171], v[170:171], v[186:187]
    v_pk_add_f32 v[168:169], v[168:169], v[188:189]
    v_pk_add_f32 v[170:171], v[170:171], v[190:191]
    v_pk_add_f32 v[168:169], v[168:169], v[192:193]
    v_pk_add_f32 v[170:171], v[170:171], v[194:195]
    v_pk_add_f32 v[168:169], v[168:169], v[196:197]
    v_pk_add_f32 v[170:171], v[170:171], v[198:199]
    s_lshl_b32 s57, s71, 4
    s_add_u32 s57, s57, s51
    s_lshl_b32 s57, s57, 10
    s_add_u32 s57, s57, 16015360
    buffer_store_dwordx4 v[168:171], v24, s[32:35], s57 offen sc0 sc1
    s_nop 1
K1_NCP3:
    ds_read_b128 v[128:131], v228
    ds_read_b128 v[132:135], v228 offset:2048
    ds_read_b64_tr_b16 v[136:137], v230 offset:0
    ds_read_b64_tr_b16 v[138:139], v231 offset:0
    ds_read_b64_tr_b16 v[140:141], v230 offset:32
    ds_read_b64_tr_b16 v[142:143], v231 offset:32
    ds_read_b64_tr_b16 v[144:145], v230 offset:64
    ds_read_b64_tr_b16 v[146:147], v231 offset:64
    ds_read_b64_tr_b16 v[148:149], v230 offset:96
    ds_read_b64_tr_b16 v[150:151], v231 offset:96
    ds_read_b64_tr_b16 v[152:153], v230 offset:128
    ds_read_b64_tr_b16 v[154:155], v231 offset:128
    ds_read_b64_tr_b16 v[156:157], v230 offset:160
    ds_read_b64_tr_b16 v[158:159], v231 offset:160
    s_waitcnt lgkmcnt(0)
    v_mfma_f32_16x16x32_bf16 v[64:67], v[136:139], v[128:131], 0
    ds_read_b128 v[168:171], v229
    ds_read_b128 v[172:175], v229 offset:2048
    s_cmp_gt_i32 s75, 0
    s_cselect_b64 exec, -1, 1
    s_cselect_b32 s57, s73, 52224
    s_add_u32 m0, s57, 102400
    s_nop 0
    buffer_load_dwordx4 v4, s[28:31], s61 offen lds
    s_mov_b64 exec, -1
    v_mfma_f32_16x16x32_bf16 v[68:71], v[136:139], v[132:135], 0
    ds_read_b64_tr_b16 v[176:177], v230 offset:13312
    ds_read_b64_tr_b16 v[178:179], v231 offset:13312
    s_cmp_gt_i32 s75, 1
    s_cselect_b64 exec, -1, 1
    s_cselect_b32 s57, s73, 51200
    s_add_u32 m0, s57, 103424
    s_nop 0
    buffer_load_dwordx4 v5, s[28:31], s61 offen lds
    s_mov_b64 exec, -1
    v_mfma_f32_16x16x32_bf16 v[72:75], v[140:143], v[128:131], 0
    ds_read_b64_tr_b16 v[180:181], v230 offset:13344
    ds_read_b64_tr_b16 v[182:183], v231 offset:13344
    s_cmp_gt_i32 s75, 2
    s_cselect_b64 exec, -1, 1
    s_cselect_b32 s57, s73, 50176
    s_add_u32 m0, s57, 104448
    s_nop 0
    buffer_load_dwordx4 v6, s[28:31], s61 offen lds
    s_mov_b64 exec, -1
    v_mfma_f32_16x16x32_bf16 v[76:79], v[140:143], v[132:135], 0
    ds_read_b64_tr_b16 v[184:185], v230 offset:13376
    ds_read_b64_tr_b16 v[186:187], v231 offset:13376
    s_cmp_gt_i32 s75, 3
    s_cselect_b64 exec, -1, 1
    s_cselect_b32 s57, s73, 49152
    s_add_u32 m0, s57, 105472
    s_nop 0
    buffer_load_dwordx4 v7, s[28:31], s61 offen lds
    s_mov_b64 exec, -1
    s_add_u32 s61, s61, s56
    v_mfma_f32_16x16x32_bf16 v[80:83], v[144:147], v[128:131], 0
    ds_read_b64_tr_b16 v[188:189], v230 offset:13408
    ds_read_b64_tr_b16 v[190:191], v231 offset:13408
    s_add_u32 m0, s74, 102400
    s_nop 0
    buffer_load_dwordx4 v9, s[24:27], s60 offen lds
    v_mfma_f32_16x16x32_bf16 v[84:87], v[144:147], v[132:135], 0
    ds_read_b64_tr_b16 v[192:193], v230 offset:13440
    ds_read_b64_tr_b16 v[194:195], v231 offset:13440
    s_add_u32 m0, s74, 103424
    s_nop 0
    buffer_load_dwordx4 v10, s[24:27], s60 offen lds
    s_add_u32 s60, s60, 128
    v_mfma_f32_16x16x32_bf16 v[88:91], v[148:151], v[128:131], 0
    ds_read_b64_tr_b16 v[196:197], v230 offset:13472
    ds_read_b64_tr_b16 v[198:199], v231 offset:13472
    v_mfma_f32_16x16x32_bf16 v[92:95], v[148:151], v[132:135], 0
    v_mfma_f32_16x16x32_bf16 v[96:99], v[152:155], v[128:131], 0
    v_mfma_f32_16x16x32_bf16 v[100:103], v[152:155], v[132:135], 0
    v_mfma_f32_16x16x32_bf16 v[104:107], v[156:159], v[128:131], 0
    v_mfma_f32_16x16x32_bf16 v[108:111], v[156:159], v[132:135], 0
    s_waitcnt vmcnt(7) lgkmcnt(0)
    s_barrier
    v_mfma_f32_16x16x32_bf16 v[64:67], v[176:179], v[168:171], v[64:67]
    ds_read_b128 v[128:131], v232
    s_bitcmp1_b32 s98, 0
    s_cselect_b32 s76, s10, s16
    s_cselect_b32 s77, s11, s17
    s_mov_b32 s78, 2211840
    s_cselect_b32 s78, 819200, s78
    s_mov_b32 s79, 0x00020000
    s_lshl_b32 s57, s48, 10
    s_add_u32 m0, s57, 155648
    s_nop 0
    buffer_load_dwordx4 v217, s[76:79], 0 offen lds
    ds_read_b128 v[132:135], v232 offset:2048
    v_mfma_f32_16x16x32_bf16 v[68:71], v[176:179], v[172:175], v[68:71]
    s_bitcmp1_b32 s98, 1
    s_cselect_b32 s76, s10, s16
    s_cselect_b32 s77, s11, s17
    s_mov_b32 s78, 2211840
    s_cselect_b32 s78, 819200, s78
    s_mov_b32 s79, 0x00020000
    s_lshl_b32 s57, s48, 10
    s_add_u32 m0, s57, 26624
    s_nop 0
    buffer_load_dwordx4 v218, s[76:79], 0 offen lds
    ds_read_b64_tr_b16 v[136:137], v234 offset:0
    s_bitcmp1_b32 s98, 2
    s_cselect_b32 s76, s10, s16
    s_cselect_b32 s77, s11, s17
    s_mov_b32 s78, 2211840
    s_cselect_b32 s78, 819200, s78
    s_mov_b32 s79, 0x00020000
    s_lshl_b32 s57, s48, 10
    s_add_u32 m0, s57, 77824
    s_nop 0
    buffer_load_dwordx4 v219, s[76:79], 0 offen lds
    v_mfma_f32_16x16x32_bf16 v[72:75], v[180:183], v[168:171], v[72:75]
    ds_read_b64_tr_b16 v[138:139], v235 offset:0
    s_bitcmp1_b32 s98, 3
    s_cselect_b32 s76, s10, s16
    s_cselect_b32 s77, s11, s17
    s_mov_b32 s78, 2211840
    s_cselect_b32 s78, 819200, s78
    s_mov_b32 s79, 0x00020000
    s_lshl_b32 s57, s48, 10
    s_add_u32 m0, s57, 129024
    s_nop 0
    buffer_load_dwordx4 v220, s[76:79], 0 offen lds
    ds_read_b64_tr_b16 v[140:141], v234 offset:32
    v_mfma_f32_16x16x32_bf16 v[76:79], v[180:183], v[172:175], v[76:79]
    s_cmp_gt_i32 s75, 0
    s_cselect_b64 exec, -1, 1
    s_cselect_b32 s57, s73, 154624
    s_add_u32 m0, s57, 0
    s_nop 0
    buffer_load_dwordx4 v4, s[28:31], s61 offen lds
    s_mov_b64 exec, -1
    ds_read_b64_tr_b16 v[142:143], v235 offset:32
    s_cmp_gt_i32 s75, 1
    s_cselect_b64 exec, -1, 1
    s_cselect_b32 s57, s73, 153600
    s_add_u32 m0, s57, 1024
    s_nop 0
    buffer_load_dwordx4 v5, s[28:31], s61 offen lds
    s_mov_b64 exec, -1
    v_mfma_f32_16x16x32_bf16 v[80:83], v[184:187], v[168:171], v[80:83]
    ds_read_b64_tr_b16 v[144:145], v234 offset:64
    s_cmp_gt_i32 s75, 2
    s_cselect_b64 exec, -1, 1
    s_cselect_b32 s57, s73, 152576
    s_add_u32 m0, s57, 2048
    s_nop 0
    buffer_load_dwordx4 v6, s[28:31], s61 offen lds
    s_mov_b64 exec, -1
    ds_read_b64_tr_b16 v[146:147], v235 offset:64
    v_mfma_f32_16x16x32_bf16 v[84:87], v[184:187], v[172:175], v[84:87]
    s_cmp_gt_i32 s75, 3
    s_cselect_b64 exec, -1, 1
    s_cselect_b32 s57, s73, 151552
    s_add_u32 m0, s57, 3072
    s_nop 0
    buffer_load_dwordx4 v7, s[28:31], s61 offen lds
    s_mov_b64 exec, -1
    s_add_u32 s61, s61, s56
    ds_read_b64_tr_b16 v[148:149], v234 offset:96
    s_add_u32 m0, s74, 0
    s_nop 0
    buffer_load_dwordx4 v9, s[24:27], s60 offen lds
    v_mfma_f32_16x16x32_bf16 v[88:91], v[188:191], v[168:171], v[88:91]
    ds_read_b64_tr_b16 v[150:151], v235 offset:96
    s_add_u32 m0, s74, 1024
    s_nop 0
    buffer_load_dwordx4 v10, s[24:27], s60 offen lds
    s_add_u32 s60, s60, 128
    ds_read_b64_tr_b16 v[152:153], v234 offset:128
    v_mfma_f32_16x16x32_bf16 v[92:95], v[188:191], v[172:175], v[92:95]
    ds_read_b64_tr_b16 v[154:155], v235 offset:128
    ds_read_b64_tr_b16 v[156:157], v234 offset:160
    ds_read_b64_tr_b16 v[158:159], v235 offset:160
    v_mfma_f32_16x16x32_bf16 v[96:99], v[192:195], v[168:171], v[96:99]
    v_mfma_f32_16x16x32_bf16 v[100:103], v[192:195], v[172:175], v[100:103]
    v_mfma_f32_16x16x32_bf16 v[104:107], v[196:199], v[168:171], v[104:107]
    v_mfma_f32_16x16x32_bf16 v[108:111], v[196:199], v[172:175], v[108:111]
    s_waitcnt lgkmcnt(0)
    v_mfma_f32_16x16x32_bf16 v[64:67], v[136:139], v[128:131], v[64:67]
    ds_read_b128 v[168:171], v233
    ds_read_b128 v[172:175], v233 offset:2048
    v_mfma_f32_16x16x32_bf16 v[68:71], v[136:139], v[132:135], v[68:71]
    ds_read_b64_tr_b16 v[176:177], v234 offset:13312
    ds_read_b64_tr_b16 v[178:179], v235 offset:13312
    v_mfma_f32_16x16x32_bf16 v[72:75], v[140:143], v[128:131], v[72:75]
    ds_read_b64_tr_b16 v[180:181], v234 offset:13344
    ds_read_b64_tr_b16 v[182:183], v235 offset:13344
    v_mfma_f32_16x16x32_bf16 v[76:79], v[140:143], v[132:135], v[76:79]
    ds_read_b64_tr_b16 v[184:185], v234 offset:13376
    ds_read_b64_tr_b16 v[186:187], v235 offset:13376
    v_mfma_f32_16x16x32_bf16 v[80:83], v[144:147], v[128:131], v[80:83]
    ds_read_b64_tr_b16 v[188:189], v234 offset:13408
    ds_read_b64_tr_b16 v[190:191], v235 offset:13408
    v_mfma_f32_16x16x32_bf16 v[84:87], v[144:147], v[132:135], v[84:87]
    ds_read_b64_tr_b16 v[192:193], v234 offset:13440
    ds_read_b64_tr_b16 v[194:195], v235 offset:13440
    v_mfma_f32_16x16x32_bf16 v[88:91], v[148:151], v[128:131], v[88:91]
    ds_read_b64_tr_b16 v[196:197], v234 offset:13472
    ds_read_b64_tr_b16 v[198:199], v235 offset:13472
    v_mfma_f32_16x16x32_bf16 v[92:95], v[148:151], v[132:135], v[92:95]
    v_mfma_f32_16x16x32_bf16 v[96:99], v[152:155], v[128:131], v[96:99]
    v_mfma_f32_16x16x32_bf16 v[100:103], v[152:155], v[132:135], v[100:103]
    v_mfma_f32_16x16x32_bf16 v[104:107], v[156:159], v[128:131], v[104:107]
    v_mfma_f32_16x16x32_bf16 v[108:111], v[156:159], v[132:135], v[108:111]
    s_waitcnt vmcnt(10) lgkmcnt(0)
    s_barrier
    v_mfma_f32_16x16x32_bf16 v[64:67], v[176:179], v[168:171], v[64:67]
    ds_read_b128 v[128:131], v236
    ds_read_b128 v[132:135], v236 offset:2048
    s_cmp_gt_i32 s75, 0
    s_cselect_b64 exec, -1, 1
    s_cselect_b32 s57, s73, 103424
    s_add_u32 m0, s57, 51200
    s_nop 0
    buffer_load_dwordx4 v4, s[28:31], s61 offen lds
    s_mov_b64 exec, -1
    v_mfma_f32_16x16x32_bf16 v[68:71], v[176:179], v[172:175], v[68:71]
    ds_read_b64_tr_b16 v[136:137], v238 offset:0
    ds_read_b64_tr_b16 v[138:139], v239 offset:0
    s_cmp_gt_i32 s75, 1
    s_cselect_b64 exec, -1, 1
    s_cselect_b32 s57, s73, 102400
    s_add_u32 m0, s57, 52224
    s_nop 0
    buffer_load_dwordx4 v5, s[28:31], s61 offen lds
    s_mov_b64 exec, -1
    v_mfma_f32_16x16x32_bf16 v[72:75], v[180:183], v[168:171], v[72:75]
    ds_read_b64_tr_b16 v[140:141], v238 offset:32
    ds_read_b64_tr_b16 v[142:143], v239 offset:32
    s_cmp_gt_i32 s75, 2
    s_cselect_b64 exec, -1, 1
    s_cselect_b32 s57, s73, 101376
    s_add_u32 m0, s57, 53248
    s_nop 0
    buffer_load_dwordx4 v6, s[28:31], s61 offen lds
    s_mov_b64 exec, -1
    v_mfma_f32_16x16x32_bf16 v[76:79], v[180:183], v[172:175], v[76:79]
    ds_read_b64_tr_b16 v[144:145], v238 offset:64
    ds_read_b64_tr_b16 v[146:147], v239 offset:64
    s_cmp_gt_i32 s75, 3
    s_cselect_b64 exec, -1, 1
    s_cselect_b32 s57, s73, 100352
    s_add_u32 m0, s57, 54272
    s_nop 0
    buffer_load_dwordx4 v7, s[28:31], s61 offen lds
    s_mov_b64 exec, -1
    s_add_u32 s61, s61, s56
    v_mfma_f32_16x16x32_bf16 v[80:83], v[184:187], v[168:171], v[80:83]
    ds_read_b64_tr_b16 v[148:149], v238 offset:96
    ds_read_b64_tr_b16 v[150:151], v239 offset:96
    s_add_u32 m0, s74, 51200
    s_nop 0
    buffer_load_dwordx4 v9, s[24:27], s60 offen lds
    v_mfma_f32_16x16x32_bf16 v[84:87], v[184:187], v[172:175], v[84:87]
    ds_read_b64_tr_b16 v[152:153], v238 offset:128
    ds_read_b64_tr_b16 v[154:155], v239 offset:128
    s_add_u32 m0, s74, 52224
    s_nop 0
    buffer_load_dwordx4 v10, s[24:27], s60 offen lds
    s_add_u32 s60, s60, 128
    v_mfma_f32_16x16x32_bf16 v[88:91], v[188:191], v[168:171], v[88:91]
    ds_read_b64_tr_b16 v[156:157], v238 offset:160
    ds_read_b64_tr_b16 v[158:159], v239 offset:160
    v_mfma_f32_16x16x32_bf16 v[92:95], v[188:191], v[172:175], v[92:95]
    v_mfma_f32_16x16x32_bf16 v[96:99], v[192:195], v[168:171], v[96:99]
    v_mfma_f32_16x16x32_bf16 v[100:103], v[192:195], v[172:175], v[100:103]
    v_mfma_f32_16x16x32_bf16 v[104:107], v[196:199], v[168:171], v[104:107]
    v_mfma_f32_16x16x32_bf16 v[108:111], v[196:199], v[172:175], v[108:111]
    s_waitcnt lgkmcnt(0)
    v_mfma_f32_16x16x32_bf16 v[64:67], v[136:139], v[128:131], v[64:67]
    ds_read_b128 v[168:171], v237
    ds_read_b128 v[172:175], v237 offset:2048
    v_mfma_f32_16x16x32_bf16 v[68:71], v[136:139], v[132:135], v[68:71]
    ds_read_b64_tr_b16 v[176:177], v238 offset:13312
    ds_read_b64_tr_b16 v[178:179], v239 offset:13312
    v_mfma_f32_16x16x32_bf16 v[72:75], v[140:143], v[128:131], v[72:75]
    ds_read_b64_tr_b16 v[180:181], v238 offset:13344
    ds_read_b64_tr_b16 v[182:183], v239 offset:13344
    v_mfma_f32_16x16x32_bf16 v[76:79], v[140:143], v[132:135], v[76:79]
    ds_read_b64_tr_b16 v[184:185], v238 offset:13376
    ds_read_b64_tr_b16 v[186:187], v239 offset:13376
    v_mfma_f32_16x16x32_bf16 v[80:83], v[144:147], v[128:131], v[80:83]
    ds_read_b64_tr_b16 v[188:189], v238 offset:13408
    ds_read_b64_tr_b16 v[190:191], v239 offset:13408
    v_mfma_f32_16x16x32_bf16 v[84:87], v[144:147], v[132:135], v[84:87]
    ds_read_b64_tr_b16 v[192:193], v238 offset:13440
    ds_read_b64_tr_b16 v[194:195], v239 offset:13440
    v_mfma_f32_16x16x32_bf16 v[88:91], v[148:151], v[128:131], v[88:91]
    ds_read_b64_tr_b16 v[196:197], v238 offset:13472
    ds_read_b64_tr_b16 v[198:199], v239 offset:13472
    v_mfma_f32_16x16x32_bf16 v[92:95], v[148:151], v[132:135], v[92:95]
    v_mfma_f32_16x16x32_bf16 v[96:99], v[152:155], v[128:131], v[96:99]
    v_mfma_f32_16x16x32_bf16 v[100:103], v[152:155], v[132:135], v[100:103]
    v_mfma_f32_16x16x32_bf16 v[104:107], v[156:159], v[128:131], v[104:107]
    v_mfma_f32_16x16x32_bf16 v[108:111], v[156:159], v[132:135], v[108:111]
    s_waitcnt vmcnt(6) lgkmcnt(0)
    s_barrier
    v_mfma_f32_16x16x32_bf16 v[64:67], v[176:179], v[168:171], v[64:67]
    ds_read_b128 v[128:131], v228
    ds_read_b128 v[132:135], v228 offset:2048
    s_cmp_gt_i32 s75, 0
    s_cselect_b64 exec, -1, 1
    s_cselect_b32 s57, s73, 52224
    s_add_u32 m0, s57, 102400
    s_nop 0
    buffer_load_dwordx4 v4, s[28:31], s61 offen lds
    s_mov_b64 exec, -1
    v_mfma_f32_16x16x32_bf16 v[68:71], v[176:179], v[172:175], v[68:71]
    ds_read_b64_tr_b16 v[136:137], v230 offset:0
    ds_read_b64_tr_b16 v[138:139], v231 offset:0
    s_cmp_gt_i32 s75, 1
    s_cselect_b64 exec, -1, 1
    s_cselect_b32 s57, s73, 51200
    s_add_u32 m0, s57, 103424
    s_nop 0
    buffer_load_dwordx4 v5, s[28:31], s61 offen lds
    s_mov_b64 exec, -1
    v_mfma_f32_16x16x32_bf16 v[72:75], v[180:183], v[168:171], v[72:75]
    ds_read_b64_tr_b16 v[140:141], v230 offset:32
    ds_read_b64_tr_b16 v[142:143], v231 offset:32
    s_cmp_gt_i32 s75, 2
    s_cselect_b64 exec, -1, 1
    s_cselect_b32 s57, s73, 50176
    s_add_u32 m0, s57, 104448
    s_nop 0
    buffer_load_dwordx4 v6, s[28:31], s61 offen lds
    s_mov_b64 exec, -1
    v_mfma_f32_16x16x32_bf16 v[76:79], v[180:183], v[172:175], v[76:79]
    ds_read_b64_tr_b16 v[144:145], v230 offset:64
    ds_read_b64_tr_b16 v[146:147], v231 offset:64
    s_cmp_gt_i32 s75, 3
    s_cselect_b64 exec, -1, 1
    s_cselect_b32 s57, s73, 49152
    s_add_u32 m0, s57, 105472
    s_nop 0
    buffer_load_dwordx4 v7, s[28:31], s61 offen lds
    s_mov_b64 exec, -1
    s_add_u32 s61, s61, s56
    v_mfma_f32_16x16x32_bf16 v[80:83], v[184:187], v[168:171], v[80:83]
    ds_read_b64_tr_b16 v[148:149], v230 offset:96
    ds_read_b64_tr_b16 v[150:151], v231 offset:96
    s_add_u32 m0, s74, 102400
    s_nop 0
    buffer_load_dwordx4 v9, s[24:27], s60 offen lds
    v_mfma_f32_16x16x32_bf16 v[84:87], v[184:187], v[172:175], v[84:87]
    ds_read_b64_tr_b16 v[152:153], v230 offset:128
    ds_read_b64_tr_b16 v[154:155], v231 offset:128
    s_add_u32 m0, s74, 103424
    s_nop 0
    buffer_load_dwordx4 v10, s[24:27], s60 offen lds
    s_add_u32 s60, s60, 128
    v_mfma_f32_16x16x32_bf16 v[88:91], v[188:191], v[168:171], v[88:91]
    ds_read_b64_tr_b16 v[156:157], v230 offset:160
    ds_read_b64_tr_b16 v[158:159], v231 offset:160
    v_mfma_f32_16x16x32_bf16 v[92:95], v[188:191], v[172:175], v[92:95]
    v_mfma_f32_16x16x32_bf16 v[96:99], v[192:195], v[168:171], v[96:99]
    v_add_u32 v210, 155648, v211
    ds_read_b64_tr_b16 v[212:213], v210
    ds_read_b64_tr_b16 v[214:215], v210 offset:1024
    s_add_u32 s64, s69, 0
    s_lshl_b32 s65, s64, 3
    s_add_u32 s65, s65, s48
    s_lshl_b32 s65, s65, 10
    s_add_u32 s65, s65, 12845056
    s_cmp_ge_u32 s64, 370
    s_cselect_b32 s65, 1073741824, s65
    s_waitcnt lgkmcnt(0)
    buffer_store_dwordx4 v[212:215], v216, s[32:35], s65 offen sc1
    s_nop 1
    s_cmp_eq_u32 s48, 0
    s_cbranch_scc0 K1_NSG3
    s_lshl_b32 s57, s51, 2
    s_add_u32 s57, s57, 64
    v_mov_b32 v24, s57
    s_lshl_b32 s57, s71, 2
    s_add_u32 s57, s57, 128
    v_mov_b32 v26, s57
    v_mov_b32 v25, 1
    s_mov_b64 exec, 1
    buffer_atomic_add v25, v24, s[44:47], 0 offen
    buffer_atomic_add v25, v26, s[44:47], 0 offen
    s_mov_b64 exec, -1
K1_NSG3:
    v_mfma_f32_16x16x32_bf16 v[100:103], v[192:195], v[172:175], v[100:103]
    v_mfma_f32_16x16x32_bf16 v[104:107], v[196:199], v[168:171], v[104:107]
    v_mfma_f32_16x16x32_bf16 v[108:111], v[196:199], v[172:175], v[108:111]
    s_waitcnt lgkmcnt(0)
    v_mfma_f32_16x16x32_bf16 v[64:67], v[136:139], v[128:131], v[64:67]
    ds_read_b128 v[168:171], v229
    ds_read_b128 v[172:175], v229 offset:2048
    v_mfma_f32_16x16x32_bf16 v[68:71], v[136:139], v[132:135], v[68:71]
    ds_read_b64_tr_b16 v[176:177], v230 offset:13312
    ds_read_b64_tr_b16 v[178:179], v231 offset:13312
    v_mfma_f32_16x16x32_bf16 v[72:75], v[140:143], v[128:131], v[72:75]
    ds_read_b64_tr_b16 v[180:181], v230 offset:13344
    ds_read_b64_tr_b16 v[182:183], v231 offset:13344
    v_mfma_f32_16x16x32_bf16 v[76:79], v[140:143], v[132:135], v[76:79]
    ds_read_b64_tr_b16 v[184:185], v230 offset:13376
    ds_read_b64_tr_b16 v[186:187], v231 offset:13376
    v_mfma_f32_16x16x32_bf16 v[80:83], v[144:147], v[128:131], v[80:83]
    ds_read_b64_tr_b16 v[188:189], v230 offset:13408
    ds_read_b64_tr_b16 v[190:191], v231 offset:13408
    v_mfma_f32_16x16x32_bf16 v[84:87], v[144:147], v[132:135], v[84:87]
    ds_read_b64_tr_b16 v[192:193], v230 offset:13440
    ds_read_b64_tr_b16 v[194:195], v231 offset:13440
    v_mfma_f32_16x16x32_bf16 v[88:91], v[148:151], v[128:131], v[88:91]
    ds_read_b64_tr_b16 v[196:197], v230 offset:13472
    ds_read_b64_tr_b16 v[198:199], v231 offset:13472
    v_mfma_f32_16x16x32_bf16 v[92:95], v[148:151], v[132:135], v[92:95]
    v_mfma_f32_16x16x32_bf16 v[96:99], v[152:155], v[128:131], v[96:99]
    v_add_u32 v210, 26624, v211
    ds_read_b64_tr_b16 v[212:213], v210
    ds_read_b64_tr_b16 v[214:215], v210 offset:1024
    s_add_u32 s64, s69, 80
    s_lshl_b32 s65, s64, 3
    s_add_u32 s65, s65, s48
    s_lshl_b32 s65, s65, 10
    s_add_u32 s65, s65, 12845056
    s_cmp_ge_u32 s64, 370
    s_cselect_b32 s65, 1073741824, s65
    s_waitcnt lgkmcnt(0)
    buffer_store_dwordx4 v[212:215], v216, s[32:35], s65 offen sc1
    s_nop 1
    v_mfma_f32_16x16x32_bf16 v[100:103], v[152:155], v[132:135], v[100:103]
    v_mfma_f32_16x16x32_bf16 v[104:107], v[156:159], v[128:131], v[104:107]
    v_mfma_f32_16x16x32_bf16 v[108:111], v[156:159], v[132:135], v[108:111]
    s_waitcnt vmcnt(6) lgkmcnt(0)
    s_barrier
    v_mfma_f32_16x16x32_bf16 v[64:67], v[176:179], v[168:171], v[64:67]
    ds_read_b128 v[128:131], v232
    s_bitcmp1_b32 s98, 4
    s_cselect_b32 s76, s10, s16
    s_cselect_b32 s77, s11, s17
    s_mov_b32 s78, 2211840
    s_cselect_b32 s78, 819200, s78
    s_mov_b32 s79, 0x00020000
    s_lshl_b32 s57, s48, 10
    s_add_u32 m0, s57, 155648
    s_nop 0
    buffer_load_dwordx4 v221, s[76:79], 0 offen lds
    ds_read_b128 v[132:135], v232 offset:2048
    v_mfma_f32_16x16x32_bf16 v[68:71], v[176:179], v[172:175], v[68:71]
    s_cmp_gt_i32 s75, 0
    s_cselect_b64 exec, -1, 1
    s_cselect_b32 s57, s73, 154624
    s_add_u32 m0, s57, 0
    s_nop 0
    buffer_load_dwordx4 v4, s[28:31], s61 offen lds
    s_mov_b64 exec, -1
    ds_read_b64_tr_b16 v[136:137], v234 offset:0
    s_cmp_gt_i32 s75, 1
    s_cselect_b64 exec, -1, 1
    s_cselect_b32 s57, s73, 153600
    s_add_u32 m0, s57, 1024
    s_nop 0
    buffer_load_dwordx4 v5, s[28:31], s61 offen lds
    s_mov_b64 exec, -1
    v_mfma_f32_16x16x32_bf16 v[72:75], v[180:183], v[168:171], v[72:75]
    ds_read_b64_tr_b16 v[138:139], v235 offset:0
    s_cmp_gt_i32 s75, 2
    s_cselect_b64 exec, -1, 1
    s_cselect_b32 s57, s73, 152576
    s_add_u32 m0, s57, 2048
    s_nop 0
    buffer_load_dwordx4 v6, s[28:31], s61 offen lds
    s_mov_b64 exec, -1
    ds_read_b64_tr_b16 v[140:141], v234 offset:32
    v_mfma_f32_16x16x32_bf16 v[76:79], v[180:183], v[172:175], v[76:79]
    s_cmp_gt_i32 s75, 3
    s_cselect_b64 exec, -1, 1
    s_cselect_b32 s57, s73, 151552
    s_add_u32 m0, s57, 3072
    s_nop 0
    buffer_load_dwordx4 v7, s[28:31], s61 offen lds
    s_mov_b64 exec, -1
    s_add_u32 s61, s61, s56
    ds_read_b64_tr_b16 v[142:143], v235 offset:32
    s_add_u32 m0, s74, 0
    s_nop 0
    buffer_load_dwordx4 v9, s[24:27], s60 offen lds
    v_mfma_f32_16x16x32_bf16 v[80:83], v[184:187], v[168:171], v[80:83]
    ds_read_b64_tr_b16 v[144:145], v234 offset:64
    s_add_u32 m0, s74, 1024
    s_nop 0
    buffer_load_dwordx4 v10, s[24:27], s60 offen lds
    s_add_u32 s60, s60, 128
    ds_read_b64_tr_b16 v[146:147], v235 offset:64
    v_mfma_f32_16x16x32_bf16 v[84:87], v[184:187], v[172:175], v[84:87]
    ds_read_b64_tr_b16 v[148:149], v234 offset:96
    ds_read_b64_tr_b16 v[150:151], v235 offset:96
    ds_read_b64_tr_b16 v[152:153], v234 offset:128
    v_mfma_f32_16x16x32_bf16 v[88:91], v[188:191], v[168:171], v[88:91]
    ds_read_b64_tr_b16 v[154:155], v235 offset:128
    ds_read_b64_tr_b16 v[156:157], v234 offset:160
    ds_read_b64_tr_b16 v[158:159], v235 offset:160
    v_mfma_f32_16x16x32_bf16 v[92:95], v[188:191], v[172:175], v[92:95]
    v_mfma_f32_16x16x32_bf16 v[96:99], v[192:195], v[168:171], v[96:99]
    v_mfma_f32_16x16x32_bf16 v[100:103], v[192:195], v[172:175], v[100:103]
    v_mfma_f32_16x16x32_bf16 v[104:107], v[196:199], v[168:171], v[104:107]
    v_mfma_f32_16x16x32_bf16 v[108:111], v[196:199], v[172:175], v[108:111]
    s_waitcnt lgkmcnt(0)
    v_mfma_f32_16x16x32_bf16 v[64:67], v[136:139], v[128:131], v[64:67]
    ds_read_b128 v[168:171], v233
    ds_read_b128 v[172:175], v233 offset:2048
    v_mfma_f32_16x16x32_bf16 v[68:71], v[136:139], v[132:135], v[68:71]
    ds_read_b64_tr_b16 v[176:177], v234 offset:13312
    ds_read_b64_tr_b16 v[178:179], v235 offset:13312
    v_mfma_f32_16x16x32_bf16 v[72:75], v[140:143], v[128:131], v[72:75]
    ds_read_b64_tr_b16 v[180:181], v234 offset:13344
    ds_read_b64_tr_b16 v[182:183], v235 offset:13344
    v_mfma_f32_16x16x32_bf16 v[76:79], v[140:143], v[132:135], v[76:79]
    ds_read_b64_tr_b16 v[184:185], v234 offset:13376
    ds_read_b64_tr_b16 v[186:187], v235 offset:13376
    v_mfma_f32_16x16x32_bf16 v[80:83], v[144:147], v[128:131], v[80:83]
    ds_read_b64_tr_b16 v[188:189], v234 offset:13408
    ds_read_b64_tr_b16 v[190:191], v235 offset:13408
    v_mfma_f32_16x16x32_bf16 v[84:87], v[144:147], v[132:135], v[84:87]
    ds_read_b64_tr_b16 v[192:193], v234 offset:13440
    ds_read_b64_tr_b16 v[194:195], v235 offset:13440
    v_mfma_f32_16x16x32_bf16 v[88:91], v[148:151], v[128:131], v[88:91]
    ds_read_b64_tr_b16 v[196:197], v234 offset:13472
    ds_read_b64_tr_b16 v[198:199], v235 offset:13472
    v_mfma_f32_16x16x32_bf16 v[92:95], v[148:151], v[132:135], v[92:95]
    v_mfma_f32_16x16x32_bf16 v[96:99], v[152:155], v[128:131], v[96:99]
    v_add_u32 v210, 77824, v211
    ds_read_b64_tr_b16 v[212:213], v210
    ds_read_b64_tr_b16 v[214:215], v210 offset:1024
    s_add_u32 s64, s69, 160
    s_lshl_b32 s65, s64, 3
    s_add_u32 s65, s65, s48
    s_lshl_b32 s65, s65, 10
    s_add_u32 s65, s65, 12845056
    s_cmp_ge_u32 s64, 370
    s_cselect_b32 s65, 1073741824, s65
    s_waitcnt lgkmcnt(0)
    buffer_store_dwordx4 v[212:215], v216, s[32:35], s65 offen sc1
    s_nop 1
    v_mfma_f32_16x16x32_bf16 v[100:103], v[152:155], v[132:135], v[100:103]
    v_mfma_f32_16x16x32_bf16 v[104:107], v[156:159], v[128:131], v[104:107]
    v_mfma_f32_16x16x32_bf16 v[108:111], v[156:159], v[132:135], v[108:111]
    s_waitcnt vmcnt(7) lgkmcnt(0)
    s_barrier
    v_mfma_f32_16x16x32_bf16 v[64:67], v[176:179], v[168:171], v[64:67]
    ds_read_b128 v[128:131], v236
    ds_read_b128 v[132:135], v236 offset:2048
    s_cmp_gt_i32 s75, 0
    s_cselect_b64 exec, -1, 1
    s_cselect_b32 s57, s73, 103424
    s_add_u32 m0, s57, 51200
    s_nop 0
    buffer_load_dwordx4 v4, s[28:31], s61 offen lds
    s_mov_b64 exec, -1
    v_mfma_f32_16x16x32_bf16 v[68:71], v[176:179], v[172:175], v[68:71]
    ds_read_b64_tr_b16 v[136:137], v238 offset:0
    ds_read_b64_tr_b16 v[138:139], v239 offset:0
    s_cmp_gt_i32 s75, 1
    s_cselect_b64 exec, -1, 1
    s_cselect_b32 s57, s73, 102400
    s_add_u32 m0, s57, 52224
    s_nop 0
    buffer_load_dwordx4 v5, s[28:31], s61 offen lds
    s_mov_b64 exec, -1
    v_mfma_f32_16x16x32_bf16 v[72:75], v[180:183], v[168:171], v[72:75]
    ds_read_b64_tr_b16 v[140:141], v238 offset:32
    ds_read_b64_tr_b16 v[142:143], v239 offset:32
    s_cmp_gt_i32 s75, 2
    s_cselect_b64 exec, -1, 1
    s_cselect_b32 s57, s73, 101376
    s_add_u32 m0, s57, 53248
    s_nop 0
    buffer_load_dwordx4 v6, s[28:31], s61 offen lds
    s_mov_b64 exec, -1
    v_mfma_f32_16x16x32_bf16 v[76:79], v[180:183], v[172:175], v[76:79]
    ds_read_b64_tr_b16 v[144:145], v238 offset:64
    ds_read_b64_tr_b16 v[146:147], v239 offset:64
    s_cmp_gt_i32 s75, 3
    s_cselect_b64 exec, -1, 1
    s_cselect_b32 s57, s73, 100352
    s_add_u32 m0, s57, 54272
    s_nop 0
    buffer_load_dwordx4 v7, s[28:31], s61 offen lds
    s_mov_b64 exec, -1
    s_add_u32 s61, s61, s56
    v_mfma_f32_16x16x32_bf16 v[80:83], v[184:187], v[168:171], v[80:83]
    ds_read_b64_tr_b16 v[148:149], v238 offset:96
    ds_read_b64_tr_b16 v[150:151], v239 offset:96
    s_add_u32 m0, s74, 51200
    s_nop 0
    buffer_load_dwordx4 v9, s[24:27], s60 offen lds
    v_mfma_f32_16x16x32_bf16 v[84:87], v[184:187], v[172:175], v[84:87]
    ds_read_b64_tr_b16 v[152:153], v238 offset:128
    ds_read_b64_tr_b16 v[154:155], v239 offset:128
    s_add_u32 m0, s74, 52224
    s_nop 0
    buffer_load_dwordx4 v10, s[24:27], s60 offen lds
    s_add_u32 s60, s60, 128
    v_mfma_f32_16x16x32_bf16 v[88:91], v[188:191], v[168:171], v[88:91]
    ds_read_b64_tr_b16 v[156:157], v238 offset:160
    ds_read_b64_tr_b16 v[158:159], v239 offset:160
    v_mfma_f32_16x16x32_bf16 v[92:95], v[188:191], v[172:175], v[92:95]
    v_mfma_f32_16x16x32_bf16 v[96:99], v[192:195], v[168:171], v[96:99]
    v_add_u32 v210, 129024, v211
    ds_read_b64_tr_b16 v[212:213], v210
    ds_read_b64_tr_b16 v[214:215], v210 offset:1024
    s_add_u32 s64, s69, 240
    s_lshl_b32 s65, s64, 3
    s_add_u32 s65, s65, s48
    s_lshl_b32 s65, s65, 10
    s_add_u32 s65, s65, 12845056
    s_cmp_ge_u32 s64, 370
    s_cselect_b32 s65, 1073741824, s65
    s_waitcnt lgkmcnt(0)
    buffer_store_dwordx4 v[212:215], v216, s[32:35], s65 offen sc1
    s_nop 1
    v_mfma_f32_16x16x32_bf16 v[100:103], v[192:195], v[172:175], v[100:103]
    v_mfma_f32_16x16x32_bf16 v[104:107], v[196:199], v[168:171], v[104:107]
    v_mfma_f32_16x16x32_bf16 v[108:111], v[196:199], v[172:175], v[108:111]
    s_waitcnt lgkmcnt(0)
    v_mfma_f32_16x16x32_bf16 v[64:67], v[136:139], v[128:131], v[64:67]
    ds_read_b128 v[168:171], v237
    ds_read_b128 v[172:175], v237 offset:2048
    v_mfma_f32_16x16x32_bf16 v[68:71], v[136:139], v[132:135], v[68:71]
    ds_read_b64_tr_b16 v[176:177], v238 offset:13312
    ds_read_b64_tr_b16 v[178:179], v239 offset:13312
    v_mfma_f32_16x16x32_bf16 v[72:75], v[140:143], v[128:131], v[72:75]
    ds_read_b64_tr_b16 v[180:181], v238 offset:13344
    ds_read_b64_tr_b16 v[182:183], v239 offset:13344
    v_mfma_f32_16x16x32_bf16 v[76:79], v[140:143], v[132:135], v[76:79]
    ds_read_b64_tr_b16 v[184:185], v238 offset:13376
    ds_read_b64_tr_b16 v[186:187], v239 offset:13376
    v_mfma_f32_16x16x32_bf16 v[80:83], v[144:147], v[128:131], v[80:83]
    ds_read_b64_tr_b16 v[188:189], v238 offset:13408
    ds_read_b64_tr_b16 v[190:191], v239 offset:13408
    v_mfma_f32_16x16x32_bf16 v[84:87], v[144:147], v[132:135], v[84:87]
    ds_read_b64_tr_b16 v[192:193], v238 offset:13440
    ds_read_b64_tr_b16 v[194:195], v239 offset:13440
    v_mfma_f32_16x16x32_bf16 v[88:91], v[148:151], v[128:131], v[88:91]
    ds_read_b64_tr_b16 v[196:197], v238 offset:13472
    ds_read_b64_tr_b16 v[198:199], v239 offset:13472
    v_mfma_f32_16x16x32_bf16 v[92:95], v[148:151], v[132:135], v[92:95]
    v_mfma_f32_16x16x32_bf16 v[96:99], v[152:155], v[128:131], v[96:99]
    v_mfma_f32_16x16x32_bf16 v[100:103], v[152:155], v[132:135], v[100:103]
    v_mfma_f32_16x16x32_bf16 v[104:107], v[156:159], v[128:131], v[104:107]
    v_mfma_f32_16x16x32_bf16 v[108:111], v[156:159], v[132:135], v[108:111]
    s_waitcnt vmcnt(6) lgkmcnt(0)
    s_barrier
    v_mfma_f32_16x16x32_bf16 v[64:67], v[176:179], v[168:171], v[64:67]
    ds_read_b128 v[128:131], v228
    ds_read_b128 v[132:135], v228 offset:2048
    s_cmp_gt_i32 s75, 0
    s_cselect_b64 exec, -1, 1
    s_cselect_b32 s57, s73, 52224
    s_add_u32 m0, s57, 102400
    s_nop 0
    buffer_load_dwordx4 v4, s[28:31], s61 offen lds
    s_mov_b64 exec, -1
    v_mfma_f32_16x16x32_bf16 v[68:71], v[176:179], v[172:175], v[68:71]
    ds_read_b64_tr_b16 v[136:137], v230 offset:0
    ds_read_b64_tr_b16 v[138:139], v231 offset:0
    s_cmp_gt_i32 s75, 1
    s_cselect_b64 exec, -1, 1
    s_cselect_b32 s57, s73, 51200
    s_add_u32 m0, s57, 103424
    s_nop 0
    buffer_load_dwordx4 v5, s[28:31], s61 offen lds
    s_mov_b64 exec, -1
    v_mfma_f32_16x16x32_bf16 v[72:75], v[180:183], v[168:171], v[72:75]
    ds_read_b64_tr_b16 v[140:141], v230 offset:32
    ds_read_b64_tr_b16 v[142:143], v231 offset:32
    s_cmp_gt_i32 s75, 2
    s_cselect_b64 exec, -1, 1
    s_cselect_b32 s57, s73, 50176
    s_add_u32 m0, s57, 104448
    s_nop 0
    buffer_load_dwordx4 v6, s[28:31], s61 offen lds
    s_mov_b64 exec, -1
    v_mfma_f32_16x16x32_bf16 v[76:79], v[180:183], v[172:175], v[76:79]
    ds_read_b64_tr_b16 v[144:145], v230 offset:64
    ds_read_b64_tr_b16 v[146:147], v231 offset:64
    s_cmp_gt_i32 s75, 3
    s_cselect_b64 exec, -1, 1
    s_cselect_b32 s57, s73, 49152
    s_add_u32 m0, s57, 105472
    s_nop 0
    buffer_load_dwordx4 v7, s[28:31], s61 offen lds
    s_mov_b64 exec, -1
    s_add_u32 s61, s61, s56
    v_mfma_f32_16x16x32_bf16 v[80:83], v[184:187], v[168:171], v[80:83]
    ds_read_b64_tr_b16 v[148:149], v230 offset:96
    ds_read_b64_tr_b16 v[150:151], v231 offset:96
    s_add_u32 m0, s74, 102400
    s_nop 0
    buffer_load_dwordx4 v9, s[24:27], s60 offen lds
    v_mfma_f32_16x16x32_bf16 v[84:87], v[184:187], v[172:175], v[84:87]
    ds_read_b64_tr_b16 v[152:153], v230 offset:128
    ds_read_b64_tr_b16 v[154:155], v231 offset:128
    s_add_u32 m0, s74, 103424
    s_nop 0
    buffer_load_dwordx4 v10, s[24:27], s60 offen lds
    s_add_u32 s60, s60, 128
    v_mfma_f32_16x16x32_bf16 v[88:91], v[188:191], v[168:171], v[88:91]
    ds_read_b64_tr_b16 v[156:157], v230 offset:160
    ds_read_b64_tr_b16 v[158:159], v231 offset:160
    v_mfma_f32_16x16x32_bf16 v[92:95], v[188:191], v[172:175], v[92:95]
    v_mfma_f32_16x16x32_bf16 v[96:99], v[192:195], v[168:171], v[96:99]
    v_add_u32 v210, 155648, v211
    ds_read_b64_tr_b16 v[212:213], v210
    ds_read_b64_tr_b16 v[214:215], v210 offset:1024
    s_add_u32 s64, s69, 320
    s_lshl_b32 s65, s64, 3
    s_add_u32 s65, s65, s48
    s_lshl_b32 s65, s65, 10
    s_add_u32 s65, s65, 12845056
    s_cmp_ge_u32 s64, 370
    s_cselect_b32 s65, 1073741824, s65
    s_waitcnt lgkmcnt(0)
    buffer_store_dwordx4 v[212:215], v216, s[32:35], s65 offen sc1
    s_nop 1
    v_mfma_f32_16x16x32_bf16 v[100:103], v[192:195], v[172:175], v[100:103]
    v_mfma_f32_16x16x32_bf16 v[104:107], v[196:199], v[168:171], v[104:107]
    v_mfma_f32_16x16x32_bf16 v[108:111], v[196:199], v[172:175], v[108:111]
    s_waitcnt lgkmcnt(0)
    v_mfma_f32_16x16x32_bf16 v[64:67], v[136:139], v[128:131], v[64:67]
    ds_read_b128 v[168:171], v229
    ds_read_b128 v[172:175], v229 offset:2048
    v_mfma_f32_16x16x32_bf16 v[68:71], v[136:139], v[132:135], v[68:71]
    ds_read_b64_tr_b16 v[176:177], v230 offset:13312
    ds_read_b64_tr_b16 v[178:179], v231 offset:13312
    v_mfma_f32_16x16x32_bf16 v[72:75], v[140:143], v[128:131], v[72:75]
    ds_read_b64_tr_b16 v[180:181], v230 offset:13344
    ds_read_b64_tr_b16 v[182:183], v231 offset:13344
    v_mfma_f32_16x16x32_bf16 v[76:79], v[140:143], v[132:135], v[76:79]
    ds_read_b64_tr_b16 v[184:185], v230 offset:13376
    ds_read_b64_tr_b16 v[186:187], v231 offset:13376
    v_mfma_f32_16x16x32_bf16 v[80:83], v[144:147], v[128:131], v[80:83]
    ds_read_b64_tr_b16 v[188:189], v230 offset:13408
    ds_read_b64_tr_b16 v[190:191], v231 offset:13408
    v_mfma_f32_16x16x32_bf16 v[84:87], v[144:147], v[132:135], v[84:87]
    ds_read_b64_tr_b16 v[192:193], v230 offset:13440
    ds_read_b64_tr_b16 v[194:195], v231 offset:13440
    v_mfma_f32_16x16x32_bf16 v[88:91], v[148:151], v[128:131], v[88:91]
    ds_read_b64_tr_b16 v[196:197], v230 offset:13472
    ds_read_b64_tr_b16 v[198:199], v231 offset:13472
    v_mfma_f32_16x16x32_bf16 v[92:95], v[148:151], v[132:135], v[92:95]
    v_mfma_f32_16x16x32_bf16 v[96:99], v[152:155], v[128:131], v[96:99]
    v_mfma_f32_16x16x32_bf16 v[100:103], v[152:155], v[132:135], v[100:103]
    v_mfma_f32_16x16x32_bf16 v[104:107], v[156:159], v[128:131], v[104:107]
    v_mfma_f32_16x16x32_bf16 v[108:111], v[156:159], v[132:135], v[108:111]
    s_waitcnt vmcnt(6) lgkmcnt(0)
    s_barrier
    v_mfma_f32_16x16x32_bf16 v[64:67], v[176:179], v[168:171], v[64:67]
    ds_read_b128 v[128:131], v232
    ds_read_b128 v[132:135], v232 offset:2048
    s_cmp_gt_i32 s75, 0
    s_cselect_b64 exec, -1, 1
    s_cselect_b32 s57, s73, 154624
    s_add_u32 m0, s57, 0
    s_nop 0
    buffer_load_dwordx4 v4, s[28:31], s61 offen lds
    s_mov_b64 exec, -1
    v_mfma_f32_16x16x32_bf16 v[68:71], v[176:179], v[172:175], v[68:71]
    ds_read_b64_tr_b16 v[136:137], v234 offset:0
    ds_read_b64_tr_b16 v[138:139], v235 offset:0
    s_cmp_gt_i32 s75, 1
    s_cselect_b64 exec, -1, 1
    s_cselect_b32 s57, s73, 153600
    s_add_u32 m0, s57, 1024
    s_nop 0
    buffer_load_dwordx4 v5, s[28:31], s61 offen lds
    s_mov_b64 exec, -1
    v_mfma_f32_16x16x32_bf16 v[72:75], v[180:183], v[168:171], v[72:75]
    ds_read_b64_tr_b16 v[140:141], v234 offset:32
    ds_read_b64_tr_b16 v[142:143], v235 offset:32
    s_cmp_gt_i32 s75, 2
    s_cselect_b64 exec, -1, 1
    s_cselect_b32 s57, s73, 152576
    s_add_u32 m0, s57, 2048
    s_nop 0
    buffer_load_dwordx4 v6, s[28:31], s61 offen lds
    s_mov_b64 exec, -1
    v_mfma_f32_16x16x32_bf16 v[76:79], v[180:183], v[172:175], v[76:79]
    ds_read_b64_tr_b16 v[144:145], v234 offset:64
    ds_read_b64_tr_b16 v[146:147], v235 offset:64
    s_cmp_gt_i32 s75, 3
    s_cselect_b64 exec, -1, 1
    s_cselect_b32 s57, s73, 151552
    s_add_u32 m0, s57, 3072
    s_nop 0
    buffer_load_dwordx4 v7, s[28:31], s61 offen lds
    s_mov_b64 exec, -1
    s_add_u32 s61, s61, s56
    v_mfma_f32_16x16x32_bf16 v[80:83], v[184:187], v[168:171], v[80:83]
    ds_read_b64_tr_b16 v[148:149], v234 offset:96
    ds_read_b64_tr_b16 v[150:151], v235 offset:96
    s_add_u32 m0, s74, 0
    s_nop 0
    buffer_load_dwordx4 v9, s[24:27], s60 offen lds
    v_mfma_f32_16x16x32_bf16 v[84:87], v[184:187], v[172:175], v[84:87]
    ds_read_b64_tr_b16 v[152:153], v234 offset:128
    ds_read_b64_tr_b16 v[154:155], v235 offset:128
    s_add_u32 m0, s74, 1024
    s_nop 0
    buffer_load_dwordx4 v10, s[24:27], s60 offen lds
    s_add_u32 s60, s60, 128
    v_mfma_f32_16x16x32_bf16 v[88:91], v[188:191], v[168:171], v[88:91]
    ds_read_b64_tr_b16 v[156:157], v234 offset:160
    ds_read_b64_tr_b16 v[158:159], v235 offset:160
    v_mfma_f32_16x16x32_bf16 v[92:95], v[188:191], v[172:175], v[92:95]
    v_mfma_f32_16x16x32_bf16 v[96:99], v[192:195], v[168:171], v[96:99]
    v_mfma_f32_16x16x32_bf16 v[100:103], v[192:195], v[172:175], v[100:103]
    v_mfma_f32_16x16x32_bf16 v[104:107], v[196:199], v[168:171], v[104:107]
    v_mfma_f32_16x16x32_bf16 v[108:111], v[196:199], v[172:175], v[108:111]
    s_waitcnt lgkmcnt(0)
    v_mfma_f32_16x16x32_bf16 v[64:67], v[136:139], v[128:131], v[64:67]
    ds_read_b128 v[168:171], v233
    ds_read_b128 v[172:175], v233 offset:2048
    v_mfma_f32_16x16x32_bf16 v[68:71], v[136:139], v[132:135], v[68:71]
    ds_read_b64_tr_b16 v[176:177], v234 offset:13312
    ds_read_b64_tr_b16 v[178:179], v235 offset:13312
    v_mfma_f32_16x16x32_bf16 v[72:75], v[140:143], v[128:131], v[72:75]
    ds_read_b64_tr_b16 v[180:181], v234 offset:13344
    ds_read_b64_tr_b16 v[182:183], v235 offset:13344
    v_mfma_f32_16x16x32_bf16 v[76:79], v[140:143], v[132:135], v[76:79]
    ds_read_b64_tr_b16 v[184:185], v234 offset:13376
    ds_read_b64_tr_b16 v[186:187], v235 offset:13376
    v_mfma_f32_16x16x32_bf16 v[80:83], v[144:147], v[128:131], v[80:83]
    ds_read_b64_tr_b16 v[188:189], v234 offset:13408
    ds_read_b64_tr_b16 v[190:191], v235 offset:13408
    v_mfma_f32_16x16x32_bf16 v[84:87], v[144:147], v[132:135], v[84:87]
    ds_read_b64_tr_b16 v[192:193], v234 offset:13440
    ds_read_b64_tr_b16 v[194:195], v235 offset:13440
    v_mfma_f32_16x16x32_bf16 v[88:91], v[148:151], v[128:131], v[88:91]
    ds_read_b64_tr_b16 v[196:197], v234 offset:13472
    ds_read_b64_tr_b16 v[198:199], v235 offset:13472
    v_mfma_f32_16x16x32_bf16 v[92:95], v[148:151], v[132:135], v[92:95]
    v_mfma_f32_16x16x32_bf16 v[96:99], v[152:155], v[128:131], v[96:99]
    v_mfma_f32_16x16x32_bf16 v[100:103], v[152:155], v[132:135], v[100:103]
    v_mfma_f32_16x16x32_bf16 v[104:107], v[156:159], v[128:131], v[104:107]
    v_mfma_f32_16x16x32_bf16 v[108:111], v[156:159], v[132:135], v[108:111]
    s_waitcnt vmcnt(6) lgkmcnt(0)
    s_barrier
    v_mfma_f32_16x16x32_bf16 v[64:67], v[176:179], v[168:171], v[64:67]
    ds_read_b128 v[128:131], v236
    ds_read_b128 v[132:135], v236 offset:2048
    v_mfma_f32_16x16x32_bf16 v[68:71], v[176:179], v[172:175], v[68:71]
    ds_read_b64_tr_b16 v[136:137], v238 offset:0
    ds_read_b64_tr_b16 v[138:139], v239 offset:0
    v_mfma_f32_16x16x32_bf16 v[72:75], v[180:183], v[168:171], v[72:75]
    ds_read_b64_tr_b16 v[140:141], v238 offset:32
    ds_read_b64_tr_b16 v[142:143], v239 offset:32
    v_mfma_f32_16x16x32_bf16 v[76:79], v[180:183], v[172:175], v[76:79]
    ds_read_b64_tr_b16 v[144:145], v238 offset:64
    ds_read_b64_tr_b16 v[146:147], v239 offset:64
    v_mfma_f32_16x16x32_bf16 v[80:83], v[184:187], v[168:171], v[80:83]
    ds_read_b64_tr_b16 v[148:149], v238 offset:96
    ds_read_b64_tr_b16 v[150:151], v239 offset:96
    v_mfma_f32_16x16x32_bf16 v[84:87], v[184:187], v[172:175], v[84:87]
    ds_read_b64_tr_b16 v[152:153], v238 offset:128
    ds_read_b64_tr_b16 v[154:155], v239 offset:128
    v_mfma_f32_16x16x32_bf16 v[88:91], v[188:191], v[168:171], v[88:91]
    ds_read_b64_tr_b16 v[156:157], v238 offset:160
    ds_read_b64_tr_b16 v[158:159], v239 offset:160
    v_mfma_f32_16x16x32_bf16 v[92:95], v[188:191], v[172:175], v[92:95]
    v_mfma_f32_16x16x32_bf16 v[96:99], v[192:195], v[168:171], v[96:99]
    v_mov_b32 v17, 0
    buffer_load_dword v17, v17, s[44:47], 0 offen sc0 sc1
    s_lshl_b32 s57, s51, 2
    s_add_u32 s57, s57, 64
    v_mov_b32 v56, s57
    s_lshl_b32 s57, s71, 2
    s_add_u32 s57, s57, 128
    v_mov_b32 v57, s57
    buffer_load_dword v58, v56, s[44:47], 0 offen sc0 sc1
    buffer_load_dword v59, v57, s[44:47], 0 offen sc0 sc1
    v_mfma_f32_16x16x32_bf16 v[100:103], v[192:195], v[172:175], v[100:103]
    v_mfma_f32_16x16x32_bf16 v[104:107], v[196:199], v[168:171], v[104:107]
    v_mfma_f32_16x16x32_bf16 v[108:111], v[196:199], v[172:175], v[108:111]
    s_waitcnt lgkmcnt(0)
    v_mfma_f32_16x16x32_bf16 v[64:67], v[136:139], v[128:131], v[64:67]
    ds_read_b128 v[168:171], v237
    ds_read_b128 v[172:175], v237 offset:2048
    v_mfma_f32_16x16x32_bf16 v[68:71], v[136:139], v[132:135], v[68:71]
    ds_read_b64_tr_b16 v[176:177], v238 offset:13312
    ds_read_b64_tr_b16 v[178:179], v239 offset:13312
    v_mfma_f32_16x16x32_bf16 v[72:75], v[140:143], v[128:131], v[72:75]
    ds_read_b64_tr_b16 v[180:181], v238 offset:13344
    ds_read_b64_tr_b16 v[182:183], v239 offset:13344
    v_mfma_f32_16x16x32_bf16 v[76:79], v[140:143], v[132:135], v[76:79]
    ds_read_b64_tr_b16 v[184:185], v238 offset:13376
    ds_read_b64_tr_b16 v[186:187], v239 offset:13376
    v_mfma_f32_16x16x32_bf16 v[80:83], v[144:147], v[128:131], v[80:83]
    ds_read_b64_tr_b16 v[188:189], v238 offset:13408
    ds_read_b64_tr_b16 v[190:191], v239 offset:13408
    v_mfma_f32_16x16x32_bf16 v[84:87], v[144:147], v[132:135], v[84:87]
    ds_read_b64_tr_b16 v[192:193], v238 offset:13440
    ds_read_b64_tr_b16 v[194:195], v239 offset:13440
    v_mfma_f32_16x16x32_bf16 v[88:91], v[148:151], v[128:131], v[88:91]
    ds_read_b64_tr_b16 v[196:197], v238 offset:13472
    ds_read_b64_tr_b16 v[198:199], v239 offset:13472
    v_mfma_f32_16x16x32_bf16 v[92:95], v[148:151], v[132:135], v[92:95]
    v_mfma_f32_16x16x32_bf16 v[96:99], v[152:155], v[128:131], v[96:99]
    v_mfma_f32_16x16x32_bf16 v[100:103], v[152:155], v[132:135], v[100:103]
    v_mfma_f32_16x16x32_bf16 v[104:107], v[156:159], v[128:131], v[104:107]
    v_mfma_f32_16x16x32_bf16 v[108:111], v[156:159], v[132:135], v[108:111]
    s_waitcnt vmcnt(0) lgkmcnt(0)
    s_barrier
    v_mfma_f32_16x16x32_bf16 v[64:67], v[176:179], v[168:171], v[64:67]
    ds_read_b128 v[128:131], v228
    ds_read_b128 v[132:135], v228 offset:2048
    v_mfma_f32_16x16x32_bf16 v[68:71], v[176:179], v[172:175], v[68:71]
    ds_read_b64_tr_b16 v[136:137], v230 offset:0
    ds_read_b64_tr_b16 v[138:139], v231 offset:0
    v_mfma_f32_16x16x32_bf16 v[72:75], v[180:183], v[168:171], v[72:75]
    ds_read_b64_tr_b16 v[140:141], v230 offset:32
    ds_read_b64_tr_b16 v[142:143], v231 offset:32
    v_mfma_f32_16x16x32_bf16 v[76:79], v[180:183], v[172:175], v[76:79]
    ds_read_b64_tr_b16 v[144:145], v230 offset:64
    ds_read_b64_tr_b16 v[146:147], v231 offset:64
    v_mfma_f32_16x16x32_bf16 v[80:83], v[184:187], v[168:171], v[80:83]
    ds_read_b64_tr_b16 v[148:149], v230 offset:96
    ds_read_b64_tr_b16 v[150:151], v231 offset:96
    v_mfma_f32_16x16x32_bf16 v[84:87], v[184:187], v[172:175], v[84:87]
    ds_read_b64_tr_b16 v[152:153], v230 offset:128
    ds_read_b64_tr_b16 v[154:155], v231 offset:128
    v_mfma_f32_16x16x32_bf16 v[88:91], v[188:191], v[168:171], v[88:91]
    ds_read_b64_tr_b16 v[156:157], v230 offset:160
    ds_read_b64_tr_b16 v[158:159], v231 offset:160
    v_mfma_f32_16x16x32_bf16 v[92:95], v[188:191], v[172:175], v[92:95]
    v_mfma_f32_16x16x32_bf16 v[96:99], v[192:195], v[168:171], v[96:99]
    s_mov_b32 s60, 0
    s_waitcnt vmcnt(0)
K1_PS3:
    v_readfirstlane_b32 s57, v58
    v_readfirstlane_b32 s61, v59
    s_and_b32 s57, s57, 0xff
    s_min_u32 s57, s57, s61
    s_cmp_ge_u32 s57, 16
    s_cbranch_scc1 K1_PSD3
    s_add_u32 s60, s60, 1
    s_cmp_ge_u32 s60, 100000
    s_cbranch_scc1 K1_PSD3
    s_sleep 8
    buffer_load_dword v58, v56, s[44:47], 0 offen sc0 sc1
    buffer_load_dword v59, v57, s[44:47], 0 offen sc0 sc1
    s_waitcnt vmcnt(0)
    s_branch K1_PS3
K1_PSD3:
    s_lshl_b32 s57, s51, 2
    s_add_u32 s57, s57, s54
    s_lshl_b32 s57, s57, 8
    s_add_u32 s57, s57, 15998976
    v_lshlrev_b32 v24, 3, v2
    buffer_load_dwordx2 v[20:21], v24, s[32:35], s57 offen sc0 sc1
    buffer_load_dwordx2 v[22:23], v24, s[32:35], s57 offen offset:128 sc0 sc1
    s_cmp_lt_u32 s48, 4
    s_cbranch_scc0 K1_NCL3
    s_lshl_b32 s57, s71, 14
    s_add_u32 s57, s57, 16015360
    s_lshl_b32 s61, s48, 2
    s_add_u32 s57, s57, s61
    v_lshlrev_b32 v24, 4, v1
    buffer_load_dword v40, v24, s[32:35], s57 offen offset:0 sc0 sc1
    buffer_load_dword v41, v24, s[32:35], s57 offen offset:1024 sc0 sc1
    buffer_load_dword v42, v24, s[32:35], s57 offen offset:2048 sc0 sc1
    buffer_load_dword v43, v24, s[32:35], s57 offen offset:3072 sc0 sc1
    s_add_u32 s57, s57, 4096
    buffer_load_dword v44, v24, s[32:35], s57 offen offset:0 sc0 sc1
    buffer_load_dword v45, v24, s[32:35], s57 offen offset:1024 sc0 sc1
    buffer_load_dword v46, v24, s[32:35], s57 offen offset:2048 sc0 sc1
    buffer_load_dword v47, v24, s[32:35], s57 offen offset:3072 sc0 sc1
    s_add_u32 s57, s57, 4096
    buffer_load_dword v48, v24, s[32:35], s57 offen offset:0 sc0 sc1
    buffer_load_dword v49, v24, s[32:35], s57 offen offset:1024 sc0 sc1
    buffer_load_dword v50, v24, s[32:35], s57 offen offset:2048 sc0 sc1
    buffer_load_dword v51, v24, s[32:35], s57 offen offset:3072 sc0 sc1
    s_add_u32 s57, s57, 4096
    buffer_load_dword v52, v24, s[32:35], s57 offen offset:0 sc0 sc1
    buffer_load_dword v53, v24, s[32:35], s57 offen offset:1024 sc0 sc1
    buffer_load_dword v54, v24, s[32:35], s57 offen offset:2048 sc0 sc1
    buffer_load_dword v55, v24, s[32:35], s57 offen offset:3072 sc0 sc1
    s_add_u32 s57, s57, 4096
K1_NCL3:
    v_mfma_f32_16x16x32_bf16 v[100:103], v[192:195], v[172:175], v[100:103]
    v_mfma_f32_16x16x32_bf16 v[104:107], v[196:199], v[168:171], v[104:107]
    v_mfma_f32_16x16x32_bf16 v[108:111], v[196:199], v[172:175], v[108:111]
    s_waitcnt lgkmcnt(0)
    v_mfma_f32_16x16x32_bf16 v[64:67], v[136:139], v[128:131], v[64:67]
    ds_read_b128 v[168:171], v229
    ds_read_b128 v[172:175], v229 offset:2048
    v_mfma_f32_16x16x32_bf16 v[68:71], v[136:139], v[132:135], v[68:71]
    ds_read_b64_tr_b16 v[176:177], v230 offset:13312
    ds_read_b64_tr_b16 v[178:179], v231 offset:13312
    v_mfma_f32_16x16x32_bf16 v[72:75], v[140:143], v[128:131], v[72:75]
    ds_read_b64_tr_b16 v[180:181], v230 offset:13344
    ds_read_b64_tr_b16 v[182:183], v231 offset:13344
    v_mfma_f32_16x16x32_bf16 v[76:79], v[140:143], v[132:135], v[76:79]
    ds_read_b64_tr_b16 v[184:185], v230 offset:13376
    ds_read_b64_tr_b16 v[186:187], v231 offset:13376
    v_mfma_f32_16x16x32_bf16 v[80:83], v[144:147], v[128:131], v[80:83]
    ds_read_b64_tr_b16 v[188:189], v230 offset:13408
    ds_read_b64_tr_b16 v[190:191], v231 offset:13408
    v_mfma_f32_16x16x32_bf16 v[84:87], v[144:147], v[132:135], v[84:87]
    ds_read_b64_tr_b16 v[192:193], v230 offset:13440
    ds_read_b64_tr_b16 v[194:195], v231 offset:13440
    v_mfma_f32_16x16x32_bf16 v[88:91], v[148:151], v[128:131], v[88:91]
    ds_read_b64_tr_b16 v[196:197], v230 offset:13472
    ds_read_b64_tr_b16 v[198:199], v231 offset:13472
    v_mfma_f32_16x16x32_bf16 v[92:95], v[148:151], v[132:135], v[92:95]
    v_mfma_f32_16x16x32_bf16 v[96:99], v[152:155], v[128:131], v[96:99]
    v_mfma_f32_16x16x32_bf16 v[100:103], v[152:155], v[132:135], v[100:103]
    v_mfma_f32_16x16x32_bf16 v[104:107], v[156:159], v[128:131], v[104:107]
    v_mfma_f32_16x16x32_bf16 v[108:111], v[156:159], v[132:135], v[108:111]
    s_waitcnt lgkmcnt(0)
    s_barrier
    v_mfma_f32_16x16x32_bf16 v[64:67], v[176:179], v[168:171], v[64:67]
    v_mfma_f32_16x16x32_bf16 v[68:71], v[176:179], v[172:175], v[68:71]
    v_mfma_f32_16x16x32_bf16 v[72:75], v[180:183], v[168:171], v[72:75]
    v_mfma_f32_16x16x32_bf16 v[76:79], v[180:183], v[172:175], v[76:79]
    v_mfma_f32_16x16x32_bf16 v[80:83], v[184:187], v[168:171], v[80:83]
    v_mfma_f32_16x16x32_bf16 v[84:87], v[184:187], v[172:175], v[84:87]
    v_mfma_f32_16x16x32_bf16 v[88:91], v[188:191], v[168:171], v[88:91]
    v_mfma_f32_16x16x32_bf16 v[92:95], v[188:191], v[172:175], v[92:95]
    v_mfma_f32_16x16x32_bf16 v[96:99], v[192:195], v[168:171], v[96:99]
    v_mfma_f32_16x16x32_bf16 v[100:103], v[192:195], v[172:175], v[100:103]
    v_mfma_f32_16x16x32_bf16 v[104:107], v[196:199], v[168:171], v[104:107]
    v_mfma_f32_16x16x32_bf16 v[108:111], v[196:199], v[172:175], v[108:111]
    s_waitcnt vmcnt(0)
    s_cmp_lt_u32 s48, 4
    s_cbranch_scc0 K1_NCS3
    v_pk_add_f32 v[40:41], v[40:41], v[42:43]
    v_pk_add_f32 v[40:41], v[40:41], v[44:45]
    v_pk_add_f32 v[40:41], v[40:41], v[46:47]
    v_pk_add_f32 v[40:41], v[40:41], v[48:49]
    v_pk_add_f32 v[40:41], v[40:41], v[50:51]
    v_pk_add_f32 v[40:41], v[40:41], v[52:53]
    v_pk_add_f32 v[40:41], v[40:41], v[54:55]
    v_add_f32 v40, v40, v41
    s_lshl_b32 s57, s48, 2
    s_add_u32 s57, s57, 153600
    v_lshlrev_b32 v24, 4, v1
    v_add_u32 v24, s57, v24
    ds_write_b32 v24, v40
K1_NCS3:
    s_waitcnt lgkmcnt(0)
    s_barrier
    s_cmp_eq_u32 s48, 0
    s_cbranch_scc0 K1_NZ3
    v_readfirstlane_b32 s57, v17
    s_nop 0
    s_cmp_lg_u32 s57, 0
    s_cbranch_scc1 K1_ZOK3
    v_mov_b32 v24, 0
    s_mov_b32 s68, 0
K1_SZ3:
    buffer_load_dword v25, v24, s[44:47], 0 offen sc0 sc1
    s_waitcnt vmcnt(0)
    v_readfirstlane_b32 s57, v25
    s_nop 0
    s_cmp_lg_u32 s57, 0
    s_cbranch_scc1 K1_SZ3_D
    s_add_u32 s68, s68, 1
    s_cmp_ge_u32 s68, 100000
    s_cbranch_scc1 K1_SZ3_D
    s_sleep 12
    s_branch K1_SZ3
K1_SZ3_D:
K1_ZOK3:
    v_mov_b32 v25, 1
    s_mov_b32 s57, 16277504
    v_lshlrev_b32 v26, 7, v1
    s_mov_b64 exec, 0xffff
    buffer_atomic_add v25, v26, s[32:35], s57 offen offset:4
    s_mov_b64 exec, -1
K1_NZ3:
    v_lshlrev_b32 v26, 4, v3
    s_mul_i32 s57, s55, 384
    s_add_u32 s57, s57, 153600
    v_add_u32 v26, s57, v26
    ds_read_b128 v[128:131], v26 offset:0
    ds_read_b128 v[132:135], v26 offset:64
    ds_read_b128 v[136:139], v26 offset:128
    ds_read_b128 v[140:143], v26 offset:192
    ds_read_b128 v[144:147], v26 offset:256
    ds_read_b128 v[148:151], v26 offset:320
    v_mov_b32 v28, v20
    v_mov_b32 v32, v21
    v_mov_b32 v30, v22
    v_mov_b32 v34, v23
    s_waitcnt lgkmcnt(0)
    v_pk_fma_f32 v[64:65], v[128:129], v[28:29], v[64:65] op_sel_hi:[1,0,1] neg_lo:[0,1,0] neg_hi:[0,1,0]
    v_pk_fma_f32 v[66:67], v[130:131], v[28:29], v[66:67] op_sel_hi:[1,0,1] neg_lo:[0,1,0] neg_hi:[0,1,0]
    v_pk_fma_f32 v[68:69], v[128:129], v[30:31], v[68:69] op_sel_hi:[1,0,1] neg_lo:[0,1,0] neg_hi:[0,1,0]
    v_pk_fma_f32 v[70:71], v[130:131], v[30:31], v[70:71] op_sel_hi:[1,0,1] neg_lo:[0,1,0] neg_hi:[0,1,0]
    v_pk_fma_f32 v[72:73], v[132:133], v[28:29], v[72:73] op_sel_hi:[1,0,1] neg_lo:[0,1,0] neg_hi:[0,1,0]
    v_pk_fma_f32 v[74:75], v[134:135], v[28:29], v[74:75] op_sel_hi:[1,0,1] neg_lo:[0,1,0] neg_hi:[0,1,0]
    v_pk_fma_f32 v[76:77], v[132:133], v[30:31], v[76:77] op_sel_hi:[1,0,1] neg_lo:[0,1,0] neg_hi:[0,1,0]
    v_pk_fma_f32 v[78:79], v[134:135], v[30:31], v[78:79] op_sel_hi:[1,0,1] neg_lo:[0,1,0] neg_hi:[0,1,0]
    v_pk_fma_f32 v[80:81], v[136:137], v[28:29], v[80:81] op_sel_hi:[1,0,1] neg_lo:[0,1,0] neg_hi:[0,1,0]
    v_pk_fma_f32 v[82:83], v[138:139], v[28:29], v[82:83] op_sel_hi:[1,0,1] neg_lo:[0,1,0] neg_hi:[0,1,0]
    v_pk_fma_f32 v[84:85], v[136:137], v[30:31], v[84:85] op_sel_hi:[1,0,1] neg_lo:[0,1,0] neg_hi:[0,1,0]
    v_pk_fma_f32 v[86:87], v[138:139], v[30:31], v[86:87] op_sel_hi:[1,0,1] neg_lo:[0,1,0] neg_hi:[0,1,0]
    v_pk_fma_f32 v[88:89], v[140:141], v[28:29], v[88:89] op_sel_hi:[1,0,1] neg_lo:[0,1,0] neg_hi:[0,1,0]
    v_pk_fma_f32 v[90:91], v[142:143], v[28:29], v[90:91] op_sel_hi:[1,0,1] neg_lo:[0,1,0] neg_hi:[0,1,0]
    v_pk_fma_f32 v[92:93], v[140:141], v[30:31], v[92:93] op_sel_hi:[1,0,1] neg_lo:[0,1,0] neg_hi:[0,1,0]
    v_pk_fma_f32 v[94:95], v[142:143], v[30:31], v[94:95] op_sel_hi:[1,0,1] neg_lo:[0,1,0] neg_hi:[0,1,0]
    v_pk_fma_f32 v[96:97], v[144:145], v[28:29], v[96:97] op_sel_hi:[1,0,1] neg_lo:[0,1,0] neg_hi:[0,1,0]
    v_pk_fma_f32 v[98:99], v[146:147], v[28:29], v[98:99] op_sel_hi:[1,0,1] neg_lo:[0,1,0] neg_hi:[0,1,0]
    v_pk_fma_f32 v[100:101], v[144:145], v[30:31], v[100:101] op_sel_hi:[1,0,1] neg_lo:[0,1,0] neg_hi:[0,1,0]
    v_pk_fma_f32 v[102:103], v[146:147], v[30:31], v[102:103] op_sel_hi:[1,0,1] neg_lo:[0,1,0] neg_hi:[0,1,0]
    v_pk_fma_f32 v[104:105], v[148:149], v[28:29], v[104:105] op_sel_hi:[1,0,1] neg_lo:[0,1,0] neg_hi:[0,1,0]
    v_pk_fma_f32 v[106:107], v[150:151], v[28:29], v[106:107] op_sel_hi:[1,0,1] neg_lo:[0,1,0] neg_hi:[0,1,0]
    v_pk_fma_f32 v[108:109], v[148:149], v[30:31], v[108:109] op_sel_hi:[1,0,1] neg_lo:[0,1,0] neg_hi:[0,1,0]
    v_pk_fma_f32 v[110:111], v[150:151], v[30:31], v[110:111] op_sel_hi:[1,0,1] neg_lo:[0,1,0] neg_hi:[0,1,0]
    v_pk_mul_f32 v[64:65], v[64:65], v[32:33] op_sel_hi:[1,0]
    v_pk_mul_f32 v[66:67], v[66:67], v[32:33] op_sel_hi:[1,0]
    v_pk_mul_f32 v[68:69], v[68:69], v[34:35] op_sel_hi:[1,0]
    v_pk_mul_f32 v[70:71], v[70:71], v[34:35] op_sel_hi:[1,0]
    v_pk_mul_f32 v[72:73], v[72:73], v[32:33] op_sel_hi:[1,0]
    v_pk_mul_f32 v[74:75], v[74:75], v[32:33] op_sel_hi:[1,0]
    v_pk_mul_f32 v[76:77], v[76:77], v[34:35] op_sel_hi:[1,0]
    v_pk_mul_f32 v[78:79], v[78:79], v[34:35] op_sel_hi:[1,0]
    v_pk_mul_f32 v[80:81], v[80:81], v[32:33] op_sel_hi:[1,0]
    v_pk_mul_f32 v[82:83], v[82:83], v[32:33] op_sel_hi:[1,0]
    v_pk_mul_f32 v[84:85], v[84:85], v[34:35] op_sel_hi:[1,0]
    v_pk_mul_f32 v[86:87], v[86:87], v[34:35] op_sel_hi:[1,0]
    v_pk_mul_f32 v[88:89], v[88:89], v[32:33] op_sel_hi:[1,0]
    v_pk_mul_f32 v[90:91], v[90:91], v[32:33] op_sel_hi:[1,0]
    v_pk_mul_f32 v[92:93], v[92:93], v[34:35] op_sel_hi:[1,0]
    v_pk_mul_f32 v[94:95], v[94:95], v[34:35] op_sel_hi:[1,0]
    v_pk_mul_f32 v[96:97], v[96:97], v[32:33] op_sel_hi:[1,0]
    v_pk_mul_f32 v[98:99], v[98:99], v[32:33] op_sel_hi:[1,0]
    v_pk_mul_f32 v[100:101], v[100:101], v[34:35] op_sel_hi:[1,0]
    v_pk_mul_f32 v[102:103], v[102:103], v[34:35] op_sel_hi:[1,0]
    v_pk_mul_f32 v[104:105], v[104:105], v[32:33] op_sel_hi:[1,0]
    v_pk_mul_f32 v[106:107], v[106:107], v[32:33] op_sel_hi:[1,0]
    v_pk_mul_f32 v[108:109], v[108:109], v[34:35] op_sel_hi:[1,0]
    v_pk_mul_f32 v[110:111], v[110:111], v[34:35] op_sel_hi:[1,0]
    s_mov_b32 s56, 1069066811
    s_mov_b32 s57, 1069066811
    s_lshl_b32 s60, s51, 3
    s_lshl_b32 s61, s54, 1
    s_add_u32 s60, s60, s61
    s_mul_i32 s60, s60, 54
    s_mul_i32 s61, s52, 3
    s_add_u32 s61, s61, 3
    s_lshl_b32 s62, s52, 2
    s_cmp_lt_u32 s52, 3
    s_cselect_b32 s61, s62, s61
    s_lshl_b32 s61, s61, 1
    s_add_u32 s60, s60, s61
    s_mul_i32 s61, s55, 3
    s_add_u32 s60, s60, s61
    s_lshl_b32 s60, s60, 10
    s_add_u32 s61, s60, 55296
    v_lshlrev_b32 v44, 4, v1
    v_pk_mul_f32 v[128:129], v[64:65], s[56:57] op_sel_hi:[1,0]
    v_pk_mul_f32 v[130:131], v[66:67], s[56:57] op_sel_hi:[1,0]
    v_pk_mul_f32 v[132:133], v[72:73], s[56:57] op_sel_hi:[1,0]
    v_pk_mul_f32 v[134:135], v[74:75], s[56:57] op_sel_hi:[1,0]
    v_exp_f32 v128, -v128
    v_exp_f32 v129, -v129
    v_exp_f32 v130, -v130
    v_exp_f32 v131, -v131
    v_exp_f32 v132, -v132
    v_exp_f32 v133, -v133
    v_exp_f32 v134, -v134
    v_exp_f32 v135, -v135
    v_pk_add_f32 v[128:129], v[128:129], 1.0 op_sel_hi:[1,0]
    v_pk_add_f32 v[130:131], v[130:131], 1.0 op_sel_hi:[1,0]
    v_pk_add_f32 v[132:133], v[132:133], 1.0 op_sel_hi:[1,0]
    v_pk_add_f32 v[134:135], v[134:135], 1.0 op_sel_hi:[1,0]
    v_rcp_f32 v128, v128
    v_rcp_f32 v129, v129
    v_rcp_f32 v130, v130
    v_rcp_f32 v131, v131
    v_rcp_f32 v132, v132
    v_rcp_f32 v133, v133
    v_rcp_f32 v134, v134
    v_rcp_f32 v135, v135
    v_pk_mul_f32 v[64:65], v[64:65], v[128:129]
    v_pk_mul_f32 v[66:67], v[66:67], v[130:131]
    v_pk_mul_f32 v[72:73], v[72:73], v[132:133]
    v_pk_mul_f32 v[74:75], v[74:75], v[134:135]
    v_cvt_pk_bf16_f32 v160, v64, v65
    v_cvt_pk_bf16_f32 v161, v66, v67
    v_cvt_pk_bf16_f32 v162, v72, v73
    v_cvt_pk_bf16_f32 v163, v74, v75
    buffer_store_dwordx4 v[160:163], v44, s[32:35], s60 offen offset:0 sc1
    v_pk_mul_f32 v[136:137], v[68:69], s[56:57] op_sel_hi:[1,0]
    v_pk_mul_f32 v[138:139], v[70:71], s[56:57] op_sel_hi:[1,0]
    v_pk_mul_f32 v[140:141], v[76:77], s[56:57] op_sel_hi:[1,0]
    v_pk_mul_f32 v[142:143], v[78:79], s[56:57] op_sel_hi:[1,0]
    v_exp_f32 v136, -v136
    v_exp_f32 v137, -v137
    v_exp_f32 v138, -v138
    v_exp_f32 v139, -v139
    v_exp_f32 v140, -v140
    v_exp_f32 v141, -v141
    v_exp_f32 v142, -v142
    v_exp_f32 v143, -v143
    v_pk_add_f32 v[136:137], v[136:137], 1.0 op_sel_hi:[1,0]
    v_pk_add_f32 v[138:139], v[138:139], 1.0 op_sel_hi:[1,0]
    v_pk_add_f32 v[140:141], v[140:141], 1.0 op_sel_hi:[1,0]
    v_pk_add_f32 v[142:143], v[142:143], 1.0 op_sel_hi:[1,0]
    v_rcp_f32 v136, v136
    v_rcp_f32 v137, v137
    v_rcp_f32 v138, v138
    v_rcp_f32 v139, v139
    v_rcp_f32 v140, v140
    v_rcp_f32 v141, v141
    v_rcp_f32 v142, v142
    v_rcp_f32 v143, v143
    v_pk_mul_f32 v[68:69], v[68:69], v[136:137]
    v_pk_mul_f32 v[70:71], v[70:71], v[138:139]
    v_pk_mul_f32 v[76:77], v[76:77], v[140:141]
    v_pk_mul_f32 v[78:79], v[78:79], v[142:143]
    v_cvt_pk_bf16_f32 v164, v68, v69
    v_cvt_pk_bf16_f32 v165, v70, v71
    v_cvt_pk_bf16_f32 v166, v76, v77
    v_cvt_pk_bf16_f32 v167, v78, v79
    buffer_store_dwordx4 v[164:167], v44, s[32:35], s61 offen offset:0 sc1
    v_pk_mul_f32 v[128:129], v[80:81], s[56:57] op_sel_hi:[1,0]
    v_pk_mul_f32 v[130:131], v[82:83], s[56:57] op_sel_hi:[1,0]
    v_pk_mul_f32 v[132:133], v[88:89], s[56:57] op_sel_hi:[1,0]
    v_pk_mul_f32 v[134:135], v[90:91], s[56:57] op_sel_hi:[1,0]
    v_exp_f32 v128, -v128
    v_exp_f32 v129, -v129
    v_exp_f32 v130, -v130
    v_exp_f32 v131, -v131
    v_exp_f32 v132, -v132
    v_exp_f32 v133, -v133
    v_exp_f32 v134, -v134
    v_exp_f32 v135, -v135
    v_pk_add_f32 v[128:129], v[128:129], 1.0 op_sel_hi:[1,0]
    v_pk_add_f32 v[130:131], v[130:131], 1.0 op_sel_hi:[1,0]
    v_pk_add_f32 v[132:133], v[132:133], 1.0 op_sel_hi:[1,0]
    v_pk_add_f32 v[134:135], v[134:135], 1.0 op_sel_hi:[1,0]
    v_rcp_f32 v128, v128
    v_rcp_f32 v129, v129
    v_rcp_f32 v130, v130
    v_rcp_f32 v131, v131
    v_rcp_f32 v132, v132
    v_rcp_f32 v133, v133
    v_rcp_f32 v134, v134
    v_rcp_f32 v135, v135
    v_pk_mul_f32 v[80:81], v[80:81], v[128:129]
    v_pk_mul_f32 v[82:83], v[82:83], v[130:131]
    v_pk_mul_f32 v[88:89], v[88:89], v[132:133]
    v_pk_mul_f32 v[90:91], v[90:91], v[134:135]
    v_cvt_pk_bf16_f32 v168, v80, v81
    v_cvt_pk_bf16_f32 v169, v82, v83
    v_cvt_pk_bf16_f32 v170, v88, v89
    v_cvt_pk_bf16_f32 v171, v90, v91
    buffer_store_dwordx4 v[168:171], v44, s[32:35], s60 offen offset:1024 sc1
    v_pk_mul_f32 v[136:137], v[84:85], s[56:57] op_sel_hi:[1,0]
    v_pk_mul_f32 v[138:139], v[86:87], s[56:57] op_sel_hi:[1,0]
    v_pk_mul_f32 v[140:141], v[92:93], s[56:57] op_sel_hi:[1,0]
    v_pk_mul_f32 v[142:143], v[94:95], s[56:57] op_sel_hi:[1,0]
    v_exp_f32 v136, -v136
    v_exp_f32 v137, -v137
    v_exp_f32 v138, -v138
    v_exp_f32 v139, -v139
    v_exp_f32 v140, -v140
    v_exp_f32 v141, -v141
    v_exp_f32 v142, -v142
    v_exp_f32 v143, -v143
    v_pk_add_f32 v[136:137], v[136:137], 1.0 op_sel_hi:[1,0]
    v_pk_add_f32 v[138:139], v[138:139], 1.0 op_sel_hi:[1,0]
    v_pk_add_f32 v[140:141], v[140:141], 1.0 op_sel_hi:[1,0]
    v_pk_add_f32 v[142:143], v[142:143], 1.0 op_sel_hi:[1,0]
    v_rcp_f32 v136, v136
    v_rcp_f32 v137, v137
    v_rcp_f32 v138, v138
    v_rcp_f32 v139, v139
    v_rcp_f32 v140, v140
    v_rcp_f32 v141, v141
    v_rcp_f32 v142, v142
    v_rcp_f32 v143, v143
    v_pk_mul_f32 v[84:85], v[84:85], v[136:137]
    v_pk_mul_f32 v[86:87], v[86:87], v[138:139]
    v_pk_mul_f32 v[92:93], v[92:93], v[140:141]
    v_pk_mul_f32 v[94:95], v[94:95], v[142:143]
    v_cvt_pk_bf16_f32 v172, v84, v85
    v_cvt_pk_bf16_f32 v173, v86, v87
    v_cvt_pk_bf16_f32 v174, v92, v93
    v_cvt_pk_bf16_f32 v175, v94, v95
    buffer_store_dwordx4 v[172:175], v44, s[32:35], s61 offen offset:1024 sc1
    v_pk_mul_f32 v[128:129], v[96:97], s[56:57] op_sel_hi:[1,0]
    v_pk_mul_f32 v[130:131], v[98:99], s[56:57] op_sel_hi:[1,0]
    v_pk_mul_f32 v[132:133], v[104:105], s[56:57] op_sel_hi:[1,0]
    v_pk_mul_f32 v[134:135], v[106:107], s[56:57] op_sel_hi:[1,0]
    v_exp_f32 v128, -v128
    v_exp_f32 v129, -v129
    v_exp_f32 v130, -v130
    v_exp_f32 v131, -v131
    v_exp_f32 v132, -v132
    v_exp_f32 v133, -v133
    v_exp_f32 v134, -v134
    v_exp_f32 v135, -v135
    v_pk_add_f32 v[128:129], v[128:129], 1.0 op_sel_hi:[1,0]
    v_pk_add_f32 v[130:131], v[130:131], 1.0 op_sel_hi:[1,0]
    v_pk_add_f32 v[132:133], v[132:133], 1.0 op_sel_hi:[1,0]
    v_pk_add_f32 v[134:135], v[134:135], 1.0 op_sel_hi:[1,0]
    v_rcp_f32 v128, v128
    v_rcp_f32 v129, v129
    v_rcp_f32 v130, v130
    v_rcp_f32 v131, v131
    v_rcp_f32 v132, v132
    v_rcp_f32 v133, v133
    v_rcp_f32 v134, v134
    v_rcp_f32 v135, v135
    v_pk_mul_f32 v[96:97], v[96:97], v[128:129]
    v_pk_mul_f32 v[98:99], v[98:99], v[130:131]
    v_pk_mul_f32 v[104:105], v[104:105], v[132:133]
    v_pk_mul_f32 v[106:107], v[106:107], v[134:135]
    v_cvt_pk_bf16_f32 v176, v96, v97
    v_cvt_pk_bf16_f32 v177, v98, v99
    v_cvt_pk_bf16_f32 v178, v104, v105
    v_cvt_pk_bf16_f32 v179, v106, v107
    buffer_store_dwordx4 v[176:179], v44, s[32:35], s60 offen offset:2048 sc1
    v_pk_mul_f32 v[136:137], v[100:101], s[56:57] op_sel_hi:[1,0]
    v_pk_mul_f32 v[138:139], v[102:103], s[56:57] op_sel_hi:[1,0]
    v_pk_mul_f32 v[140:141], v[108:109], s[56:57] op_sel_hi:[1,0]
    v_pk_mul_f32 v[142:143], v[110:111], s[56:57] op_sel_hi:[1,0]
    v_exp_f32 v136, -v136
    v_exp_f32 v137, -v137
    v_exp_f32 v138, -v138
    v_exp_f32 v139, -v139
    v_exp_f32 v140, -v140
    v_exp_f32 v141, -v141
    v_exp_f32 v142, -v142
    v_exp_f32 v143, -v143
    v_pk_add_f32 v[136:137], v[136:137], 1.0 op_sel_hi:[1,0]
    v_pk_add_f32 v[138:139], v[138:139], 1.0 op_sel_hi:[1,0]
    v_pk_add_f32 v[140:141], v[140:141], 1.0 op_sel_hi:[1,0]
    v_pk_add_f32 v[142:143], v[142:143], 1.0 op_sel_hi:[1,0]
    v_rcp_f32 v136, v136
    v_rcp_f32 v137, v137
    v_rcp_f32 v138, v138
    v_rcp_f32 v139, v139
    v_rcp_f32 v140, v140
    v_rcp_f32 v141, v141
    v_rcp_f32 v142, v142
    v_rcp_f32 v143, v143
    v_pk_mul_f32 v[100:101], v[100:101], v[136:137]
    v_pk_mul_f32 v[102:103], v[102:103], v[138:139]
    v_pk_mul_f32 v[108:109], v[108:109], v[140:141]
    v_pk_mul_f32 v[110:111], v[110:111], v[142:143]
    v_cvt_pk_bf16_f32 v180, v100, v101
    v_cvt_pk_bf16_f32 v181, v102, v103
    v_cvt_pk_bf16_f32 v182, v108, v109
    v_cvt_pk_bf16_f32 v183, v110, v111
    buffer_store_dwordx4 v[180:183], v44, s[32:35], s61 offen offset:2048 sc1
    s_branch K1_P2
K1_P2:
    s_lshr_b32 s57, s48, 2
    s_mul_i32 s57, s57, 81920
    s_add_u32 s57, s57, 20464
    v_mov_b32 v62, s57
    v_mov_b32 v63, 0
    ds_write_b32 v62, v63
    s_waitcnt vmcnt(0) lgkmcnt(0)
    s_barrier
    s_cmp_eq_u32 s48, 0
    s_cbranch_scc0 P2_NSIG
    v_mov_b32 v25, 1
    s_mov_b32 s58, 16277504
    s_cmp_eq_u32 s53, 0
    s_cbranch_scc1 P2_SQ
    s_lshl_b32 s57, s51, 7
    v_mov_b32 v24, s57
    v_lshlrev_b32 v26, 7, v1
    s_mov_b64 exec, 1
    buffer_atomic_add v25, v24, s[32:35], s58 offen
    s_branch P2_SE
P2_SQ:
    s_lshl_b32 s57, s52, 7
    s_add_u32 s57, s57, 2048
    v_mov_b32 v24, s57
    s_mov_b64 exec, 1
    buffer_atomic_add v25, v24, s[32:35], s58 offen
P2_SE:
    s_mov_b64 exec, -1
P2_NSIG:
    s_and_b32 s49, s2, 7
    s_lshr_b32 s50, s2, 3
    s_and_b32 s51, s49, 1
    s_lshl_b32 s51, s51, 4
    s_bfe_u32 s52, s49, 0x10001
    s_lshl_b32 s52, s52, 3
    s_add_u32 s51, s51, s52
    s_and_b32 s52, s50, 7
    s_add_u32 s51, s51, s52
    s_lshr_b32 s52, s49, 2
    s_lshl_b32 s52, s52, 2
    s_lshr_b32 s53, s50, 3
    s_add_u32 s52, s52, s53
    s_mov_b32 s28, s18
    s_mov_b32 s29, s19
    s_mov_b32 s30, 2621440
    s_mov_b32 s31, 0x00020000
    v_lshlrev_b32 v5, 4, v1
    v_mov_b32 v23, 1073741824
    s_mul_i32 s56, s52, 5120
    s_add_u32 s56, s56, 12845056
    v_add_u32 v10, s56, v5
    v_add_u32 v11, 4096, v10
    s_mul_i32 s66, s48, 20480
    v_lshrrev_b32 v24, 1, v2
    v_xor_b32 v24, v24, v3
    v_and_b32 v24, 3, v24
    v_lshl_add_u32 v24, v2, 2, v24
    v_lshlrev_b32 v24, 4, v24
    v_add_u32 v13, s66, v24
    v_lshrrev_b32 v14, 2, v1
    v_and_b32 v15, 3, v1
    v_lshrrev_b32 v24, 1, v14
    v_xor_b32 v24, v24, v15
    v_and_b32 v24, 3, v24
    v_lshl_add_u32 v24, v14, 2, v24
    v_lshlrev_b32 v12, 4, v24
    s_cmp_ge_u32 s48, 4
    s_cbranch_scc1 P2_OW
    s_mul_i32 s55, s51, 221184
    s_add_u32 s56, s55, 0
    v_add_u32 v6, s56, v5
    s_add_u32 s56, s55, 55296
    v_add_u32 v7, s56, v5
    s_add_u32 s56, s55, 110592
    v_add_u32 v8, s56, v5
    s_add_u32 s56, s55, 165888
    v_add_u32 v9, s56, v5
    s_mul_i32 s53, s48, 14
    s_cmp_eq_u32 s48, 3
    s_cselect_b32 s57, 1, 0
    s_sub_u32 s53, s53, s57
    s_lshl_b32 s60, s53, 10
    s_mul_i32 s61, s53, 40960
    s_lshr_b32 s62, s48, 1
    s_lshr_b32 s57, s51, 1
    s_lshl_b32 s57, s57, 7
    s_add_u32 s57, s57, 16277504
    v_mov_b32 v24, s57
    s_cmp_eq_u32 s48, 0
    s_cbranch_scc0 P2_LF
    s_mov_b32 s68, 0
P2_SF:
    buffer_load_dwordx2 v[26:27], v24, s[32:35], 0 offen sc0 sc1
    s_waitcnt vmcnt(0)
    v_readfirstlane_b32 s57, v26
    v_readfirstlane_b32 s58, v27
    s_mul_i32 s57, s57, 10
    s_min_u32 s57, s57, s58
    s_cmp_ge_u32 s57, 80
    s_cbranch_scc1 P2_SF_D
    s_add_u32 s68, s68, 1
    s_cmp_ge_u32 s68, 100000
    s_cbranch_scc1 P2_SF_D
    s_sleep 12
    s_branch P2_SF
P2_SF_D:
    v_mov_b32 v63, 1
    ds_write_b32 v62, v63
    s_branch P2_GEMM
P2_LF:
    s_mov_b32 s68, 0
P2_LFS:
    ds_read_b32 v63, v62
    s_waitcnt lgkmcnt(0)
    v_readfirstlane_b32 s57, v63
    s_nop 0
    s_cmp_lg_u32 s57, 0
    s_cbranch_scc1 P2_LFS_D
    s_add_u32 s68, s68, 1
    s_cmp_ge_u32 s68, 3000000
    s_cbranch_scc1 P2_LFS_D
    s_sleep 1
    s_branch P2_LFS
P2_LFS_D:
    s_branch P2_GEMM
P2_OW:
    s_setprio 3
    s_lshl_b32 s57, s51, 7
    s_add_u32 s57, s57, 16280576
    v_mov_b32 v18, s57
    s_bitcmp1_b32 s52, 1
    s_cbranch_scc0 P2_OSKIP
    s_cmp_ge_u32 s48, 6
    s_cselect_b32 s57, 2, 0
    s_sub_u32 s70, s52, s57
    s_mul_i32 s56, s70, 3200
    v_add_u32 v24, 0, v5
    v_add_u32 v25, s56, v24
    v_cmp_gt_u32 vcc, 3200, v24
    s_nop 1
    v_cndmask_b32 v25, v23, v25, vcc
    buffer_load_dwordx4 v[144:147], v25, s[36:39], 0 offen
    v_add_u32 v24, 1024, v5
    v_add_u32 v25, s56, v24
    v_cmp_gt_u32 vcc, 3200, v24
    s_nop 1
    v_cndmask_b32 v25, v23, v25, vcc
    buffer_load_dwordx4 v[148:151], v25, s[36:39], 0 offen
    v_add_u32 v24, 2048, v5
    v_add_u32 v25, s56, v24
    v_cmp_gt_u32 vcc, 3200, v24
    s_nop 1
    v_cndmask_b32 v25, v23, v25, vcc
    buffer_load_dwordx4 v[152:155], v25, s[36:39], 0 offen
    v_add_u32 v24, 3072, v5
    v_add_u32 v25, s56, v24
    v_cmp_gt_u32 vcc, 3200, v24
    s_nop 1
    v_cndmask_b32 v25, v23, v25, vcc
    buffer_load_dwordx4 v[156:159], v25, s[36:39], 0 offen
    v_add_u32 v16, s66, v5
    v_mov_b32 v160, 0
    v_mov_b32 v161, 0
    v_mov_b32 v162, 0
    v_mov_b32 v163, 0
    ds_write_b128 v16, v[160:163] offset:12288
    ds_write_b128 v16, v[160:163] offset:13312
    ds_write_b128 v16, v[160:163] offset:14336
    ds_write_b128 v16, v[160:163] offset:15360
    ds_write_b128 v16, v[160:163] offset:16384
    ds_write_b128 v16, v[160:163] offset:17408
    ds_write_b128 v16, v[160:163] offset:18432
    ds_write_b128 v16, v[160:163] offset:19456
    s_waitcnt vmcnt(0)
    ds_write_b128 v16, v[144:147] offset:0
    ds_write_b128 v16, v[148:151] offset:1024
    ds_write_b128 v16, v[152:155] offset:2048
    ds_write_b128 v16, v[156:159] offset:3072
    s_lshr_b32 s57, s51, 1
    s_lshl_b32 s57, s57, 7
    s_add_u32 s57, s57, 16277512
    v_mov_b32 v24, s57
    s_mov_b32 s68, 0
P2_SQ2:
    buffer_load_dword v25, v24, s[32:35], 0 offen sc0 sc1
    s_waitcnt vmcnt(0)
    v_readfirstlane_b32 s57, v25
    s_nop 0
    s_cmp_ge_u32 s57, 8
    s_cbranch_scc1 P2_SQ2_D
    s_add_u32 s68, s68, 1
    s_cmp_ge_u32 s68, 100000
    s_cbranch_scc1 P2_SQ2_D
    s_sleep 12
    s_branch P2_SQ2
P2_SQ2_D:
    s_lshl_b32 s64, s51, 2
    s_and_b32 s57, s48, 1
    s_lshl_b32 s57, s57, 1
    s_add_u32 s64, s64, s57
    s_lshl_b32 s65, s64, 3
    s_add_u32 s65, s65, s70
    s_mul_i32 s65, s65, 3072
    s_add_u32 s65, s65, 7077888
    s_add_u32 s67, s65, 24576
    buffer_load_dwordx4 v[208:211], v5, s[32:35], s65 offen offset:0 sc0 sc1
    buffer_load_dwordx4 v[212:215], v5, s[32:35], s65 offen offset:1024 sc0 sc1
    buffer_load_dwordx4 v[216:219], v5, s[32:35], s65 offen offset:2048 sc0 sc1
    buffer_load_dwordx4 v[220:223], v5, s[32:35], s67 offen offset:0 sc0 sc1
    buffer_load_dwordx4 v[224:227], v5, s[32:35], s67 offen offset:1024 sc0 sc1
    buffer_load_dwordx4 v[228:231], v5, s[32:35], s67 offen offset:2048 sc0 sc1
    v_lshrrev_b32 v26, 2, v1
    v_and_b32 v26, 3, v26
    v_and_b32 v27, 3, v1
    v_mul_u32_u24 v28, 800, v3
    v_mul_u32_u24 v29, 40, v26
    v_add3_u32 v28, v28, v29, s66
    v_mov_b32 v29, 3200
    v_add_u32 v29, s66, v29
    v_cmp_eq_u32 vcc, v27, v3
    v_add_u32 v30, 0, v28
    s_nop 0
    v_cndmask_b32 v31, v29, v30, vcc
    v_add_u32 v30, 160, v28
    v_cndmask_b32 v32, v29, v30, vcc
    v_add_u32 v30, 320, v28
    v_cndmask_b32 v33, v29, v30, vcc
    v_add_u32 v30, 480, v28
    v_cndmask_b32 v34, v29, v30, vcc
    v_add_u32 v30, 640, v28
    v_cndmask_b32 v35, v29, v30, vcc
    v_lshrrev_b32 v24, 2, v2
    v_lshlrev_b32 v25, 4, v2
    v_add_u32 v25, 4096, v25
    v_mov_b32 v28, 12288
    v_cmp_eq_u32 vcc, v24, v3
    s_nop 1
    v_cndmask_b32 v17, v28, v25, vcc
    v_add_u32 v17, s66, v17
    s_waitcnt vmcnt(0) lgkmcnt(0)
    v_mov_b32 v154, 0
    v_mov_b32 v155, 0
    v_mov_b32 v166, 0
    v_mov_b32 v167, 0
    s_mov_b32 s56, 1069066811
    s_mov_b32 s57, 1069066811
    s_mul_i32 s65, s64, 20
    s_lshr_b32 s67, s70, 1
    s_mul_i32 s67, s67, 5
    s_add_u32 s65, s65, s67
    s_lshl_b32 s65, s65, 10
    s_add_u32 s65, s65, 10223616
    s_mov_b32 s63, 0
P2_PL:
    ds_read_b64_tr_b16 v[144:145], v31 offset:0
    ds_read_b64_tr_b16 v[146:147], v32 offset:0
    ds_read_b64_tr_b16 v[148:149], v33 offset:0
    ds_read_b64_tr_b16 v[150:151], v34 offset:0
    ds_read_b64_tr_b16 v[152:153], v35 offset:0
    ds_read_b64_tr_b16 v[156:157], v31 offset:8
    ds_read_b64_tr_b16 v[158:159], v32 offset:8
    ds_read_b64_tr_b16 v[160:161], v33 offset:8
    ds_read_b64_tr_b16 v[162:163], v34 offset:8
    ds_read_b64_tr_b16 v[164:165], v35 offset:8
    s_waitcnt lgkmcnt(5)
    v_mfma_f32_16x16x32_bf16 v[64:67], v[144:147], v[208:211], 0
    v_mfma_f32_16x16x32_bf16 v[64:67], v[148:151], v[212:215], v[64:67]
    v_mfma_f32_16x16x32_bf16 v[64:67], v[152:155], v[216:219], v[64:67]
    ds_read_b64_tr_b16 v[144:145], v31 offset:16
    ds_read_b64_tr_b16 v[146:147], v32 offset:16
    ds_read_b64_tr_b16 v[148:149], v33 offset:16
    ds_read_b64_tr_b16 v[150:151], v34 offset:16
    ds_read_b64_tr_b16 v[152:153], v35 offset:16
    s_waitcnt lgkmcnt(5)
    v_mfma_f32_16x16x32_bf16 v[68:71], v[156:159], v[208:211], 0
    v_mfma_f32_16x16x32_bf16 v[68:71], v[160:163], v[212:215], v[68:71]
    v_mfma_f32_16x16x32_bf16 v[68:71], v[164:167], v[216:219], v[68:71]
    ds_read_b64_tr_b16 v[156:157], v31 offset:24
    ds_read_b64_tr_b16 v[158:159], v32 offset:24
    ds_read_b64_tr_b16 v[160:161], v33 offset:24
    ds_read_b64_tr_b16 v[162:163], v34 offset:24
    ds_read_b64_tr_b16 v[164:165], v35 offset:24
    s_waitcnt lgkmcnt(5)
    v_mfma_f32_16x16x32_bf16 v[72:75], v[144:147], v[208:211], 0
    v_mfma_f32_16x16x32_bf16 v[72:75], v[148:151], v[212:215], v[72:75]
    v_mfma_f32_16x16x32_bf16 v[72:75], v[152:155], v[216:219], v[72:75]
    ds_read_b64_tr_b16 v[144:145], v31 offset:32
    ds_read_b64_tr_b16 v[146:147], v32 offset:32
    ds_read_b64_tr_b16 v[148:149], v33 offset:32
    ds_read_b64_tr_b16 v[150:151], v34 offset:32
    ds_read_b64_tr_b16 v[152:153], v35 offset:32
    s_waitcnt lgkmcnt(5)
    v_mfma_f32_16x16x32_bf16 v[76:79], v[156:159], v[208:211], 0
    v_mfma_f32_16x16x32_bf16 v[76:79], v[160:163], v[212:215], v[76:79]
    v_mfma_f32_16x16x32_bf16 v[76:79], v[164:167], v[216:219], v[76:79]
    s_waitcnt lgkmcnt(0)
    v_mfma_f32_16x16x32_bf16 v[80:83], v[144:147], v[208:211], 0
    v_mfma_f32_16x16x32_bf16 v[80:83], v[148:151], v[212:215], v[80:83]
    v_mfma_f32_16x16x32_bf16 v[80:83], v[152:155], v[216:219], v[80:83]
    v_max3_f32 v40, v64, v65, v66
    v_min3_f32 v42, v64, v65, v66
    v_max3_f32 v40, v40, v67, v68
    v_min3_f32 v42, v42, v67, v68
    v_max3_f32 v40, v40, v69, v70
    v_min3_f32 v42, v42, v69, v70
    v_max3_f32 v40, v40, v71, v72
    v_min3_f32 v42, v42, v71, v72
    v_max3_f32 v40, v40, v73, v74
    v_min3_f32 v42, v42, v73, v74
    v_max3_f32 v40, v40, v75, v76
    v_min3_f32 v42, v42, v75, v76
    v_max3_f32 v40, v40, v77, v78
    v_min3_f32 v42, v42, v77, v78
    v_max3_f32 v40, v40, v79, v80
    v_min3_f32 v42, v42, v79, v80
    v_max3_f32 v40, v40, v81, v82
    v_min3_f32 v42, v42, v81, v82
    v_max_f32 v40, v40, v83
    v_min_f32 v42, v42, v83
    v_mul_f32 v40, s56, v40
    v_mul_f32 v42, s56, v42
    v_pk_fma_f32 v[84:85], v[64:65], s[56:57], v[40:41] op_sel_hi:[1,0,0] neg_lo:[0,0,1] neg_hi:[0,0,1]
    v_pk_fma_f32 v[64:65], v[64:65], s[56:57], v[42:43] op_sel_hi:[1,0,0] neg_lo:[1,0,0] neg_hi:[1,0,0]
    v_pk_fma_f32 v[86:87], v[66:67], s[56:57], v[40:41] op_sel_hi:[1,0,0] neg_lo:[0,0,1] neg_hi:[0,0,1]
    v_pk_fma_f32 v[66:67], v[66:67], s[56:57], v[42:43] op_sel_hi:[1,0,0] neg_lo:[1,0,0] neg_hi:[1,0,0]
    v_pk_fma_f32 v[88:89], v[68:69], s[56:57], v[40:41] op_sel_hi:[1,0,0] neg_lo:[0,0,1] neg_hi:[0,0,1]
    v_pk_fma_f32 v[68:69], v[68:69], s[56:57], v[42:43] op_sel_hi:[1,0,0] neg_lo:[1,0,0] neg_hi:[1,0,0]
    v_pk_fma_f32 v[90:91], v[70:71], s[56:57], v[40:41] op_sel_hi:[1,0,0] neg_lo:[0,0,1] neg_hi:[0,0,1]
    v_pk_fma_f32 v[70:71], v[70:71], s[56:57], v[42:43] op_sel_hi:[1,0,0] neg_lo:[1,0,0] neg_hi:[1,0,0]
    v_pk_fma_f32 v[92:93], v[72:73], s[56:57], v[40:41] op_sel_hi:[1,0,0] neg_lo:[0,0,1] neg_hi:[0,0,1]
    v_pk_fma_f32 v[72:73], v[72:73], s[56:57], v[42:43] op_sel_hi:[1,0,0] neg_lo:[1,0,0] neg_hi:[1,0,0]
    v_pk_fma_f32 v[94:95], v[74:75], s[56:57], v[40:41] op_sel_hi:[1,0,0] neg_lo:[0,0,1] neg_hi:[0,0,1]
    v_pk_fma_f32 v[74:75], v[74:75], s[56:57], v[42:43] op_sel_hi:[1,0,0] neg_lo:[1,0,0] neg_hi:[1,0,0]
    v_pk_fma_f32 v[96:97], v[76:77], s[56:57], v[40:41] op_sel_hi:[1,0,0] neg_lo:[0,0,1] neg_hi:[0,0,1]
    v_pk_fma_f32 v[76:77], v[76:77], s[56:57], v[42:43] op_sel_hi:[1,0,0] neg_lo:[1,0,0] neg_hi:[1,0,0]
    v_pk_fma_f32 v[98:99], v[78:79], s[56:57], v[40:41] op_sel_hi:[1,0,0] neg_lo:[0,0,1] neg_hi:[0,0,1]
    v_pk_fma_f32 v[78:79], v[78:79], s[56:57], v[42:43] op_sel_hi:[1,0,0] neg_lo:[1,0,0] neg_hi:[1,0,0]
    v_pk_fma_f32 v[100:101], v[80:81], s[56:57], v[40:41] op_sel_hi:[1,0,0] neg_lo:[0,0,1] neg_hi:[0,0,1]
    v_pk_fma_f32 v[80:81], v[80:81], s[56:57], v[42:43] op_sel_hi:[1,0,0] neg_lo:[1,0,0] neg_hi:[1,0,0]
    v_pk_fma_f32 v[102:103], v[82:83], s[56:57], v[40:41] op_sel_hi:[1,0,0] neg_lo:[0,0,1] neg_hi:[0,0,1]
    v_pk_fma_f32 v[82:83], v[82:83], s[56:57], v[42:43] op_sel_hi:[1,0,0] neg_lo:[1,0,0] neg_hi:[1,0,0]
    v_exp_f32 v84, v84
    v_exp_f32 v64, v64
    v_exp_f32 v85, v85
    v_exp_f32 v65, v65
    v_exp_f32 v86, v86
    v_exp_f32 v66, v66
    v_exp_f32 v87, v87
    v_exp_f32 v67, v67
    v_exp_f32 v88, v88
    v_exp_f32 v68, v68
    v_exp_f32 v89, v89
    v_exp_f32 v69, v69
    v_exp_f32 v90, v90
    v_exp_f32 v70, v70
    v_exp_f32 v91, v91
    v_exp_f32 v71, v71
    v_exp_f32 v92, v92
    v_exp_f32 v72, v72
    v_exp_f32 v93, v93
    v_exp_f32 v73, v73
    v_exp_f32 v94, v94
    v_exp_f32 v74, v74
    v_exp_f32 v95, v95
    v_exp_f32 v75, v75
    v_exp_f32 v96, v96
    v_exp_f32 v76, v76
    v_exp_f32 v97, v97
    v_exp_f32 v77, v77
    v_exp_f32 v98, v98
    v_exp_f32 v78, v78
    v_exp_f32 v99, v99
    v_exp_f32 v79, v79
    v_exp_f32 v100, v100
    v_exp_f32 v80, v80
    v_exp_f32 v101, v101
    v_exp_f32 v81, v81
    v_exp_f32 v102, v102
    v_exp_f32 v82, v82
    v_exp_f32 v103, v103
    v_exp_f32 v83, v83
    v_pk_add_f32 v[44:45], v[84:85], v[86:87]
    v_pk_add_f32 v[46:47], v[64:65], v[66:67]
    v_pk_add_f32 v[44:45], v[44:45], v[88:89]
    v_pk_add_f32 v[46:47], v[46:47], v[68:69]
    v_pk_add_f32 v[44:45], v[44:45], v[90:91]
    v_pk_add_f32 v[46:47], v[46:47], v[70:71]
    v_pk_add_f32 v[44:45], v[44:45], v[92:93]
    v_pk_add_f32 v[46:47], v[46:47], v[72:73]
    v_pk_add_f32 v[44:45], v[44:45], v[94:95]
    v_pk_add_f32 v[46:47], v[46:47], v[74:75]
    v_pk_add_f32 v[44:45], v[44:45], v[96:97]
    v_pk_add_f32 v[46:47], v[46:47], v[76:77]
    v_pk_add_f32 v[44:45], v[44:45], v[98:99]
    v_pk_add_f32 v[46:47], v[46:47], v[78:79]
    v_pk_add_f32 v[44:45], v[44:45], v[100:101]
    v_pk_add_f32 v[46:47], v[46:47], v[80:81]
    v_pk_add_f32 v[44:45], v[44:45], v[102:103]
    v_pk_add_f32 v[46:47], v[46:47], v[82:83]
    v_add_f32 v44, v44, v45
    v_add_f32 v46, v46, v47
    v_rcp_f32 v44, v44
    v_rcp_f32 v46, v46
    v_pk_mul_f32 v[84:85], v[84:85], v[44:45] op_sel_hi:[1,0]
    v_pk_mul_f32 v[64:65], v[64:65], v[46:47] op_sel_hi:[1,0]
    v_pk_mul_f32 v[86:87], v[86:87], v[44:45] op_sel_hi:[1,0]
    v_pk_mul_f32 v[66:67], v[66:67], v[46:47] op_sel_hi:[1,0]
    v_pk_mul_f32 v[88:89], v[88:89], v[44:45] op_sel_hi:[1,0]
    v_pk_mul_f32 v[68:69], v[68:69], v[46:47] op_sel_hi:[1,0]
    v_pk_mul_f32 v[90:91], v[90:91], v[44:45] op_sel_hi:[1,0]
    v_pk_mul_f32 v[70:71], v[70:71], v[46:47] op_sel_hi:[1,0]
    v_pk_mul_f32 v[92:93], v[92:93], v[44:45] op_sel_hi:[1,0]
    v_pk_mul_f32 v[72:73], v[72:73], v[46:47] op_sel_hi:[1,0]
    v_pk_mul_f32 v[94:95], v[94:95], v[44:45] op_sel_hi:[1,0]
    v_pk_mul_f32 v[74:75], v[74:75], v[46:47] op_sel_hi:[1,0]
    v_pk_mul_f32 v[96:97], v[96:97], v[44:45] op_sel_hi:[1,0]
    v_pk_mul_f32 v[76:77], v[76:77], v[46:47] op_sel_hi:[1,0]
    v_pk_mul_f32 v[98:99], v[98:99], v[44:45] op_sel_hi:[1,0]
    v_pk_mul_f32 v[78:79], v[78:79], v[46:47] op_sel_hi:[1,0]
    v_pk_mul_f32 v[100:101], v[100:101], v[44:45] op_sel_hi:[1,0]
    v_pk_mul_f32 v[80:81], v[80:81], v[46:47] op_sel_hi:[1,0]
    v_pk_mul_f32 v[102:103], v[102:103], v[44:45] op_sel_hi:[1,0]
    v_pk_mul_f32 v[82:83], v[82:83], v[46:47] op_sel_hi:[1,0]
    v_cvt_pk_bf16_f32 v104, v84, v85
    v_cvt_pk_bf16_f32 v114, v64, v65
    v_cvt_pk_bf16_f32 v105, v86, v87
    v_cvt_pk_bf16_f32 v115, v66, v67
    v_cvt_pk_bf16_f32 v106, v88, v89
    v_cvt_pk_bf16_f32 v116, v68, v69
    v_cvt_pk_bf16_f32 v107, v90, v91
    v_cvt_pk_bf16_f32 v117, v70, v71
    v_cvt_pk_bf16_f32 v108, v92, v93
    v_cvt_pk_bf16_f32 v118, v72, v73
    v_cvt_pk_bf16_f32 v109, v94, v95
    v_cvt_pk_bf16_f32 v119, v74, v75
    v_cvt_pk_bf16_f32 v110, v96, v97
    v_cvt_pk_bf16_f32 v120, v76, v77
    v_cvt_pk_bf16_f32 v111, v98, v99
    v_cvt_pk_bf16_f32 v121, v78, v79
    v_cvt_pk_bf16_f32 v112, v100, v101
    v_cvt_pk_bf16_f32 v122, v80, v81
    v_cvt_pk_bf16_f32 v113, v102, v103
    v_cvt_pk_bf16_f32 v123, v82, v83
    s_cmp_eq_u32 s63, 0
    s_cbranch_scc0 P2_PLE
    v_mov_b32 v208, v220
    v_mov_b32 v209, v221
    v_mov_b32 v210, v222
    v_mov_b32 v211, v223
    v_mov_b32 v212, v224
    v_mov_b32 v213, v225
    v_mov_b32 v214, v226
    v_mov_b32 v215, v227
    v_mov_b32 v216, v228
    v_mov_b32 v217, v229
    v_mov_b32 v218, v230
    v_mov_b32 v219, v231
    v_mov_b32 v232, v104
    v_mov_b32 v233, v105
    v_mov_b32 v234, v106
    v_mov_b32 v235, v107
    v_mov_b32 v236, v108
    v_mov_b32 v237, v109
    v_mov_b32 v238, v110
    v_mov_b32 v239, v111
    v_mov_b32 v240, v112
    v_mov_b32 v241, v113
    v_mov_b32 v242, v114
    v_mov_b32 v243, v115
    v_mov_b32 v244, v116
    v_mov_b32 v245, v117
    v_mov_b32 v246, v118
    v_mov_b32 v247, v119
    v_mov_b32 v248, v120
    v_mov_b32 v249, v121
    v_mov_b32 v250, v122
    v_mov_b32 v251, v123
    s_mov_b32 s63, 1
    s_branch P2_PL
P2_PLE:
    s_lshl_b32 s57, s70, 7
    s_add_u32 s57, s57, 16279552
    v_mov_b32 v24, s57
    v_lshlrev_b32 v25, 9, v3
    v_lshl_add_u32 v20, v2, 4, v25
    s_mul_i32 s62, s70, 15360
    s_add_u32 s62, s62, 15876096
    v_add_u32 v25, 14336, v20
    v_cmp_gt_u32 vcc, 15360, v25
    s_nop 1
    v_cndmask_b32 v21, v23, v20, vcc
    s_mov_b32 s68, 0
P2_SK:
    buffer_load_dword v25, v24, s[32:35], 0 offen sc0 sc1
    s_waitcnt vmcnt(0)
    v_readfirstlane_b32 s57, v25
    s_nop 0
    s_cmp_ge_u32 s57, 16
    s_cbranch_scc1 P2_SK_D
    s_add_u32 s68, s68, 1
    s_cmp_ge_u32 s68, 100000
    s_cbranch_scc1 P2_SK_D
    s_sleep 12
    s_branch P2_SK
P2_SK_D:
    buffer_load_dwordx4 v[144:147], v20, s[32:35], s62 offen sc0 sc1
    buffer_load_dwordx4 v[148:151], v20, s[32:35], s62 offen offset:256 sc0 sc1
    s_add_u32 s62, s62, 2048
    buffer_load_dwordx4 v[152:155], v20, s[32:35], s62 offen sc0 sc1
    buffer_load_dwordx4 v[156:159], v20, s[32:35], s62 offen offset:256 sc0 sc1
    s_add_u32 s62, s62, 2048
    buffer_load_dwordx4 v[160:163], v20, s[32:35], s62 offen sc0 sc1
    buffer_load_dwordx4 v[164:167], v20, s[32:35], s62 offen offset:256 sc0 sc1
    s_add_u32 s62, s62, 2048
    buffer_load_dwordx4 v[168:171], v20, s[32:35], s62 offen sc0 sc1
    buffer_load_dwordx4 v[172:175], v20, s[32:35], s62 offen offset:256 sc0 sc1
    s_add_u32 s62, s62, 2048
    buffer_load_dwordx4 v[176:179], v20, s[32:35], s62 offen sc0 sc1
    buffer_load_dwordx4 v[180:183], v20, s[32:35], s62 offen offset:256 sc0 sc1
    s_add_u32 s62, s62, 2048
    buffer_load_dwordx4 v[184:187], v20, s[32:35], s62 offen sc0 sc1
    buffer_load_dwordx4 v[188:191], v20, s[32:35], s62 offen offset:256 sc0 sc1
    s_add_u32 s62, s62, 2048
    buffer_load_dwordx4 v[192:195], v20, s[32:35], s62 offen sc0 sc1
    buffer_load_dwordx4 v[196:199], v20, s[32:35], s62 offen offset:256 sc0 sc1
    s_add_u32 s62, s62, 2048
    buffer_load_dwordx4 v[200:203], v21, s[32:35], s62 offen sc0 sc1
    buffer_load_dwordx4 v[204:207], v21, s[32:35], s62 offen offset:256 sc0 sc1
    s_add_u32 s62, s62, 2048
    s_waitcnt vmcnt(0)
    v_cvt_pk_bf16_f32 v144, v144, v145
    v_cvt_pk_bf16_f32 v145, v146, v147
    v_cvt_pk_bf16_f32 v146, v148, v149
    v_cvt_pk_bf16_f32 v147, v150, v151
    ds_write_b128 v16, v[144:147] offset:4096
    v_cvt_pk_bf16_f32 v152, v152, v153
    v_cvt_pk_bf16_f32 v153, v154, v155
    v_cvt_pk_bf16_f32 v154, v156, v157
    v_cvt_pk_bf16_f32 v155, v158, v159
    ds_write_b128 v16, v[152:155] offset:5120
    v_cvt_pk_bf16_f32 v160, v160, v161
    v_cvt_pk_bf16_f32 v161, v162, v163
    v_cvt_pk_bf16_f32 v162, v164, v165
    v_cvt_pk_bf16_f32 v163, v166, v167
    ds_write_b128 v16, v[160:163] offset:6144
    v_cvt_pk_bf16_f32 v168, v168, v169
    v_cvt_pk_bf16_f32 v169, v170, v171
    v_cvt_pk_bf16_f32 v170, v172, v173
    v_cvt_pk_bf16_f32 v171, v174, v175
    ds_write_b128 v16, v[168:171] offset:7168
    v_cvt_pk_bf16_f32 v176, v176, v177
    v_cvt_pk_bf16_f32 v177, v178, v179
    v_cvt_pk_bf16_f32 v178, v180, v181
    v_cvt_pk_bf16_f32 v179, v182, v183
    ds_write_b128 v16, v[176:179] offset:8192
    v_cvt_pk_bf16_f32 v184, v184, v185
    v_cvt_pk_bf16_f32 v185, v186, v187
    v_cvt_pk_bf16_f32 v186, v188, v189
    v_cvt_pk_bf16_f32 v187, v190, v191
    ds_write_b128 v16, v[184:187] offset:9216
    v_cvt_pk_bf16_f32 v192, v192, v193
    v_cvt_pk_bf16_f32 v193, v194, v195
    v_cvt_pk_bf16_f32 v194, v196, v197
    v_cvt_pk_bf16_f32 v195, v198, v199
    ds_write_b128 v16, v[192:195] offset:10240
    v_cvt_pk_bf16_f32 v200, v200, v201
    v_cvt_pk_bf16_f32 v201, v202, v203
    v_cvt_pk_bf16_f32 v202, v204, v205
    v_cvt_pk_bf16_f32 v203, v206, v207
    ds_write_b128 v16, v[200:203] offset:11264
    s_waitcnt lgkmcnt(0)
    ds_read_b128 v[168:171], v17 offset:0
    ds_read_b128 v[172:175], v17 offset:256
    ds_read_b128 v[176:179], v17 offset:512
    ds_read_b128 v[180:183], v17 offset:768
    ds_read_b128 v[184:187], v17 offset:1024
    ds_read_b128 v[188:191], v17 offset:1280
    ds_read_b128 v[192:195], v17 offset:1536
    ds_read_b128 v[196:199], v17 offset:1792
    ds_read_b128 v[200:203], v17 offset:2048
    ds_read_b128 v[204:207], v17 offset:2304
    s_waitcnt lgkmcnt(5)
    v_mfma_f32_16x16x32_bf16 v[64:67], v[168:171], v[232:235], 0
    v_mfma_f32_16x16x32_bf16 v[128:131], v[168:171], v[104:107], 0
    v_mfma_f32_16x16x32_bf16 v[64:67], v[172:175], v[236:239], v[64:67]
    v_mfma_f32_16x16x32_bf16 v[128:131], v[172:175], v[108:111], v[128:131]
    v_mfma_f32_16x16x32_bf16 v[64:67], v[176:179], v[240:243], v[64:67]
    v_mfma_f32_16x16x32_bf16 v[128:131], v[176:179], v[112:115], v[128:131]
    v_mfma_f32_16x16x32_bf16 v[64:67], v[180:183], v[244:247], v[64:67]
    v_mfma_f32_16x16x32_bf16 v[128:131], v[180:183], v[116:119], v[128:131]
    v_mfma_f32_16x16x32_bf16 v[64:67], v[184:187], v[248:251], v[64:67]
    v_mfma_f32_16x16x32_bf16 v[128:131], v[184:187], v[120:123], v[128:131]
    ds_read_b128 v[168:171], v17 offset:2560
    ds_read_b128 v[172:175], v17 offset:2816
    ds_read_b128 v[176:179], v17 offset:3072
    ds_read_b128 v[180:183], v17 offset:3328
    ds_read_b128 v[184:187], v17 offset:3584
    s_waitcnt lgkmcnt(5)
    v_mfma_f32_16x16x32_bf16 v[68:71], v[188:191], v[232:235], 0
    v_mfma_f32_16x16x32_bf16 v[132:135], v[188:191], v[104:107], 0
    v_mfma_f32_16x16x32_bf16 v[68:71], v[192:195], v[236:239], v[68:71]
    v_mfma_f32_16x16x32_bf16 v[132:135], v[192:195], v[108:111], v[132:135]
    v_mfma_f32_16x16x32_bf16 v[68:71], v[196:199], v[240:243], v[68:71]
    v_mfma_f32_16x16x32_bf16 v[132:135], v[196:199], v[112:115], v[132:135]
    v_mfma_f32_16x16x32_bf16 v[68:71], v[200:203], v[244:247], v[68:71]
    v_mfma_f32_16x16x32_bf16 v[132:135], v[200:203], v[116:119], v[132:135]
    v_mfma_f32_16x16x32_bf16 v[68:71], v[204:207], v[248:251], v[68:71]
    v_mfma_f32_16x16x32_bf16 v[132:135], v[204:207], v[120:123], v[132:135]
    ds_read_b128 v[188:191], v17 offset:3840
    ds_read_b128 v[192:195], v17 offset:4096
    ds_read_b128 v[196:199], v17 offset:4352
    ds_read_b128 v[200:203], v17 offset:4608
    ds_read_b128 v[204:207], v17 offset:4864
    s_waitcnt lgkmcnt(5)
    v_mfma_f32_16x16x32_bf16 v[72:75], v[168:171], v[232:235], 0
    v_mfma_f32_16x16x32_bf16 v[136:139], v[168:171], v[104:107], 0
    v_mfma_f32_16x16x32_bf16 v[72:75], v[172:175], v[236:239], v[72:75]
    v_mfma_f32_16x16x32_bf16 v[136:139], v[172:175], v[108:111], v[136:139]
    v_mfma_f32_16x16x32_bf16 v[72:75], v[176:179], v[240:243], v[72:75]
    v_mfma_f32_16x16x32_bf16 v[136:139], v[176:179], v[112:115], v[136:139]
    v_mfma_f32_16x16x32_bf16 v[72:75], v[180:183], v[244:247], v[72:75]
    v_mfma_f32_16x16x32_bf16 v[136:139], v[180:183], v[116:119], v[136:139]
    v_mfma_f32_16x16x32_bf16 v[72:75], v[184:187], v[248:251], v[72:75]
    v_mfma_f32_16x16x32_bf16 v[136:139], v[184:187], v[120:123], v[136:139]
    ds_read_b128 v[168:171], v17 offset:5120
    ds_read_b128 v[172:175], v17 offset:5376
    ds_read_b128 v[176:179], v17 offset:5632
    ds_read_b128 v[180:183], v17 offset:5888
    ds_read_b128 v[184:187], v17 offset:6144
    s_waitcnt lgkmcnt(5)
    v_mfma_f32_16x16x32_bf16 v[76:79], v[188:191], v[232:235], 0
    v_mfma_f32_16x16x32_bf16 v[140:143], v[188:191], v[104:107], 0
    v_mfma_f32_16x16x32_bf16 v[76:79], v[192:195], v[236:239], v[76:79]
    v_mfma_f32_16x16x32_bf16 v[140:143], v[192:195], v[108:111], v[140:143]
    v_mfma_f32_16x16x32_bf16 v[76:79], v[196:199], v[240:243], v[76:79]
    v_mfma_f32_16x16x32_bf16 v[140:143], v[196:199], v[112:115], v[140:143]
    v_mfma_f32_16x16x32_bf16 v[76:79], v[200:203], v[244:247], v[76:79]
    v_mfma_f32_16x16x32_bf16 v[140:143], v[200:203], v[116:119], v[140:143]
    v_mfma_f32_16x16x32_bf16 v[76:79], v[204:207], v[248:251], v[76:79]
    v_mfma_f32_16x16x32_bf16 v[140:143], v[204:207], v[120:123], v[140:143]
    ds_read_b128 v[188:191], v17 offset:6400
    ds_read_b128 v[192:195], v17 offset:6656
    ds_read_b128 v[196:199], v17 offset:6912
    ds_read_b128 v[200:203], v17 offset:7168
    ds_read_b128 v[204:207], v17 offset:7424
    s_waitcnt lgkmcnt(5)
    v_mfma_f32_16x16x32_bf16 v[80:83], v[168:171], v[232:235], 0
    v_mfma_f32_16x16x32_bf16 v[144:147], v[168:171], v[104:107], 0
    v_mfma_f32_16x16x32_bf16 v[80:83], v[172:175], v[236:239], v[80:83]
    v_mfma_f32_16x16x32_bf16 v[144:147], v[172:175], v[108:111], v[144:147]
    v_mfma_f32_16x16x32_bf16 v[80:83], v[176:179], v[240:243], v[80:83]
    v_mfma_f32_16x16x32_bf16 v[144:147], v[176:179], v[112:115], v[144:147]
    v_mfma_f32_16x16x32_bf16 v[80:83], v[180:183], v[244:247], v[80:83]
    v_mfma_f32_16x16x32_bf16 v[144:147], v[180:183], v[116:119], v[144:147]
    v_mfma_f32_16x16x32_bf16 v[80:83], v[184:187], v[248:251], v[80:83]
    v_mfma_f32_16x16x32_bf16 v[144:147], v[184:187], v[120:123], v[144:147]
    s_waitcnt lgkmcnt(0)
    v_mfma_f32_16x16x32_bf16 v[84:87], v[188:191], v[232:235], 0
    v_mfma_f32_16x16x32_bf16 v[148:151], v[188:191], v[104:107], 0
    v_mfma_f32_16x16x32_bf16 v[84:87], v[192:195], v[236:239], v[84:87]
    v_mfma_f32_16x16x32_bf16 v[148:151], v[192:195], v[108:111], v[148:151]
    v_mfma_f32_16x16x32_bf16 v[84:87], v[196:199], v[240:243], v[84:87]
    v_mfma_f32_16x16x32_bf16 v[148:151], v[196:199], v[112:115], v[148:151]
    v_mfma_f32_16x16x32_bf16 v[84:87], v[200:203], v[244:247], v[84:87]
    v_mfma_f32_16x16x32_bf16 v[148:151], v[200:203], v[116:119], v[148:151]
    v_mfma_f32_16x16x32_bf16 v[84:87], v[204:207], v[248:251], v[84:87]
    v_mfma_f32_16x16x32_bf16 v[148:151], v[204:207], v[120:123], v[148:151]
    s_nop 6
    v_add_f32 v84, 0x358637bd, v84
    v_rcp_f32 v84, v84
    s_nop 0
    v_pk_mul_f32 v[64:65], v[64:65], v[84:85] op_sel_hi:[1,0]
    v_pk_mul_f32 v[66:67], v[66:67], v[84:85] op_sel_hi:[1,0]
    v_pk_mul_f32 v[68:69], v[68:69], v[84:85] op_sel_hi:[1,0]
    v_pk_mul_f32 v[70:71], v[70:71], v[84:85] op_sel_hi:[1,0]
    v_pk_mul_f32 v[72:73], v[72:73], v[84:85] op_sel_hi:[1,0]
    v_pk_mul_f32 v[74:75], v[74:75], v[84:85] op_sel_hi:[1,0]
    v_pk_mul_f32 v[76:77], v[76:77], v[84:85] op_sel_hi:[1,0]
    v_pk_mul_f32 v[78:79], v[78:79], v[84:85] op_sel_hi:[1,0]
    v_pk_mul_f32 v[80:81], v[80:81], v[84:85] op_sel_hi:[1,0]
    v_pk_mul_f32 v[82:83], v[82:83], v[84:85] op_sel_hi:[1,0]
    v_cvt_pk_bf16_f32 v152, v64, v65
    v_cvt_pk_bf16_f32 v153, v66, v67
    v_cvt_pk_bf16_f32 v154, v68, v69
    v_cvt_pk_bf16_f32 v155, v70, v71
    v_cvt_pk_bf16_f32 v156, v72, v73
    v_cvt_pk_bf16_f32 v157, v74, v75
    v_cvt_pk_bf16_f32 v158, v76, v77
    v_cvt_pk_bf16_f32 v159, v78, v79
    v_cvt_pk_bf16_f32 v160, v80, v81
    v_cvt_pk_bf16_f32 v161, v82, v83
    v_add_f32 v148, 0x358637bd, v148
    v_rcp_f32 v148, v148
    s_nop 0
    v_pk_mul_f32 v[128:129], v[128:129], v[148:149] op_sel_hi:[1,0]
    v_pk_mul_f32 v[130:131], v[130:131], v[148:149] op_sel_hi:[1,0]
    v_pk_mul_f32 v[132:133], v[132:133], v[148:149] op_sel_hi:[1,0]
    v_pk_mul_f32 v[134:135], v[134:135], v[148:149] op_sel_hi:[1,0]
    v_pk_mul_f32 v[136:137], v[136:137], v[148:149] op_sel_hi:[1,0]
    v_pk_mul_f32 v[138:139], v[138:139], v[148:149] op_sel_hi:[1,0]
    v_pk_mul_f32 v[140:141], v[140:141], v[148:149] op_sel_hi:[1,0]
    v_pk_mul_f32 v[142:143], v[142:143], v[148:149] op_sel_hi:[1,0]
    v_pk_mul_f32 v[144:145], v[144:145], v[148:149] op_sel_hi:[1,0]
    v_pk_mul_f32 v[146:147], v[146:147], v[148:149] op_sel_hi:[1,0]
    v_cvt_pk_bf16_f32 v208, v128, v129
    v_cvt_pk_bf16_f32 v209, v130, v131
    v_cvt_pk_bf16_f32 v210, v132, v133
    v_cvt_pk_bf16_f32 v211, v134, v135
    v_cvt_pk_bf16_f32 v212, v136, v137
    v_cvt_pk_bf16_f32 v213, v138, v139
    v_cvt_pk_bf16_f32 v214, v140, v141
    v_cvt_pk_bf16_f32 v215, v142, v143
    v_cvt_pk_bf16_f32 v216, v144, v145
    v_cvt_pk_bf16_f32 v217, v146, v147
    s_and_b32 s67, s70, 1
    s_cmp_eq_u32 s67, 0
    s_cbranch_scc0 P2_OODD
    buffer_store_dwordx4 v[152:155], v5, s[32:35], s65 offen sc0 sc1
    buffer_store_dwordx4 v[156:159], v5, s[32:35], s65 offen offset:1024 sc0 sc1
    buffer_store_dwordx2 v[160:161], v5, s[32:35], s65 offen offset:2048 sc0 sc1
    s_add_u32 s65, s65, 20480
    buffer_store_dwordx4 v[208:211], v5, s[32:35], s65 offen sc0 sc1
    buffer_store_dwordx4 v[212:215], v5, s[32:35], s65 offen offset:1024 sc0 sc1
    buffer_store_dwordx2 v[216:217], v5, s[32:35], s65 offen offset:2048 sc0 sc1
    s_add_u32 s65, s65, 20480
    s_branch P2_OST
P2_OODD:
    buffer_store_dwordx2 v[152:153], v5, s[32:35], s65 offen offset:2056 sc0 sc1
    buffer_store_dwordx4 v[154:157], v5, s[32:35], s65 offen offset:3072 sc0 sc1
    s_add_u32 s67, s65, 4096
    buffer_store_dwordx4 v[158:161], v5, s[32:35], s67 offen sc0 sc1
    s_add_u32 s65, s65, 20480
    buffer_store_dwordx2 v[208:209], v5, s[32:35], s65 offen offset:2056 sc0 sc1
    buffer_store_dwordx4 v[210:213], v5, s[32:35], s65 offen offset:3072 sc0 sc1
    s_add_u32 s67, s65, 4096
    buffer_store_dwordx4 v[214:217], v5, s[32:35], s67 offen sc0 sc1
    s_add_u32 s65, s65, 20480
P2_OST:
    s_waitcnt vmcnt(0)
    v_mov_b32 v25, 1
    s_mov_b64 exec, 1
    buffer_atomic_add v25, v18, s[32:35], 0 offen
    s_mov_b64 exec, -1
P2_OSKIP:
    v_mov_b32 v24, v18
    s_mul_i32 s55, s51, 81920
    s_add_u32 s56, s55, 10223616
    v_add_u32 v6, s56, v5
    s_add_u32 s56, s55, 10244096
    v_add_u32 v7, s56, v5
    s_add_u32 s56, s55, 10264576
    v_add_u32 v8, s56, v5
    s_add_u32 s56, s55, 10285056
    v_add_u32 v9, s56, v5
    s_sub_u32 s53, s48, 4
    s_mul_i32 s53, s53, 5
    s_lshl_b32 s60, s53, 10
    s_add_u32 s53, s53, 54
    s_mul_i32 s61, s53, 40960
    s_mov_b32 s62, 0
    s_lshr_b32 s57, s51, 1
    s_lshl_b32 s57, s57, 7
    s_add_u32 s57, s57, 16277508
    v_mov_b32 v26, s57
    s_mov_b32 s68, 0
P2_SW:
    buffer_load_dword v27, v26, s[32:35], 0 offen sc0 sc1
    s_waitcnt vmcnt(0)
    v_readfirstlane_b32 s58, v27
    s_nop 0
    s_cmp_ge_u32 s58, 80
    s_cbranch_scc1 P2_SW_D
    s_add_u32 s68, s68, 1
    s_cmp_ge_u32 s68, 100000
    s_cbranch_scc1 P2_SW_D
    s_sleep 12
    s_branch P2_SW
P2_SW_D:
    buffer_load_dwordx4 v[144:147], v10, s[32:35], s61 offen offset:0 sc1
    buffer_load_dwordx4 v[148:151], v10, s[32:35], s61 offen offset:1024 sc1
    buffer_load_dwordx4 v[152:155], v10, s[32:35], s61 offen offset:2048 sc1
    buffer_load_dwordx4 v[156:159], v10, s[32:35], s61 offen offset:3072 sc1
    buffer_load_dwordx4 v[160:163], v11, s[32:35], s61 offen sc1
    s_add_u32 s61, s61, 40960
    buffer_load_dwordx4 v[164:167], v10, s[32:35], s61 offen offset:0 sc1
    buffer_load_dwordx4 v[168:171], v10, s[32:35], s61 offen offset:1024 sc1
    buffer_load_dwordx4 v[172:175], v10, s[32:35], s61 offen offset:2048 sc1
    buffer_load_dwordx4 v[176:179], v10, s[32:35], s61 offen offset:3072 sc1
    buffer_load_dwordx4 v[180:183], v11, s[32:35], s61 offen sc1
    s_add_u32 s61, s61, 40960
    buffer_load_dwordx4 v[184:187], v10, s[32:35], s61 offen offset:0 sc1
    buffer_load_dwordx4 v[188:191], v10, s[32:35], s61 offen offset:1024 sc1
    buffer_load_dwordx4 v[192:195], v10, s[32:35], s61 offen offset:2048 sc1
    buffer_load_dwordx4 v[196:199], v10, s[32:35], s61 offen offset:3072 sc1
    buffer_load_dwordx4 v[200:203], v11, s[32:35], s61 offen sc1
    s_add_u32 s61, s61, 40960
    buffer_load_dwordx4 v[204:207], v10, s[32:35], s61 offen offset:0 sc1
    buffer_load_dwordx4 v[208:211], v10, s[32:35], s61 offen offset:1024 sc1
    buffer_load_dwordx4 v[212:215], v10, s[32:35], s61 offen offset:2048 sc1
    buffer_load_dwordx4 v[216:219], v10, s[32:35], s61 offen offset:3072 sc1
    buffer_load_dwordx4 v[220:223], v11, s[32:35], s61 offen sc1
    s_add_u32 s61, s61, 40960
    buffer_load_dwordx4 v[224:227], v10, s[32:35], s61 offen offset:0 sc1
    buffer_load_dwordx4 v[228:231], v10, s[32:35], s61 offen offset:1024 sc1
    buffer_load_dwordx4 v[232:235], v10, s[32:35], s61 offen offset:2048 sc1
    buffer_load_dwordx4 v[236:239], v10, s[32:35], s61 offen offset:3072 sc1
    buffer_load_dwordx4 v[240:243], v11, s[32:35], s61 offen sc1
    s_add_u32 s61, s61, 40960
    s_cmp_eq_u32 s48, 4
    s_cbranch_scc0 P2_LO
    s_mov_b32 s68, 0
P2_SO:
    buffer_load_dword v25, v24, s[32:35], 0 offen sc0 sc1
    s_waitcnt vmcnt(0)
    v_readfirstlane_b32 s57, v25
    s_nop 0
    s_cmp_ge_u32 s57, 16
    s_cbranch_scc1 P2_SO_D
    s_add_u32 s68, s68, 1
    s_cmp_ge_u32 s68, 100000
    s_cbranch_scc1 P2_SO_D
    s_sleep 12
    s_branch P2_SO
P2_SO_D:
    v_mov_b32 v63, 1
    ds_write_b32 v62, v63
    s_branch P2_LOE
P2_LO:
    s_mov_b32 s68, 0
P2_LOS:
    ds_read_b32 v63, v62
    s_waitcnt lgkmcnt(0)
    v_readfirstlane_b32 s57, v63
    s_nop 0
    s_cmp_lg_u32 s57, 0
    s_cbranch_scc1 P2_LOS_D
    s_add_u32 s68, s68, 1
    s_cmp_ge_u32 s68, 3000000
    s_cbranch_scc1 P2_LOS_D
    s_sleep 1
    s_branch P2_LOS
P2_LOS_D:
    s_waitcnt vmcnt(0)
P2_LOE:
P2_GEMM:
    s_cmp_ge_u32 s48, 4
    s_cbranch_scc1 P2_G5
    buffer_load_dwordx4 v[160:163], v10, s[32:35], s61 offen offset:0 sc1
    buffer_load_dwordx4 v[164:167], v10, s[32:35], s61 offen offset:1024 sc1
    buffer_load_dwordx4 v[168:171], v10, s[32:35], s61 offen offset:2048 sc1
    buffer_load_dwordx4 v[172:175], v10, s[32:35], s61 offen offset:3072 sc1
    buffer_load_dwordx4 v[176:179], v11, s[32:35], s61 offen sc1
    buffer_load_dwordx4 v[144:147], v6, s[32:35], s60 offen sc1
    buffer_load_dwordx4 v[148:151], v7, s[32:35], s60 offen sc1
    buffer_load_dwordx4 v[152:155], v8, s[32:35], s60 offen sc1
    buffer_load_dwordx4 v[156:159], v9, s[32:35], s60 offen sc1
    s_add_u32 s60, s60, 1024
    s_add_u32 s61, s61, 40960
    buffer_load_dwordx4 v[196:199], v10, s[32:35], s61 offen offset:0 sc1
    buffer_load_dwordx4 v[200:203], v10, s[32:35], s61 offen offset:1024 sc1
    buffer_load_dwordx4 v[204:207], v10, s[32:35], s61 offen offset:2048 sc1
    buffer_load_dwordx4 v[208:211], v10, s[32:35], s61 offen offset:3072 sc1
    buffer_load_dwordx4 v[212:215], v11, s[32:35], s61 offen sc1
    buffer_load_dwordx4 v[180:183], v6, s[32:35], s60 offen sc1
    buffer_load_dwordx4 v[184:187], v7, s[32:35], s60 offen sc1
    buffer_load_dwordx4 v[188:191], v8, s[32:35], s60 offen sc1
    buffer_load_dwordx4 v[192:195], v9, s[32:35], s60 offen sc1
    s_add_u32 s60, s60, 1024
    s_add_u32 s61, s61, 40960
    buffer_load_dwordx4 v[232:235], v10, s[32:35], s61 offen offset:0 sc1
    buffer_load_dwordx4 v[236:239], v10, s[32:35], s61 offen offset:1024 sc1
    buffer_load_dwordx4 v[240:243], v10, s[32:35], s61 offen offset:2048 sc1
    buffer_load_dwordx4 v[244:247], v10, s[32:35], s61 offen offset:3072 sc1
    buffer_load_dwordx4 v[248:251], v11, s[32:35], s61 offen sc1
    buffer_load_dwordx4 v[216:219], v6, s[32:35], s60 offen sc1
    buffer_load_dwordx4 v[220:223], v7, s[32:35], s60 offen sc1
    buffer_load_dwordx4 v[224:227], v8, s[32:35], s60 offen sc1
    buffer_load_dwordx4 v[228:231], v9, s[32:35], s60 offen sc1
    s_waitcnt vmcnt(18)
    v_mfma_f32_16x16x32_bf16 v[64:67], v[160:163], v[144:147], 0
    s_add_u32 s60, s60, 1024
    s_add_u32 s61, s61, 40960
    buffer_load_dwordx4 v[44:47], v10, s[32:35], s61 offen offset:0 sc1
    v_mfma_f32_16x16x32_bf16 v[68:71], v[160:163], v[148:151], 0
    v_mfma_f32_16x16x32_bf16 v[72:75], v[160:163], v[152:155], 0
    buffer_load_dwordx4 v[48:51], v10, s[32:35], s61 offen offset:1024 sc1
    v_mfma_f32_16x16x32_bf16 v[76:79], v[160:163], v[156:159], 0
    v_mfma_f32_16x16x32_bf16 v[80:83], v[164:167], v[144:147], 0
    buffer_load_dwordx4 v[52:55], v10, s[32:35], s61 offen offset:2048 sc1
    v_mfma_f32_16x16x32_bf16 v[84:87], v[164:167], v[148:151], 0
    v_mfma_f32_16x16x32_bf16 v[88:91], v[164:167], v[152:155], 0
    buffer_load_dwordx4 v[56:59], v10, s[32:35], s61 offen offset:3072 sc1
    v_mfma_f32_16x16x32_bf16 v[92:95], v[164:167], v[156:159], 0
    v_mfma_f32_16x16x32_bf16 v[96:99], v[168:171], v[144:147], 0
    buffer_load_dwordx4 v[60:63], v11, s[32:35], s61 offen sc1
    v_mfma_f32_16x16x32_bf16 v[100:103], v[168:171], v[148:151], 0
    v_mfma_f32_16x16x32_bf16 v[104:107], v[168:171], v[152:155], 0
    v_mfma_f32_16x16x32_bf16 v[108:111], v[168:171], v[156:159], 0
    buffer_load_dwordx4 v[28:31], v6, s[32:35], s60 offen sc1
    v_mfma_f32_16x16x32_bf16 v[112:115], v[172:175], v[144:147], 0
    v_mfma_f32_16x16x32_bf16 v[116:119], v[172:175], v[148:151], 0
    buffer_load_dwordx4 v[32:35], v7, s[32:35], s60 offen sc1
    v_mfma_f32_16x16x32_bf16 v[120:123], v[172:175], v[152:155], 0
    v_mfma_f32_16x16x32_bf16 v[124:127], v[172:175], v[156:159], 0
    buffer_load_dwordx4 v[36:39], v8, s[32:35], s60 offen sc1
    v_mfma_f32_16x16x32_bf16 v[128:131], v[176:179], v[144:147], 0
    v_mfma_f32_16x16x32_bf16 v[132:135], v[176:179], v[148:151], 0
    buffer_load_dwordx4 v[40:43], v9, s[32:35], s60 offen sc1
    v_mfma_f32_16x16x32_bf16 v[136:139], v[176:179], v[152:155], 0
    v_mfma_f32_16x16x32_bf16 v[140:143], v[176:179], v[156:159], 0
    s_waitcnt vmcnt(18)
    v_mfma_f32_16x16x32_bf16 v[64:67], v[196:199], v[180:183], v[64:67]
    s_add_u32 s60, s60, 1024
    s_add_u32 s61, s61, 40960
    buffer_load_dwordx4 v[160:163], v10, s[32:35], s61 offen offset:0 sc1
    v_mfma_f32_16x16x32_bf16 v[68:71], v[196:199], v[184:187], v[68:71]
    v_mfma_f32_16x16x32_bf16 v[72:75], v[196:199], v[188:191], v[72:75]
    buffer_load_dwordx4 v[164:167], v10, s[32:35], s61 offen offset:1024 sc1
    v_mfma_f32_16x16x32_bf16 v[76:79], v[196:199], v[192:195], v[76:79]
    v_mfma_f32_16x16x32_bf16 v[80:83], v[200:203], v[180:183], v[80:83]
    buffer_load_dwordx4 v[168:171], v10, s[32:35], s61 offen offset:2048 sc1
    v_mfma_f32_16x16x32_bf16 v[84:87], v[200:203], v[184:187], v[84:87]
    v_mfma_f32_16x16x32_bf16 v[88:91], v[200:203], v[188:191], v[88:91]
    buffer_load_dwordx4 v[172:175], v10, s[32:35], s61 offen offset:3072 sc1
    v_mfma_f32_16x16x32_bf16 v[92:95], v[200:203], v[192:195], v[92:95]
    v_mfma_f32_16x16x32_bf16 v[96:99], v[204:207], v[180:183], v[96:99]
    buffer_load_dwordx4 v[176:179], v11, s[32:35], s61 offen sc1
    v_mfma_f32_16x16x32_bf16 v[100:103], v[204:207], v[184:187], v[100:103]
    v_mfma_f32_16x16x32_bf16 v[104:107], v[204:207], v[188:191], v[104:107]
    v_mfma_f32_16x16x32_bf16 v[108:111], v[204:207], v[192:195], v[108:111]
    buffer_load_dwordx4 v[144:147], v6, s[32:35], s60 offen sc1
    v_mfma_f32_16x16x32_bf16 v[112:115], v[208:211], v[180:183], v[112:115]
    v_mfma_f32_16x16x32_bf16 v[116:119], v[208:211], v[184:187], v[116:119]
    buffer_load_dwordx4 v[148:151], v7, s[32:35], s60 offen sc1
    v_mfma_f32_16x16x32_bf16 v[120:123], v[208:211], v[188:191], v[120:123]
    v_mfma_f32_16x16x32_bf16 v[124:127], v[208:211], v[192:195], v[124:127]
    buffer_load_dwordx4 v[152:155], v8, s[32:35], s60 offen sc1
    v_mfma_f32_16x16x32_bf16 v[128:131], v[212:215], v[180:183], v[128:131]
    v_mfma_f32_16x16x32_bf16 v[132:135], v[212:215], v[184:187], v[132:135]
    buffer_load_dwordx4 v[156:159], v9, s[32:35], s60 offen sc1
    v_mfma_f32_16x16x32_bf16 v[136:139], v[212:215], v[188:191], v[136:139]
    v_mfma_f32_16x16x32_bf16 v[140:143], v[212:215], v[192:195], v[140:143]
    s_waitcnt vmcnt(18)
    v_mfma_f32_16x16x32_bf16 v[64:67], v[232:235], v[216:219], v[64:67]
    s_add_u32 s60, s60, 1024
    s_add_u32 s61, s61, 40960
    buffer_load_dwordx4 v[196:199], v10, s[32:35], s61 offen offset:0 sc1
    v_mfma_f32_16x16x32_bf16 v[68:71], v[232:235], v[220:223], v[68:71]
    v_mfma_f32_16x16x32_bf16 v[72:75], v[232:235], v[224:227], v[72:75]
    buffer_load_dwordx4 v[200:203], v10, s[32:35], s61 offen offset:1024 sc1
    v_mfma_f32_16x16x32_bf16 v[76:79], v[232:235], v[228:231], v[76:79]
    v_mfma_f32_16x16x32_bf16 v[80:83], v[236:239], v[216:219], v[80:83]
    buffer_load_dwordx4 v[204:207], v10, s[32:35], s61 offen offset:2048 sc1
    v_mfma_f32_16x16x32_bf16 v[84:87], v[236:239], v[220:223], v[84:87]
    v_mfma_f32_16x16x32_bf16 v[88:91], v[236:239], v[224:227], v[88:91]
    buffer_load_dwordx4 v[208:211], v10, s[32:35], s61 offen offset:3072 sc1
    v_mfma_f32_16x16x32_bf16 v[92:95], v[236:239], v[228:231], v[92:95]
    v_mfma_f32_16x16x32_bf16 v[96:99], v[240:243], v[216:219], v[96:99]
    buffer_load_dwordx4 v[212:215], v11, s[32:35], s61 offen sc1
    v_mfma_f32_16x16x32_bf16 v[100:103], v[240:243], v[220:223], v[100:103]
    v_mfma_f32_16x16x32_bf16 v[104:107], v[240:243], v[224:227], v[104:107]
    v_mfma_f32_16x16x32_bf16 v[108:111], v[240:243], v[228:231], v[108:111]
    buffer_load_dwordx4 v[180:183], v6, s[32:35], s60 offen sc1
    v_mfma_f32_16x16x32_bf16 v[112:115], v[244:247], v[216:219], v[112:115]
    v_mfma_f32_16x16x32_bf16 v[116:119], v[244:247], v[220:223], v[116:119]
    buffer_load_dwordx4 v[184:187], v7, s[32:35], s60 offen sc1
    v_mfma_f32_16x16x32_bf16 v[120:123], v[244:247], v[224:227], v[120:123]
    v_mfma_f32_16x16x32_bf16 v[124:127], v[244:247], v[228:231], v[124:127]
    buffer_load_dwordx4 v[188:191], v8, s[32:35], s60 offen sc1
    v_mfma_f32_16x16x32_bf16 v[128:131], v[248:251], v[216:219], v[128:131]
    v_mfma_f32_16x16x32_bf16 v[132:135], v[248:251], v[220:223], v[132:135]
    buffer_load_dwordx4 v[192:195], v9, s[32:35], s60 offen sc1
    v_mfma_f32_16x16x32_bf16 v[136:139], v[248:251], v[224:227], v[136:139]
    v_mfma_f32_16x16x32_bf16 v[140:143], v[248:251], v[228:231], v[140:143]
    s_waitcnt vmcnt(18)
    v_mfma_f32_16x16x32_bf16 v[64:67], v[44:47], v[28:31], v[64:67]
    s_add_u32 s60, s60, 1024
    s_add_u32 s61, s61, 40960
    buffer_load_dwordx4 v[232:235], v10, s[32:35], s61 offen offset:0 sc1
    v_mfma_f32_16x16x32_bf16 v[68:71], v[44:47], v[32:35], v[68:71]
    v_mfma_f32_16x16x32_bf16 v[72:75], v[44:47], v[36:39], v[72:75]
    buffer_load_dwordx4 v[236:239], v10, s[32:35], s61 offen offset:1024 sc1
    v_mfma_f32_16x16x32_bf16 v[76:79], v[44:47], v[40:43], v[76:79]
    v_mfma_f32_16x16x32_bf16 v[80:83], v[48:51], v[28:31], v[80:83]
    buffer_load_dwordx4 v[240:243], v10, s[32:35], s61 offen offset:2048 sc1
    v_mfma_f32_16x16x32_bf16 v[84:87], v[48:51], v[32:35], v[84:87]
    v_mfma_f32_16x16x32_bf16 v[88:91], v[48:51], v[36:39], v[88:91]
    buffer_load_dwordx4 v[244:247], v10, s[32:35], s61 offen offset:3072 sc1
    v_mfma_f32_16x16x32_bf16 v[92:95], v[48:51], v[40:43], v[92:95]
    v_mfma_f32_16x16x32_bf16 v[96:99], v[52:55], v[28:31], v[96:99]
    buffer_load_dwordx4 v[248:251], v11, s[32:35], s61 offen sc1
    v_mfma_f32_16x16x32_bf16 v[100:103], v[52:55], v[32:35], v[100:103]
    v_mfma_f32_16x16x32_bf16 v[104:107], v[52:55], v[36:39], v[104:107]
    v_mfma_f32_16x16x32_bf16 v[108:111], v[52:55], v[40:43], v[108:111]
    buffer_load_dwordx4 v[216:219], v6, s[32:35], s60 offen sc1
    v_mfma_f32_16x16x32_bf16 v[112:115], v[56:59], v[28:31], v[112:115]
    v_mfma_f32_16x16x32_bf16 v[116:119], v[56:59], v[32:35], v[116:119]
    buffer_load_dwordx4 v[220:223], v7, s[32:35], s60 offen sc1
    v_mfma_f32_16x16x32_bf16 v[120:123], v[56:59], v[36:39], v[120:123]
    v_mfma_f32_16x16x32_bf16 v[124:127], v[56:59], v[40:43], v[124:127]
    buffer_load_dwordx4 v[224:227], v8, s[32:35], s60 offen sc1
    v_mfma_f32_16x16x32_bf16 v[128:131], v[60:63], v[28:31], v[128:131]
    v_mfma_f32_16x16x32_bf16 v[132:135], v[60:63], v[32:35], v[132:135]
    buffer_load_dwordx4 v[228:231], v9, s[32:35], s60 offen sc1
    v_mfma_f32_16x16x32_bf16 v[136:139], v[60:63], v[36:39], v[136:139]
    v_mfma_f32_16x16x32_bf16 v[140:143], v[60:63], v[40:43], v[140:143]
    s_waitcnt vmcnt(18)
    v_mfma_f32_16x16x32_bf16 v[64:67], v[160:163], v[144:147], v[64:67]
    s_add_u32 s60, s60, 1024
    s_add_u32 s61, s61, 40960
    buffer_load_dwordx4 v[44:47], v10, s[32:35], s61 offen offset:0 sc1
    v_mfma_f32_16x16x32_bf16 v[68:71], v[160:163], v[148:151], v[68:71]
    v_mfma_f32_16x16x32_bf16 v[72:75], v[160:163], v[152:155], v[72:75]
    buffer_load_dwordx4 v[48:51], v10, s[32:35], s61 offen offset:1024 sc1
    v_mfma_f32_16x16x32_bf16 v[76:79], v[160:163], v[156:159], v[76:79]
    v_mfma_f32_16x16x32_bf16 v[80:83], v[164:167], v[144:147], v[80:83]
    buffer_load_dwordx4 v[52:55], v10, s[32:35], s61 offen offset:2048 sc1
    v_mfma_f32_16x16x32_bf16 v[84:87], v[164:167], v[148:151], v[84:87]
    v_mfma_f32_16x16x32_bf16 v[88:91], v[164:167], v[152:155], v[88:91]
    buffer_load_dwordx4 v[56:59], v10, s[32:35], s61 offen offset:3072 sc1
    v_mfma_f32_16x16x32_bf16 v[92:95], v[164:167], v[156:159], v[92:95]
    v_mfma_f32_16x16x32_bf16 v[96:99], v[168:171], v[144:147], v[96:99]
    buffer_load_dwordx4 v[60:63], v11, s[32:35], s61 offen sc1
    v_mfma_f32_16x16x32_bf16 v[100:103], v[168:171], v[148:151], v[100:103]
    v_mfma_f32_16x16x32_bf16 v[104:107], v[168:171], v[152:155], v[104:107]
    v_mfma_f32_16x16x32_bf16 v[108:111], v[168:171], v[156:159], v[108:111]
    buffer_load_dwordx4 v[28:31], v6, s[32:35], s60 offen sc1
    v_mfma_f32_16x16x32_bf16 v[112:115], v[172:175], v[144:147], v[112:115]
    v_mfma_f32_16x16x32_bf16 v[116:119], v[172:175], v[148:151], v[116:119]
    buffer_load_dwordx4 v[32:35], v7, s[32:35], s60 offen sc1
    v_mfma_f32_16x16x32_bf16 v[120:123], v[172:175], v[152:155], v[120:123]
    v_mfma_f32_16x16x32_bf16 v[124:127], v[172:175], v[156:159], v[124:127]
    buffer_load_dwordx4 v[36:39], v8, s[32:35], s60 offen sc1
    v_mfma_f32_16x16x32_bf16 v[128:131], v[176:179], v[144:147], v[128:131]
    v_mfma_f32_16x16x32_bf16 v[132:135], v[176:179], v[148:151], v[132:135]
    buffer_load_dwordx4 v[40:43], v9, s[32:35], s60 offen sc1
    v_mfma_f32_16x16x32_bf16 v[136:139], v[176:179], v[152:155], v[136:139]
    v_mfma_f32_16x16x32_bf16 v[140:143], v[176:179], v[156:159], v[140:143]
    s_waitcnt vmcnt(18)
    v_mfma_f32_16x16x32_bf16 v[64:67], v[196:199], v[180:183], v[64:67]
    s_add_u32 s60, s60, 1024
    s_add_u32 s61, s61, 40960
    buffer_load_dwordx4 v[160:163], v10, s[32:35], s61 offen offset:0 sc1
    v_mfma_f32_16x16x32_bf16 v[68:71], v[196:199], v[184:187], v[68:71]
    v_mfma_f32_16x16x32_bf16 v[72:75], v[196:199], v[188:191], v[72:75]
    buffer_load_dwordx4 v[164:167], v10, s[32:35], s61 offen offset:1024 sc1
    v_mfma_f32_16x16x32_bf16 v[76:79], v[196:199], v[192:195], v[76:79]
    v_mfma_f32_16x16x32_bf16 v[80:83], v[200:203], v[180:183], v[80:83]
    buffer_load_dwordx4 v[168:171], v10, s[32:35], s61 offen offset:2048 sc1
    v_mfma_f32_16x16x32_bf16 v[84:87], v[200:203], v[184:187], v[84:87]
    v_mfma_f32_16x16x32_bf16 v[88:91], v[200:203], v[188:191], v[88:91]
    buffer_load_dwordx4 v[172:175], v10, s[32:35], s61 offen offset:3072 sc1
    v_mfma_f32_16x16x32_bf16 v[92:95], v[200:203], v[192:195], v[92:95]
    v_mfma_f32_16x16x32_bf16 v[96:99], v[204:207], v[180:183], v[96:99]
    buffer_load_dwordx4 v[176:179], v11, s[32:35], s61 offen sc1
    v_mfma_f32_16x16x32_bf16 v[100:103], v[204:207], v[184:187], v[100:103]
    v_mfma_f32_16x16x32_bf16 v[104:107], v[204:207], v[188:191], v[104:107]
    v_mfma_f32_16x16x32_bf16 v[108:111], v[204:207], v[192:195], v[108:111]
    buffer_load_dwordx4 v[144:147], v6, s[32:35], s60 offen sc1
    v_mfma_f32_16x16x32_bf16 v[112:115], v[208:211], v[180:183], v[112:115]
    v_mfma_f32_16x16x32_bf16 v[116:119], v[208:211], v[184:187], v[116:119]
    buffer_load_dwordx4 v[148:151], v7, s[32:35], s60 offen sc1
    v_mfma_f32_16x16x32_bf16 v[120:123], v[208:211], v[188:191], v[120:123]
    v_mfma_f32_16x16x32_bf16 v[124:127], v[208:211], v[192:195], v[124:127]
    buffer_load_dwordx4 v[152:155], v8, s[32:35], s60 offen sc1
    v_mfma_f32_16x16x32_bf16 v[128:131], v[212:215], v[180:183], v[128:131]
    v_mfma_f32_16x16x32_bf16 v[132:135], v[212:215], v[184:187], v[132:135]
    buffer_load_dwordx4 v[156:159], v9, s[32:35], s60 offen sc1
    v_mfma_f32_16x16x32_bf16 v[136:139], v[212:215], v[188:191], v[136:139]
    v_mfma_f32_16x16x32_bf16 v[140:143], v[212:215], v[192:195], v[140:143]
    s_waitcnt vmcnt(18)
    v_mfma_f32_16x16x32_bf16 v[64:67], v[232:235], v[216:219], v[64:67]
    s_add_u32 s60, s60, 1024
    s_add_u32 s61, s61, 40960
    buffer_load_dwordx4 v[196:199], v10, s[32:35], s61 offen offset:0 sc1
    v_mfma_f32_16x16x32_bf16 v[68:71], v[232:235], v[220:223], v[68:71]
    v_mfma_f32_16x16x32_bf16 v[72:75], v[232:235], v[224:227], v[72:75]
    buffer_load_dwordx4 v[200:203], v10, s[32:35], s61 offen offset:1024 sc1
    v_mfma_f32_16x16x32_bf16 v[76:79], v[232:235], v[228:231], v[76:79]
    v_mfma_f32_16x16x32_bf16 v[80:83], v[236:239], v[216:219], v[80:83]
    buffer_load_dwordx4 v[204:207], v10, s[32:35], s61 offen offset:2048 sc1
    v_mfma_f32_16x16x32_bf16 v[84:87], v[236:239], v[220:223], v[84:87]
    v_mfma_f32_16x16x32_bf16 v[88:91], v[236:239], v[224:227], v[88:91]
    buffer_load_dwordx4 v[208:211], v10, s[32:35], s61 offen offset:3072 sc1
    v_mfma_f32_16x16x32_bf16 v[92:95], v[236:239], v[228:231], v[92:95]
    v_mfma_f32_16x16x32_bf16 v[96:99], v[240:243], v[216:219], v[96:99]
    buffer_load_dwordx4 v[212:215], v11, s[32:35], s61 offen sc1
    v_mfma_f32_16x16x32_bf16 v[100:103], v[240:243], v[220:223], v[100:103]
    v_mfma_f32_16x16x32_bf16 v[104:107], v[240:243], v[224:227], v[104:107]
    v_mfma_f32_16x16x32_bf16 v[108:111], v[240:243], v[228:231], v[108:111]
    buffer_load_dwordx4 v[180:183], v6, s[32:35], s60 offen sc1
    v_mfma_f32_16x16x32_bf16 v[112:115], v[244:247], v[216:219], v[112:115]
    v_mfma_f32_16x16x32_bf16 v[116:119], v[244:247], v[220:223], v[116:119]
    buffer_load_dwordx4 v[184:187], v7, s[32:35], s60 offen sc1
    v_mfma_f32_16x16x32_bf16 v[120:123], v[244:247], v[224:227], v[120:123]
    v_mfma_f32_16x16x32_bf16 v[124:127], v[244:247], v[228:231], v[124:127]
    buffer_load_dwordx4 v[188:191], v8, s[32:35], s60 offen sc1
    v_mfma_f32_16x16x32_bf16 v[128:131], v[248:251], v[216:219], v[128:131]
    v_mfma_f32_16x16x32_bf16 v[132:135], v[248:251], v[220:223], v[132:135]
    buffer_load_dwordx4 v[192:195], v9, s[32:35], s60 offen sc1
    v_mfma_f32_16x16x32_bf16 v[136:139], v[248:251], v[224:227], v[136:139]
    v_mfma_f32_16x16x32_bf16 v[140:143], v[248:251], v[228:231], v[140:143]
    s_waitcnt vmcnt(18)
    v_mfma_f32_16x16x32_bf16 v[64:67], v[44:47], v[28:31], v[64:67]
    s_add_u32 s60, s60, 1024
    s_add_u32 s61, s61, 40960
    buffer_load_dwordx4 v[232:235], v10, s[32:35], s61 offen offset:0 sc1
    v_mfma_f32_16x16x32_bf16 v[68:71], v[44:47], v[32:35], v[68:71]
    v_mfma_f32_16x16x32_bf16 v[72:75], v[44:47], v[36:39], v[72:75]
    buffer_load_dwordx4 v[236:239], v10, s[32:35], s61 offen offset:1024 sc1
    v_mfma_f32_16x16x32_bf16 v[76:79], v[44:47], v[40:43], v[76:79]
    v_mfma_f32_16x16x32_bf16 v[80:83], v[48:51], v[28:31], v[80:83]
    buffer_load_dwordx4 v[240:243], v10, s[32:35], s61 offen offset:2048 sc1
    v_mfma_f32_16x16x32_bf16 v[84:87], v[48:51], v[32:35], v[84:87]
    v_mfma_f32_16x16x32_bf16 v[88:91], v[48:51], v[36:39], v[88:91]
    buffer_load_dwordx4 v[244:247], v10, s[32:35], s61 offen offset:3072 sc1
    v_mfma_f32_16x16x32_bf16 v[92:95], v[48:51], v[40:43], v[92:95]
    v_mfma_f32_16x16x32_bf16 v[96:99], v[52:55], v[28:31], v[96:99]
    buffer_load_dwordx4 v[248:251], v11, s[32:35], s61 offen sc1
    v_mfma_f32_16x16x32_bf16 v[100:103], v[52:55], v[32:35], v[100:103]
    v_mfma_f32_16x16x32_bf16 v[104:107], v[52:55], v[36:39], v[104:107]
    v_mfma_f32_16x16x32_bf16 v[108:111], v[52:55], v[40:43], v[108:111]
    buffer_load_dwordx4 v[216:219], v6, s[32:35], s60 offen sc1
    v_mfma_f32_16x16x32_bf16 v[112:115], v[56:59], v[28:31], v[112:115]
    v_mfma_f32_16x16x32_bf16 v[116:119], v[56:59], v[32:35], v[116:119]
    buffer_load_dwordx4 v[220:223], v7, s[32:35], s60 offen sc1
    v_mfma_f32_16x16x32_bf16 v[120:123], v[56:59], v[36:39], v[120:123]
    v_mfma_f32_16x16x32_bf16 v[124:127], v[56:59], v[40:43], v[124:127]
    buffer_load_dwordx4 v[224:227], v8, s[32:35], s60 offen sc1
    v_mfma_f32_16x16x32_bf16 v[128:131], v[60:63], v[28:31], v[128:131]
    v_mfma_f32_16x16x32_bf16 v[132:135], v[60:63], v[32:35], v[132:135]
    buffer_load_dwordx4 v[228:231], v9, s[32:35], s60 offen sc1
    v_mfma_f32_16x16x32_bf16 v[136:139], v[60:63], v[36:39], v[136:139]
    v_mfma_f32_16x16x32_bf16 v[140:143], v[60:63], v[40:43], v[140:143]
    s_waitcnt vmcnt(18)
    v_mfma_f32_16x16x32_bf16 v[64:67], v[160:163], v[144:147], v[64:67]
    s_add_u32 s60, s60, 1024
    s_add_u32 s61, s61, 40960
    buffer_load_dwordx4 v[44:47], v10, s[32:35], s61 offen offset:0 sc1
    v_mfma_f32_16x16x32_bf16 v[68:71], v[160:163], v[148:151], v[68:71]
    v_mfma_f32_16x16x32_bf16 v[72:75], v[160:163], v[152:155], v[72:75]
    buffer_load_dwordx4 v[48:51], v10, s[32:35], s61 offen offset:1024 sc1
    v_mfma_f32_16x16x32_bf16 v[76:79], v[160:163], v[156:159], v[76:79]
    v_mfma_f32_16x16x32_bf16 v[80:83], v[164:167], v[144:147], v[80:83]
    buffer_load_dwordx4 v[52:55], v10, s[32:35], s61 offen offset:2048 sc1
    v_mfma_f32_16x16x32_bf16 v[84:87], v[164:167], v[148:151], v[84:87]
    v_mfma_f32_16x16x32_bf16 v[88:91], v[164:167], v[152:155], v[88:91]
    buffer_load_dwordx4 v[56:59], v10, s[32:35], s61 offen offset:3072 sc1
    v_mfma_f32_16x16x32_bf16 v[92:95], v[164:167], v[156:159], v[92:95]
    v_mfma_f32_16x16x32_bf16 v[96:99], v[168:171], v[144:147], v[96:99]
    buffer_load_dwordx4 v[60:63], v11, s[32:35], s61 offen sc1
    v_mfma_f32_16x16x32_bf16 v[100:103], v[168:171], v[148:151], v[100:103]
    v_mfma_f32_16x16x32_bf16 v[104:107], v[168:171], v[152:155], v[104:107]
    v_mfma_f32_16x16x32_bf16 v[108:111], v[168:171], v[156:159], v[108:111]
    buffer_load_dwordx4 v[28:31], v6, s[32:35], s60 offen sc1
    v_mfma_f32_16x16x32_bf16 v[112:115], v[172:175], v[144:147], v[112:115]
    v_mfma_f32_16x16x32_bf16 v[116:119], v[172:175], v[148:151], v[116:119]
    buffer_load_dwordx4 v[32:35], v7, s[32:35], s60 offen sc1
    v_mfma_f32_16x16x32_bf16 v[120:123], v[172:175], v[152:155], v[120:123]
    v_mfma_f32_16x16x32_bf16 v[124:127], v[172:175], v[156:159], v[124:127]
    buffer_load_dwordx4 v[36:39], v8, s[32:35], s60 offen sc1
    v_mfma_f32_16x16x32_bf16 v[128:131], v[176:179], v[144:147], v[128:131]
    v_mfma_f32_16x16x32_bf16 v[132:135], v[176:179], v[148:151], v[132:135]
    buffer_load_dwordx4 v[40:43], v9, s[32:35], s60 offen sc1
    v_mfma_f32_16x16x32_bf16 v[136:139], v[176:179], v[152:155], v[136:139]
    v_mfma_f32_16x16x32_bf16 v[140:143], v[176:179], v[156:159], v[140:143]
    s_waitcnt vmcnt(18)
    v_mfma_f32_16x16x32_bf16 v[64:67], v[196:199], v[180:183], v[64:67]
    s_add_u32 s60, s60, 1024
    s_add_u32 s61, s61, 40960
    buffer_load_dwordx4 v[160:163], v10, s[32:35], s61 offen offset:0 sc1
    v_mfma_f32_16x16x32_bf16 v[68:71], v[196:199], v[184:187], v[68:71]
    v_mfma_f32_16x16x32_bf16 v[72:75], v[196:199], v[188:191], v[72:75]
    buffer_load_dwordx4 v[164:167], v10, s[32:35], s61 offen offset:1024 sc1
    v_mfma_f32_16x16x32_bf16 v[76:79], v[196:199], v[192:195], v[76:79]
    v_mfma_f32_16x16x32_bf16 v[80:83], v[200:203], v[180:183], v[80:83]
    buffer_load_dwordx4 v[168:171], v10, s[32:35], s61 offen offset:2048 sc1
    v_mfma_f32_16x16x32_bf16 v[84:87], v[200:203], v[184:187], v[84:87]
    v_mfma_f32_16x16x32_bf16 v[88:91], v[200:203], v[188:191], v[88:91]
    buffer_load_dwordx4 v[172:175], v10, s[32:35], s61 offen offset:3072 sc1
    v_mfma_f32_16x16x32_bf16 v[92:95], v[200:203], v[192:195], v[92:95]
    v_mfma_f32_16x16x32_bf16 v[96:99], v[204:207], v[180:183], v[96:99]
    buffer_load_dwordx4 v[176:179], v11, s[32:35], s61 offen sc1
    v_mfma_f32_16x16x32_bf16 v[100:103], v[204:207], v[184:187], v[100:103]
    v_mfma_f32_16x16x32_bf16 v[104:107], v[204:207], v[188:191], v[104:107]
    v_mfma_f32_16x16x32_bf16 v[108:111], v[204:207], v[192:195], v[108:111]
    buffer_load_dwordx4 v[144:147], v6, s[32:35], s60 offen sc1
    v_mfma_f32_16x16x32_bf16 v[112:115], v[208:211], v[180:183], v[112:115]
    v_mfma_f32_16x16x32_bf16 v[116:119], v[208:211], v[184:187], v[116:119]
    buffer_load_dwordx4 v[148:151], v7, s[32:35], s60 offen sc1
    v_mfma_f32_16x16x32_bf16 v[120:123], v[208:211], v[188:191], v[120:123]
    v_mfma_f32_16x16x32_bf16 v[124:127], v[208:211], v[192:195], v[124:127]
    buffer_load_dwordx4 v[152:155], v8, s[32:35], s60 offen sc1
    v_mfma_f32_16x16x32_bf16 v[128:131], v[212:215], v[180:183], v[128:131]
    v_mfma_f32_16x16x32_bf16 v[132:135], v[212:215], v[184:187], v[132:135]
    buffer_load_dwordx4 v[156:159], v9, s[32:35], s60 offen sc1
    v_mfma_f32_16x16x32_bf16 v[136:139], v[212:215], v[188:191], v[136:139]
    v_mfma_f32_16x16x32_bf16 v[140:143], v[212:215], v[192:195], v[140:143]
    s_waitcnt vmcnt(18)
    v_mfma_f32_16x16x32_bf16 v[64:67], v[232:235], v[216:219], v[64:67]
    s_add_u32 s60, s60, 1024
    s_add_u32 s61, s61, 40960
    s_cmp_eq_u32 s62, 1
    s_cselect_b32 s60, 1073741824, s60
    s_cselect_b32 s61, 1073741824, s61
    buffer_load_dwordx4 v[196:199], v10, s[32:35], s61 offen offset:0 sc1
    v_mfma_f32_16x16x32_bf16 v[68:71], v[232:235], v[220:223], v[68:71]
    v_mfma_f32_16x16x32_bf16 v[72:75], v[232:235], v[224:227], v[72:75]
    buffer_load_dwordx4 v[200:203], v10, s[32:35], s61 offen offset:1024 sc1
    v_mfma_f32_16x16x32_bf16 v[76:79], v[232:235], v[228:231], v[76:79]
    v_mfma_f32_16x16x32_bf16 v[80:83], v[236:239], v[216:219], v[80:83]
    buffer_load_dwordx4 v[204:207], v10, s[32:35], s61 offen offset:2048 sc1
    v_mfma_f32_16x16x32_bf16 v[84:87], v[236:239], v[220:223], v[84:87]
    v_mfma_f32_16x16x32_bf16 v[88:91], v[236:239], v[224:227], v[88:91]
    buffer_load_dwordx4 v[208:211], v10, s[32:35], s61 offen offset:3072 sc1
    v_mfma_f32_16x16x32_bf16 v[92:95], v[236:239], v[228:231], v[92:95]
    v_mfma_f32_16x16x32_bf16 v[96:99], v[240:243], v[216:219], v[96:99]
    buffer_load_dwordx4 v[212:215], v11, s[32:35], s61 offen sc1
    v_mfma_f32_16x16x32_bf16 v[100:103], v[240:243], v[220:223], v[100:103]
    v_mfma_f32_16x16x32_bf16 v[104:107], v[240:243], v[224:227], v[104:107]
    v_mfma_f32_16x16x32_bf16 v[108:111], v[240:243], v[228:231], v[108:111]
    buffer_load_dwordx4 v[180:183], v6, s[32:35], s60 offen sc1
    v_mfma_f32_16x16x32_bf16 v[112:115], v[244:247], v[216:219], v[112:115]
    v_mfma_f32_16x16x32_bf16 v[116:119], v[244:247], v[220:223], v[116:119]
    buffer_load_dwordx4 v[184:187], v7, s[32:35], s60 offen sc1
    v_mfma_f32_16x16x32_bf16 v[120:123], v[244:247], v[224:227], v[120:123]
    v_mfma_f32_16x16x32_bf16 v[124:127], v[244:247], v[228:231], v[124:127]
    buffer_load_dwordx4 v[188:191], v8, s[32:35], s60 offen sc1
    v_mfma_f32_16x16x32_bf16 v[128:131], v[248:251], v[216:219], v[128:131]
    v_mfma_f32_16x16x32_bf16 v[132:135], v[248:251], v[220:223], v[132:135]
    buffer_load_dwordx4 v[192:195], v9, s[32:35], s60 offen sc1
    v_mfma_f32_16x16x32_bf16 v[136:139], v[248:251], v[224:227], v[136:139]
    v_mfma_f32_16x16x32_bf16 v[140:143], v[248:251], v[228:231], v[140:143]
    s_waitcnt vmcnt(18)
    v_mfma_f32_16x16x32_bf16 v[64:67], v[44:47], v[28:31], v[64:67]
    v_mfma_f32_16x16x32_bf16 v[68:71], v[44:47], v[32:35], v[68:71]
    v_mfma_f32_16x16x32_bf16 v[72:75], v[44:47], v[36:39], v[72:75]
    v_mfma_f32_16x16x32_bf16 v[76:79], v[44:47], v[40:43], v[76:79]
    v_mfma_f32_16x16x32_bf16 v[80:83], v[48:51], v[28:31], v[80:83]
    v_mfma_f32_16x16x32_bf16 v[84:87], v[48:51], v[32:35], v[84:87]
    v_mfma_f32_16x16x32_bf16 v[88:91], v[48:51], v[36:39], v[88:91]
    v_mfma_f32_16x16x32_bf16 v[92:95], v[48:51], v[40:43], v[92:95]
    v_mfma_f32_16x16x32_bf16 v[96:99], v[52:55], v[28:31], v[96:99]
    v_mfma_f32_16x16x32_bf16 v[100:103], v[52:55], v[32:35], v[100:103]
    v_mfma_f32_16x16x32_bf16 v[104:107], v[52:55], v[36:39], v[104:107]
    v_mfma_f32_16x16x32_bf16 v[108:111], v[52:55], v[40:43], v[108:111]
    v_mfma_f32_16x16x32_bf16 v[112:115], v[56:59], v[28:31], v[112:115]
    v_mfma_f32_16x16x32_bf16 v[116:119], v[56:59], v[32:35], v[116:119]
    v_mfma_f32_16x16x32_bf16 v[120:123], v[56:59], v[36:39], v[120:123]
    v_mfma_f32_16x16x32_bf16 v[124:127], v[56:59], v[40:43], v[124:127]
    v_mfma_f32_16x16x32_bf16 v[128:131], v[60:63], v[28:31], v[128:131]
    v_mfma_f32_16x16x32_bf16 v[132:135], v[60:63], v[32:35], v[132:135]
    v_mfma_f32_16x16x32_bf16 v[136:139], v[60:63], v[36:39], v[136:139]
    v_mfma_f32_16x16x32_bf16 v[140:143], v[60:63], v[40:43], v[140:143]
    s_waitcnt vmcnt(9)
    v_mfma_f32_16x16x32_bf16 v[64:67], v[160:163], v[144:147], v[64:67]
    v_mfma_f32_16x16x32_bf16 v[68:71], v[160:163], v[148:151], v[68:71]
    v_mfma_f32_16x16x32_bf16 v[72:75], v[160:163], v[152:155], v[72:75]
    v_mfma_f32_16x16x32_bf16 v[76:79], v[160:163], v[156:159], v[76:79]
    v_mfma_f32_16x16x32_bf16 v[80:83], v[164:167], v[144:147], v[80:83]
    v_mfma_f32_16x16x32_bf16 v[84:87], v[164:167], v[148:151], v[84:87]
    v_mfma_f32_16x16x32_bf16 v[88:91], v[164:167], v[152:155], v[88:91]
    v_mfma_f32_16x16x32_bf16 v[92:95], v[164:167], v[156:159], v[92:95]
    v_mfma_f32_16x16x32_bf16 v[96:99], v[168:171], v[144:147], v[96:99]
    v_mfma_f32_16x16x32_bf16 v[100:103], v[168:171], v[148:151], v[100:103]
    v_mfma_f32_16x16x32_bf16 v[104:107], v[168:171], v[152:155], v[104:107]
    v_mfma_f32_16x16x32_bf16 v[108:111], v[168:171], v[156:159], v[108:111]
    v_mfma_f32_16x16x32_bf16 v[112:115], v[172:175], v[144:147], v[112:115]
    v_mfma_f32_16x16x32_bf16 v[116:119], v[172:175], v[148:151], v[116:119]
    v_mfma_f32_16x16x32_bf16 v[120:123], v[172:175], v[152:155], v[120:123]
    v_mfma_f32_16x16x32_bf16 v[124:127], v[172:175], v[156:159], v[124:127]
    v_mfma_f32_16x16x32_bf16 v[128:131], v[176:179], v[144:147], v[128:131]
    v_mfma_f32_16x16x32_bf16 v[132:135], v[176:179], v[148:151], v[132:135]
    v_mfma_f32_16x16x32_bf16 v[136:139], v[176:179], v[152:155], v[136:139]
    v_mfma_f32_16x16x32_bf16 v[140:143], v[176:179], v[156:159], v[140:143]
    s_waitcnt vmcnt(0)
    v_mfma_f32_16x16x32_bf16 v[64:67], v[196:199], v[180:183], v[64:67]
    v_mfma_f32_16x16x32_bf16 v[68:71], v[196:199], v[184:187], v[68:71]
    v_mfma_f32_16x16x32_bf16 v[72:75], v[196:199], v[188:191], v[72:75]
    v_mfma_f32_16x16x32_bf16 v[76:79], v[196:199], v[192:195], v[76:79]
    v_mfma_f32_16x16x32_bf16 v[80:83], v[200:203], v[180:183], v[80:83]
    v_mfma_f32_16x16x32_bf16 v[84:87], v[200:203], v[184:187], v[84:87]
    v_mfma_f32_16x16x32_bf16 v[88:91], v[200:203], v[188:191], v[88:91]
    v_mfma_f32_16x16x32_bf16 v[92:95], v[200:203], v[192:195], v[92:95]
    v_mfma_f32_16x16x32_bf16 v[96:99], v[204:207], v[180:183], v[96:99]
    v_mfma_f32_16x16x32_bf16 v[100:103], v[204:207], v[184:187], v[100:103]
    v_mfma_f32_16x16x32_bf16 v[104:107], v[204:207], v[188:191], v[104:107]
    v_mfma_f32_16x16x32_bf16 v[108:111], v[204:207], v[192:195], v[108:111]
    v_mfma_f32_16x16x32_bf16 v[112:115], v[208:211], v[180:183], v[112:115]
    v_mfma_f32_16x16x32_bf16 v[116:119], v[208:211], v[184:187], v[116:119]
    v_mfma_f32_16x16x32_bf16 v[120:123], v[208:211], v[188:191], v[120:123]
    v_mfma_f32_16x16x32_bf16 v[124:127], v[208:211], v[192:195], v[124:127]
    v_mfma_f32_16x16x32_bf16 v[128:131], v[212:215], v[180:183], v[128:131]
    v_mfma_f32_16x16x32_bf16 v[132:135], v[212:215], v[184:187], v[132:135]
    v_mfma_f32_16x16x32_bf16 v[136:139], v[212:215], v[188:191], v[136:139]
    v_mfma_f32_16x16x32_bf16 v[140:143], v[212:215], v[192:195], v[140:143]
    s_branch P2_GE
P2_G5:
    s_add_u32 s63, s60, 4096
    buffer_load_dwordx4 v[28:31], v6, s[32:35], s60 offen offset:0 sc1
    buffer_load_dwordx4 v[32:35], v7, s[32:35], s60 offen offset:0 sc1
    buffer_load_dwordx4 v[36:39], v8, s[32:35], s60 offen offset:0 sc1
    buffer_load_dwordx4 v[40:43], v9, s[32:35], s60 offen offset:0 sc1
    buffer_load_dwordx4 v[44:47], v6, s[32:35], s60 offen offset:1024 sc1
    buffer_load_dwordx4 v[48:51], v7, s[32:35], s60 offen offset:1024 sc1
    buffer_load_dwordx4 v[52:55], v8, s[32:35], s60 offen offset:1024 sc1
    buffer_load_dwordx4 v[56:59], v9, s[32:35], s60 offen offset:1024 sc1
    buffer_load_dwordx4 v[244:247], v6, s[32:35], s60 offen offset:2048 sc1
    buffer_load_dwordx4 v[248:251], v7, s[32:35], s60 offen offset:2048 sc1
    buffer_load_dwordx4 v[252:255], v8, s[32:35], s60 offen offset:2048 sc1
    buffer_load_dwordx4 v[60:63], v9, s[32:35], s60 offen offset:2048 sc1
    s_waitcnt vmcnt(8)
    v_mfma_f32_16x16x32_bf16 v[64:67], v[144:147], v[28:31], 0
    v_mfma_f32_16x16x32_bf16 v[68:71], v[144:147], v[32:35], 0
    v_mfma_f32_16x16x32_bf16 v[72:75], v[144:147], v[36:39], 0
    v_mfma_f32_16x16x32_bf16 v[76:79], v[144:147], v[40:43], 0
    v_mfma_f32_16x16x32_bf16 v[80:83], v[148:151], v[28:31], 0
    v_mfma_f32_16x16x32_bf16 v[84:87], v[148:151], v[32:35], 0
    v_mfma_f32_16x16x32_bf16 v[88:91], v[148:151], v[36:39], 0
    v_mfma_f32_16x16x32_bf16 v[92:95], v[148:151], v[40:43], 0
    v_mfma_f32_16x16x32_bf16 v[96:99], v[152:155], v[28:31], 0
    v_mfma_f32_16x16x32_bf16 v[100:103], v[152:155], v[32:35], 0
    v_mfma_f32_16x16x32_bf16 v[104:107], v[152:155], v[36:39], 0
    v_mfma_f32_16x16x32_bf16 v[108:111], v[152:155], v[40:43], 0
    v_mfma_f32_16x16x32_bf16 v[112:115], v[156:159], v[28:31], 0
    v_mfma_f32_16x16x32_bf16 v[116:119], v[156:159], v[32:35], 0
    v_mfma_f32_16x16x32_bf16 v[120:123], v[156:159], v[36:39], 0
    v_mfma_f32_16x16x32_bf16 v[124:127], v[156:159], v[40:43], 0
    v_mfma_f32_16x16x32_bf16 v[128:131], v[160:163], v[28:31], 0
    v_mfma_f32_16x16x32_bf16 v[132:135], v[160:163], v[32:35], 0
    v_mfma_f32_16x16x32_bf16 v[136:139], v[160:163], v[36:39], 0
    v_mfma_f32_16x16x32_bf16 v[140:143], v[160:163], v[40:43], 0
    buffer_load_dwordx4 v[28:31], v6, s[32:35], s60 offen offset:3072 sc1
    buffer_load_dwordx4 v[32:35], v7, s[32:35], s60 offen offset:3072 sc1
    buffer_load_dwordx4 v[36:39], v8, s[32:35], s60 offen offset:3072 sc1
    buffer_load_dwordx4 v[40:43], v9, s[32:35], s60 offen offset:3072 sc1
    s_waitcnt vmcnt(8)
    v_mfma_f32_16x16x32_bf16 v[64:67], v[164:167], v[44:47], v[64:67]
    v_mfma_f32_16x16x32_bf16 v[68:71], v[164:167], v[48:51], v[68:71]
    v_mfma_f32_16x16x32_bf16 v[72:75], v[164:167], v[52:55], v[72:75]
    v_mfma_f32_16x16x32_bf16 v[76:79], v[164:167], v[56:59], v[76:79]
    v_mfma_f32_16x16x32_bf16 v[80:83], v[168:171], v[44:47], v[80:83]
    v_mfma_f32_16x16x32_bf16 v[84:87], v[168:171], v[48:51], v[84:87]
    v_mfma_f32_16x16x32_bf16 v[88:91], v[168:171], v[52:55], v[88:91]
    v_mfma_f32_16x16x32_bf16 v[92:95], v[168:171], v[56:59], v[92:95]
    v_mfma_f32_16x16x32_bf16 v[96:99], v[172:175], v[44:47], v[96:99]
    v_mfma_f32_16x16x32_bf16 v[100:103], v[172:175], v[48:51], v[100:103]
    v_mfma_f32_16x16x32_bf16 v[104:107], v[172:175], v[52:55], v[104:107]
    v_mfma_f32_16x16x32_bf16 v[108:111], v[172:175], v[56:59], v[108:111]
    v_mfma_f32_16x16x32_bf16 v[112:115], v[176:179], v[44:47], v[112:115]
    v_mfma_f32_16x16x32_bf16 v[116:119], v[176:179], v[48:51], v[116:119]
    v_mfma_f32_16x16x32_bf16 v[120:123], v[176:179], v[52:55], v[120:123]
    v_mfma_f32_16x16x32_bf16 v[124:127], v[176:179], v[56:59], v[124:127]
    v_mfma_f32_16x16x32_bf16 v[128:131], v[180:183], v[44:47], v[128:131]
    v_mfma_f32_16x16x32_bf16 v[132:135], v[180:183], v[48:51], v[132:135]
    v_mfma_f32_16x16x32_bf16 v[136:139], v[180:183], v[52:55], v[136:139]
    v_mfma_f32_16x16x32_bf16 v[140:143], v[180:183], v[56:59], v[140:143]
    buffer_load_dwordx4 v[44:47], v6, s[32:35], s63 offen sc1
    buffer_load_dwordx4 v[48:51], v7, s[32:35], s63 offen sc1
    buffer_load_dwordx4 v[52:55], v8, s[32:35], s63 offen sc1
    buffer_load_dwordx4 v[56:59], v9, s[32:35], s63 offen sc1
    s_waitcnt vmcnt(8)
    v_mfma_f32_16x16x32_bf16 v[64:67], v[184:187], v[244:247], v[64:67]
    v_mfma_f32_16x16x32_bf16 v[68:71], v[184:187], v[248:251], v[68:71]
    v_mfma_f32_16x16x32_bf16 v[72:75], v[184:187], v[252:255], v[72:75]
    v_mfma_f32_16x16x32_bf16 v[76:79], v[184:187], v[60:63], v[76:79]
    v_mfma_f32_16x16x32_bf16 v[80:83], v[188:191], v[244:247], v[80:83]
    v_mfma_f32_16x16x32_bf16 v[84:87], v[188:191], v[248:251], v[84:87]
    v_mfma_f32_16x16x32_bf16 v[88:91], v[188:191], v[252:255], v[88:91]
    v_mfma_f32_16x16x32_bf16 v[92:95], v[188:191], v[60:63], v[92:95]
    v_mfma_f32_16x16x32_bf16 v[96:99], v[192:195], v[244:247], v[96:99]
    v_mfma_f32_16x16x32_bf16 v[100:103], v[192:195], v[248:251], v[100:103]
    v_mfma_f32_16x16x32_bf16 v[104:107], v[192:195], v[252:255], v[104:107]
    v_mfma_f32_16x16x32_bf16 v[108:111], v[192:195], v[60:63], v[108:111]
    v_mfma_f32_16x16x32_bf16 v[112:115], v[196:199], v[244:247], v[112:115]
    v_mfma_f32_16x16x32_bf16 v[116:119], v[196:199], v[248:251], v[116:119]
    v_mfma_f32_16x16x32_bf16 v[120:123], v[196:199], v[252:255], v[120:123]
    v_mfma_f32_16x16x32_bf16 v[124:127], v[196:199], v[60:63], v[124:127]
    v_mfma_f32_16x16x32_bf16 v[128:131], v[200:203], v[244:247], v[128:131]
    v_mfma_f32_16x16x32_bf16 v[132:135], v[200:203], v[248:251], v[132:135]
    v_mfma_f32_16x16x32_bf16 v[136:139], v[200:203], v[252:255], v[136:139]
    v_mfma_f32_16x16x32_bf16 v[140:143], v[200:203], v[60:63], v[140:143]
    s_waitcnt vmcnt(4)
    v_mfma_f32_16x16x32_bf16 v[64:67], v[204:207], v[28:31], v[64:67]
    v_mfma_f32_16x16x32_bf16 v[68:71], v[204:207], v[32:35], v[68:71]
    v_mfma_f32_16x16x32_bf16 v[72:75], v[204:207], v[36:39], v[72:75]
    v_mfma_f32_16x16x32_bf16 v[76:79], v[204:207], v[40:43], v[76:79]
    v_mfma_f32_16x16x32_bf16 v[80:83], v[208:211], v[28:31], v[80:83]
    v_mfma_f32_16x16x32_bf16 v[84:87], v[208:211], v[32:35], v[84:87]
    v_mfma_f32_16x16x32_bf16 v[88:91], v[208:211], v[36:39], v[88:91]
    v_mfma_f32_16x16x32_bf16 v[92:95], v[208:211], v[40:43], v[92:95]
    v_mfma_f32_16x16x32_bf16 v[96:99], v[212:215], v[28:31], v[96:99]
    v_mfma_f32_16x16x32_bf16 v[100:103], v[212:215], v[32:35], v[100:103]
    v_mfma_f32_16x16x32_bf16 v[104:107], v[212:215], v[36:39], v[104:107]
    v_mfma_f32_16x16x32_bf16 v[108:111], v[212:215], v[40:43], v[108:111]
    v_mfma_f32_16x16x32_bf16 v[112:115], v[216:219], v[28:31], v[112:115]
    v_mfma_f32_16x16x32_bf16 v[116:119], v[216:219], v[32:35], v[116:119]
    v_mfma_f32_16x16x32_bf16 v[120:123], v[216:219], v[36:39], v[120:123]
    v_mfma_f32_16x16x32_bf16 v[124:127], v[216:219], v[40:43], v[124:127]
    v_mfma_f32_16x16x32_bf16 v[128:131], v[220:223], v[28:31], v[128:131]
    v_mfma_f32_16x16x32_bf16 v[132:135], v[220:223], v[32:35], v[132:135]
    v_mfma_f32_16x16x32_bf16 v[136:139], v[220:223], v[36:39], v[136:139]
    v_mfma_f32_16x16x32_bf16 v[140:143], v[220:223], v[40:43], v[140:143]
    s_waitcnt vmcnt(0)
    v_mfma_f32_16x16x32_bf16 v[64:67], v[224:227], v[44:47], v[64:67]
    v_mfma_f32_16x16x32_bf16 v[68:71], v[224:227], v[48:51], v[68:71]
    v_mfma_f32_16x16x32_bf16 v[72:75], v[224:227], v[52:55], v[72:75]
    v_mfma_f32_16x16x32_bf16 v[76:79], v[224:227], v[56:59], v[76:79]
    v_mfma_f32_16x16x32_bf16 v[80:83], v[228:231], v[44:47], v[80:83]
    v_mfma_f32_16x16x32_bf16 v[84:87], v[228:231], v[48:51], v[84:87]
    v_mfma_f32_16x16x32_bf16 v[88:91], v[228:231], v[52:55], v[88:91]
    v_mfma_f32_16x16x32_bf16 v[92:95], v[228:231], v[56:59], v[92:95]
    v_mfma_f32_16x16x32_bf16 v[96:99], v[232:235], v[44:47], v[96:99]
    v_mfma_f32_16x16x32_bf16 v[100:103], v[232:235], v[48:51], v[100:103]
    v_mfma_f32_16x16x32_bf16 v[104:107], v[232:235], v[52:55], v[104:107]
    v_mfma_f32_16x16x32_bf16 v[108:111], v[232:235], v[56:59], v[108:111]
    v_mfma_f32_16x16x32_bf16 v[112:115], v[236:239], v[44:47], v[112:115]
    v_mfma_f32_16x16x32_bf16 v[116:119], v[236:239], v[48:51], v[116:119]
    v_mfma_f32_16x16x32_bf16 v[120:123], v[236:239], v[52:55], v[120:123]
    v_mfma_f32_16x16x32_bf16 v[124:127], v[236:239], v[56:59], v[124:127]
    v_mfma_f32_16x16x32_bf16 v[128:131], v[240:243], v[44:47], v[128:131]
    v_mfma_f32_16x16x32_bf16 v[132:135], v[240:243], v[48:51], v[132:135]
    v_mfma_f32_16x16x32_bf16 v[136:139], v[240:243], v[52:55], v[136:139]
    v_mfma_f32_16x16x32_bf16 v[140:143], v[240:243], v[56:59], v[140:143]
P2_GE:
    s_lshl_b32 s55, s51, 6
    s_and_b32 s56, s48, 3
    s_lshl_b32 s56, s56, 4
    s_add_u32 s55, s55, s56
    v_add_u32 v24, s55, v14
    v_mul_u32_u24 v24, 1280, v24
    v_lshl_add_u32 v24, v15, 3, v24
    s_mul_i32 s56, s52, 160
    v_add_u32 v22, s56, v24
    s_lshr_b32 s57, s48, 2
    s_mul_i32 s58, s57, 96
    v_add_u32 v22, s58, v22
    s_cmp_eq_u32 s57, 0
    s_cselect_b64 vcc, -1, 0
    v_cndmask_b32 v19, v23, v22, vcc
    buffer_load_dwordx2 v[28:29], v22, s[24:27], 0 offen offset:0
    buffer_load_dwordx2 v[30:31], v22, s[24:27], 0 offen offset:32
    buffer_load_dwordx2 v[32:33], v19, s[24:27], 0 offen offset:64
    ds_write_b128 v13, v[64:67] offset:0
    ds_write_b128 v13, v[80:83] offset:1024
    ds_write_b128 v13, v[96:99] offset:2048
    ds_write_b128 v13, v[112:115] offset:3072
    ds_write_b128 v13, v[128:131] offset:4096
    ds_write_b128 v13, v[68:71] offset:5120
    ds_write_b128 v13, v[84:87] offset:6144
    ds_write_b128 v13, v[100:103] offset:7168
    ds_write_b128 v13, v[116:119] offset:8192
    ds_write_b128 v13, v[132:135] offset:9216
    ds_write_b128 v13, v[72:75] offset:10240
    ds_write_b128 v13, v[88:91] offset:11264
    ds_write_b128 v13, v[104:107] offset:12288
    ds_write_b128 v13, v[120:123] offset:13312
    ds_write_b128 v13, v[136:139] offset:14336
    ds_write_b128 v13, v[76:79] offset:15360
    ds_write_b128 v13, v[92:95] offset:16384
    ds_write_b128 v13, v[108:111] offset:17408
    ds_write_b128 v13, v[124:127] offset:18432
    ds_write_b128 v13, v[140:143] offset:19456
    s_waitcnt lgkmcnt(0)
    s_barrier
    s_and_b32 s55, s48, 3
    s_mul_i32 s55, s55, 5120
    s_mul_i32 s58, s57, 3072
    s_add_u32 s55, s55, s58
    v_add_u32 v4, s55, v12
    v_add_u32 v21, 61440, v4
    v_add_u32 v20, 122880, v4
    ds_read_b128 v[64:67], v4 offset:0
    ds_read_b128 v[68:71], v4 offset:1024
    ds_read_b128 v[72:75], v4 offset:2048
    ds_read_b128 v[76:79], v4 offset:20480
    ds_read_b128 v[80:83], v4 offset:21504
    ds_read_b128 v[84:87], v4 offset:22528
    ds_read_b128 v[88:91], v4 offset:40960
    ds_read_b128 v[92:95], v4 offset:41984
    ds_read_b128 v[96:99], v4 offset:43008
    ds_read_b128 v[100:103], v21 offset:0
    ds_read_b128 v[104:107], v21 offset:1024
    ds_read_b128 v[108:111], v21 offset:2048
    ds_read_b128 v[112:115], v21 offset:20480
    ds_read_b128 v[116:119], v21 offset:21504
    ds_read_b128 v[120:123], v21 offset:22528
    ds_read_b128 v[124:127], v21 offset:40960
    ds_read_b128 v[128:131], v21 offset:41984
    ds_read_b128 v[132:135], v21 offset:43008
    ds_read_b128 v[136:139], v20 offset:0
    ds_read_b128 v[140:143], v20 offset:1024
    ds_read_b128 v[144:147], v20 offset:2048
    ds_read_b128 v[148:151], v20 offset:20480
    ds_read_b128 v[152:155], v20 offset:21504
    ds_read_b128 v[156:159], v20 offset:22528
    s_waitcnt lgkmcnt(15)
    v_pk_add_f32 v[64:65], v[64:65], v[76:77]
    v_pk_add_f32 v[66:67], v[66:67], v[78:79]
    v_pk_add_f32 v[68:69], v[68:69], v[80:81]
    v_pk_add_f32 v[70:71], v[70:71], v[82:83]
    v_pk_add_f32 v[72:73], v[72:73], v[84:85]
    v_pk_add_f32 v[74:75], v[74:75], v[86:87]
    s_waitcnt lgkmcnt(15)
    v_pk_add_f32 v[64:65], v[64:65], v[88:89]
    v_pk_add_f32 v[66:67], v[66:67], v[90:91]
    v_pk_add_f32 v[68:69], v[68:69], v[92:93]
    v_pk_add_f32 v[70:71], v[70:71], v[94:95]
    v_pk_add_f32 v[72:73], v[72:73], v[96:97]
    v_pk_add_f32 v[74:75], v[74:75], v[98:99]
    s_waitcnt lgkmcnt(12)
    v_pk_add_f32 v[64:65], v[64:65], v[100:101]
    v_pk_add_f32 v[66:67], v[66:67], v[102:103]
    v_pk_add_f32 v[68:69], v[68:69], v[104:105]
    v_pk_add_f32 v[70:71], v[70:71], v[106:107]
    v_pk_add_f32 v[72:73], v[72:73], v[108:109]
    v_pk_add_f32 v[74:75], v[74:75], v[110:111]
    s_waitcnt lgkmcnt(6)
    v_pk_add_f32 v[112:113], v[112:113], v[124:125]
    v_pk_add_f32 v[114:115], v[114:115], v[126:127]
    v_pk_add_f32 v[116:117], v[116:117], v[128:129]
    v_pk_add_f32 v[118:119], v[118:119], v[130:131]
    v_pk_add_f32 v[120:121], v[120:121], v[132:133]
    v_pk_add_f32 v[122:123], v[122:123], v[134:135]
    s_waitcnt lgkmcnt(3)
    v_pk_add_f32 v[112:113], v[112:113], v[136:137]
    v_pk_add_f32 v[114:115], v[114:115], v[138:139]
    v_pk_add_f32 v[116:117], v[116:117], v[140:141]
    v_pk_add_f32 v[118:119], v[118:119], v[142:143]
    v_pk_add_f32 v[120:121], v[120:121], v[144:145]
    v_pk_add_f32 v[122:123], v[122:123], v[146:147]
    s_waitcnt lgkmcnt(0)
    v_pk_add_f32 v[112:113], v[112:113], v[148:149]
    v_pk_add_f32 v[114:115], v[114:115], v[150:151]
    v_pk_add_f32 v[116:117], v[116:117], v[152:153]
    v_pk_add_f32 v[118:119], v[118:119], v[154:155]
    v_pk_add_f32 v[120:121], v[120:121], v[156:157]
    v_pk_add_f32 v[122:123], v[122:123], v[158:159]
    s_mov_b32 s56, 1069066811
    s_mov_b32 s57, 1069066811
    v_pk_mul_f32 v[76:77], v[64:65], s[56:57] op_sel_hi:[1,0]
    v_pk_mul_f32 v[78:79], v[66:67], s[56:57] op_sel_hi:[1,0]
    v_pk_mul_f32 v[80:81], v[68:69], s[56:57] op_sel_hi:[1,0]
    v_pk_mul_f32 v[82:83], v[70:71], s[56:57] op_sel_hi:[1,0]
    v_pk_mul_f32 v[84:85], v[72:73], s[56:57] op_sel_hi:[1,0]
    v_pk_mul_f32 v[86:87], v[74:75], s[56:57] op_sel_hi:[1,0]
    v_exp_f32 v76, -v76
    v_exp_f32 v77, -v77
    v_exp_f32 v78, -v78
    v_exp_f32 v79, -v79
    v_exp_f32 v80, -v80
    v_exp_f32 v81, -v81
    v_exp_f32 v82, -v82
    v_exp_f32 v83, -v83
    v_exp_f32 v84, -v84
    v_exp_f32 v85, -v85
    v_exp_f32 v86, -v86
    v_exp_f32 v87, -v87
    v_pk_add_f32 v[76:77], v[76:77], 1.0 op_sel_hi:[1,0]
    v_pk_add_f32 v[78:79], v[78:79], 1.0 op_sel_hi:[1,0]
    v_pk_add_f32 v[80:81], v[80:81], 1.0 op_sel_hi:[1,0]
    v_pk_add_f32 v[82:83], v[82:83], 1.0 op_sel_hi:[1,0]
    v_pk_add_f32 v[84:85], v[84:85], 1.0 op_sel_hi:[1,0]
    v_pk_add_f32 v[86:87], v[86:87], 1.0 op_sel_hi:[1,0]
    v_rcp_f32 v76, v76
    v_rcp_f32 v77, v77
    v_rcp_f32 v78, v78
    v_rcp_f32 v79, v79
    v_rcp_f32 v80, v80
    v_rcp_f32 v81, v81
    v_rcp_f32 v82, v82
    v_rcp_f32 v83, v83
    v_rcp_f32 v84, v84
    v_rcp_f32 v85, v85
    v_rcp_f32 v86, v86
    v_rcp_f32 v87, v87
    v_pk_mul_f32 v[64:65], v[64:65], v[76:77]
    v_pk_mul_f32 v[66:67], v[66:67], v[78:79]
    v_pk_mul_f32 v[68:69], v[68:69], v[80:81]
    v_pk_mul_f32 v[70:71], v[70:71], v[82:83]
    v_pk_mul_f32 v[72:73], v[72:73], v[84:85]
    v_pk_mul_f32 v[74:75], v[74:75], v[86:87]
    s_waitcnt vmcnt(0)
    v_lshlrev_b32 v88, 16, v28
    v_and_b32 v89, 0xffff0000, v28
    v_pk_fma_f32 v[88:89], v[112:113], v[64:65], v[88:89]
    v_cvt_pk_bf16_f32 v90, v88, v89
    v_lshlrev_b32 v88, 16, v29
    v_and_b32 v89, 0xffff0000, v29
    v_pk_fma_f32 v[88:89], v[114:115], v[66:67], v[88:89]
    v_cvt_pk_bf16_f32 v91, v88, v89
    buffer_store_dwordx2 v[90:91], v22, s[28:31], 0 offen offset:0
    v_lshlrev_b32 v88, 16, v30
    v_and_b32 v89, 0xffff0000, v30
    v_pk_fma_f32 v[88:89], v[116:117], v[68:69], v[88:89]
    v_cvt_pk_bf16_f32 v92, v88, v89
    v_lshlrev_b32 v88, 16, v31
    v_and_b32 v89, 0xffff0000, v31
    v_pk_fma_f32 v[88:89], v[118:119], v[70:71], v[88:89]
    v_cvt_pk_bf16_f32 v93, v88, v89
    buffer_store_dwordx2 v[92:93], v22, s[28:31], 0 offen offset:32
    v_lshlrev_b32 v88, 16, v32
    v_and_b32 v89, 0xffff0000, v32
    v_pk_fma_f32 v[88:89], v[120:121], v[72:73], v[88:89]
    v_cvt_pk_bf16_f32 v94, v88, v89
    v_lshlrev_b32 v88, 16, v33
    v_and_b32 v89, 0xffff0000, v33
    v_pk_fma_f32 v[88:89], v[122:123], v[74:75], v[88:89]
    v_cvt_pk_bf16_f32 v95, v88, v89
    buffer_store_dwordx2 v[94:95], v19, s[28:31], 0 offen offset:64
P2_DONE:
K1_END:
    s_endpgm
.section .rodata,"a"

.p2align 6
.amdhsa_kernel k1_kernel
  .amdhsa_next_free_vgpr 256
  .amdhsa_next_free_sgpr 100
  .amdhsa_accum_offset 256
  .amdhsa_group_segment_fixed_size 0
  .amdhsa_kernarg_size 80
  .amdhsa_user_sgpr_count 2
  .amdhsa_user_sgpr_kernarg_segment_ptr 1
  .amdhsa_system_sgpr_workgroup_id_x 1
.end_amdhsa_kernel
```
